```python
import torch

def _softmax(x, axis=-1):
    return torch.softmax(x, dim=axis)
def _gelu(x):
    return torch.nn.functional.gelu(x, approximate="tanh")
def _silu(x):
    return torch.nn.functional.silu(x)
def _sigmoid(x):
    return torch.sigmoid(x)
def _layernorm(x, axis=-1, eps=1e-5):
    m = x.mean(dim=axis, keepdim=True)
    v = x.var(dim=axis, keepdim=True, unbiased=False)
    return (x - m) / torch.sqrt(v + eps)
def _scatter_add(tgt, idx, src, axis=0):
    return tgt.clone().index_add_(axis, idx, src)
def _segment_sum(src, seg, n):
    out = torch.zeros((n,) + src.shape[1:], dtype=src.dtype)
    return out.index_add_(0, seg, src)
def _pad(x, pw):
    flat = tuple(v for pair in reversed(pw) for v in pair)
    return torch.nn.functional.pad(x, flat)

kernel_name = 'standalone__gqa_block_cached__near_ridge'

def setup_inputs():

    _w = (lambda a: (lambda t: t.to(torch.bfloat16) if t.is_floating_point() else t)(torch.as_tensor(a)))
    B, Sq, D = 8, 192, 512
    Hq, Hkv, Sk, Dh = 32, 32, 1024, 128
    assert Hq % Hkv == 0, (Hq, Hkv)
    return {
        "x": _w((lambda *s: torch.randn(*s, dtype=torch.bfloat16) * 0.8)(B, Sq, D)),
        "k_cache": _w((lambda *s: torch.randn(*s, dtype=torch.bfloat16) * 0.8)(B, Hkv, Sk, Dh)),
        "v_cache": _w((lambda *s: torch.randn(*s, dtype=torch.bfloat16) * 0.05)(B, Hkv, Sk, Dh)),
        "wq": _w((lambda *s: torch.randn(*s, dtype=torch.bfloat16) * 0.8)(D, Hq * Dh) * (D ** -0.5)),
        "wo": _w((lambda *s: torch.randn(*s, dtype=torch.bfloat16) * 0.05)(Hq * Dh, D) * ((Hq * Dh) ** -0.5)),
    }

def reference(x, k_cache, v_cache, wq, wo):
    B, Sq, D = x.shape
    Hq, Dh = 32, 128
    Hkv = k_cache.shape[1]
    rep = Hq // Hkv
    q = (lambda x, *d: x.permute(*d))((x @ wq).reshape(B, Sq, Hq, Dh), 0, 2, 1, 3)
    k = (lambda x, n, axis: torch.repeat_interleave(x, n, dim=axis))(k_cache, rep, axis=1)
    v = (lambda x, n, axis: torch.repeat_interleave(x, n, dim=axis))(v_cache, rep, axis=1)
    scores = torch.einsum("bhqd,bhkd->bhqk", q, k) * (Dh ** -0.5)
    p = _softmax(scores, axis=-1)
    o = torch.einsum("bhqk,bhkd->bhqd", p, v)
    return (lambda x, *d: x.permute(*d))(o, 0, 2, 1, 3).reshape(B, Sq, Hq * Dh) @ wo
```

```asm
; @launch grid=(256,1,1) block=(512,1,1) lds=163840
.amdgcn_target "amdgcn-amd-amdhsa--gfx950"
.text
.globl standalone__gqa_block_cached__near_ridge_kernel
.p2align 8
.type standalone__gqa_block_cached__near_ridge_kernel,@function
standalone__gqa_block_cached__near_ridge_kernel:
    s_cmp_ge_u32 s2, 256
    s_cbranch_scc1 A_done
    s_load_dwordx16 s[4:19], s[0:1], 0
    v_lshrrev_b32 v1, 6, v0
    v_and_b32 v255, 63, v0
    v_readfirstlane_b32 s44, v1
    s_and_b32 s46, s2, 1
    s_lshl_b32 s46, s46, 2
    s_bfe_u32 s47, s2, 0x20003
    s_add_u32 s45, s46, s47
    s_bfe_u32 s46, s2, 0x20001
    s_lshl_b32 s46, s46, 3
    s_lshr_b32 s48, s2, 5
    s_add_u32 s50, s46, s48
    s_lshl_b32 s47, s47, 1
    s_add_u32 s51, s47, s48
    s_add_u32 s46, s2, 1
    s_mul_i32 s46, s46, 0x9E3779B1
    s_lshr_b32 s47, s46, 15
    s_xor_b32 s46, s46, s47
    s_mul_i32 s46, s46, 0x85EBCA6B
    s_lshr_b32 s52, s46, 24
    s_or_b32 s52, s52, 16
    v_lshrrev_b32 v254, 4, v255
    v_and_b32 v253, 15, v255
    s_cmp_ge_u32 s44, 4
    s_cbranch_scc1 A_loader
    s_mov_b32 s54, 0x3e0293ee
    s_mov_b32 s55, 0x40004000
    s_mul_i32 s46, s44, 6144
    v_lshl_add_u32 v1, v253, 7, s46
    v_lshrrev_b32 v2, 1, v253
    v_xor_b32 v2, v2, v254
    v_lshl_add_u32 v247, v2, 4, v1
    v_xor_b32 v2, 4, v2
    v_lshl_add_u32 v248, v2, 4, v1
    v_add_u32 v250, 69632, v247
    v_add_u32 v251, 69632, v248
    v_bfe_u32 v1, v255, 2, 3
    v_mul_u32_u24 v1, 1056, v1
    v_and_b32 v2, 3, v255
    v_lshl_add_u32 v1, v2, 3, v1
    v_add_u32 v1, 94208, v1
    v_lshrrev_b32 v2, 5, v255
    v_lshl_add_u32 v245, v2, 8, v1
    v_lshl_add_u32 v249, v2, 9, v1
    v_lshrrev_b32 v1, 2, v253
    v_mul_u32_u24 v1, 1088, v1
    v_and_b32 v3, 3, v253
    v_lshl_add_u32 v1, v3, 8, v1
    v_and_b32 v4, 1, v254
    v_lshl_or_b32 v4, v4, 1, v2
    v_xor_b32 v4, v4, v3
    v_lshl_add_u32 v244, v4, 4, v1
    v_mov_b32 v216, 0x3f803f80
    v_mov_b32 v217, 0x3f803f80
    v_mov_b32 v218, 0x3f803f80
    v_mov_b32 v219, 0x3f803f80
    s_waitcnt lgkmcnt(0)
    s_mov_b32 s36, s18
    s_and_b32 s37, s19, 0xffff
    s_mov_b32 s38, 37748736
    s_mov_b32 s39, 0x00020000
    s_cmp_lg_u32 s44, 1
    s_cbranch_scc1 A_nocpf
    s_getpc_b64 s[48:49]
A_pc:
    s_lshr_b32 s46, s2, 3
    s_lshl_b32 s46, s46, 11
    v_lshl_add_u32 v1, v253, 7, s46
    v_min_u32 v1, A_hot_end-A_pc, v1
    s_mov_b64 exec, 0xffff
    global_load_dword v252, v1, s[48:49]
    s_mov_b64 exec, -1
A_nocpf:
    s_cmp_lg_u32 s44, 0
    s_cbranch_scc1 A_noclr
    s_lshl_b32 s46, s45, 11
    s_lshr_b32 s48, s50, 3
    s_and_b32 s49, s50, 7
    s_lshl_b32 s47, s48, 7
    s_add_u32 s46, s46, s47
    s_lshl_b32 s47, s49, 2
    s_add_u32 s46, s46, s47
    s_add_u32 s46, s46, 16777216
    s_lshl_b32 s47, s45, 3
    s_add_u32 s47, s47, s49
    s_lshl_b32 s47, s47, 9
    s_lshl_b32 s48, s48, 2
    s_add_u32 s47, s47, s48
    s_add_u32 s47, s47, 16793600
    v_lshlrev_b32 v1, 9, v255
    v_lshrrev_b32 v3, 1, v255
    v_lshlrev_b32 v3, 7, v3
    v_and_b32 v2, 1, v255
    v_lshl_add_u32 v3, v2, 4, v3
    v_mov_b32 v2, 0
    s_mov_b64 exec, 15
    buffer_store_dword v2, v1, s[36:39], s46 offen sc1
    s_mov_b64 exec, 255
    buffer_store_dword v2, v3, s[36:39], s47 offen sc1
    s_mov_b64 exec, -1
A_noclr:
    s_barrier
    ds_read_b128 v[96:99], v247 offset:45056
    ds_read_b128 v[100:103], v247 offset:47104
    ds_read_b128 v[104:107], v247 offset:49152
    ds_read_b64_tr_b16 v[168:169], v249 offset:33792
    ds_read_b64_tr_b16 v[170:171], v249 offset:34048
    ds_read_b128 v[108:111], v248 offset:45056
    ds_read_b128 v[112:115], v248 offset:47104
    ds_read_b128 v[116:119], v248 offset:49152
    ds_read_b64_tr_b16 v[172:173], v249 offset:42240
    ds_read_b64_tr_b16 v[174:175], v249 offset:42496
    ds_read_b64_tr_b16 v[176:177], v249 offset:33824
    ds_read_b64_tr_b16 v[178:179], v249 offset:34080
    ds_read_b64_tr_b16 v[180:181], v249 offset:42272
    ds_read_b64_tr_b16 v[182:183], v249 offset:42528
    s_waitcnt lgkmcnt(4)
    v_mfma_f32_16x16x32_bf16 v[0:3], v[168:171], v[96:99], 0
    v_mfma_f32_16x16x32_bf16 v[0:3], v[172:175], v[108:111], v[0:3]
    ds_read_b64_tr_b16 v[184:185], v249 offset:33856
    v_mfma_f32_16x16x32_bf16 v[4:7], v[168:171], v[100:103], 0
    ds_read_b64_tr_b16 v[186:187], v249 offset:34112
    v_mfma_f32_16x16x32_bf16 v[4:7], v[172:175], v[112:115], v[4:7]
    v_mfma_f32_16x16x32_bf16 v[8:11], v[168:171], v[104:107], 0
    ds_read_b64_tr_b16 v[188:189], v249 offset:42304
    v_mfma_f32_16x16x32_bf16 v[8:11], v[172:175], v[116:119], v[8:11]
    ds_read_b64_tr_b16 v[190:191], v249 offset:42560
    s_waitcnt lgkmcnt(4)
    v_mfma_f32_16x16x32_bf16 v[12:15], v[176:179], v[96:99], 0
    v_mfma_f32_16x16x32_bf16 v[12:15], v[180:183], v[108:111], v[12:15]
    ds_read_b64_tr_b16 v[192:193], v249 offset:33888
    v_mfma_f32_16x16x32_bf16 v[16:19], v[176:179], v[100:103], 0
    ds_read_b64_tr_b16 v[194:195], v249 offset:34144
    v_mfma_f32_16x16x32_bf16 v[16:19], v[180:183], v[112:115], v[16:19]
    ds_read_b64_tr_b16 v[196:197], v249 offset:42336
    v_mfma_f32_16x16x32_bf16 v[20:23], v[176:179], v[104:107], 0
    ds_read_b64_tr_b16 v[198:199], v249 offset:42592
    v_mfma_f32_16x16x32_bf16 v[20:23], v[180:183], v[116:119], v[20:23]
    ds_read_b64_tr_b16 v[200:201], v249 offset:33920
    s_waitcnt lgkmcnt(5)
    v_mfma_f32_16x16x32_bf16 v[24:27], v[184:187], v[96:99], 0
    v_mfma_f32_16x16x32_bf16 v[24:27], v[188:191], v[108:111], v[24:27]
    ds_read_b64_tr_b16 v[202:203], v249 offset:34176
    v_mfma_f32_16x16x32_bf16 v[28:31], v[184:187], v[100:103], 0
    ds_read_b64_tr_b16 v[204:205], v249 offset:42368
    v_mfma_f32_16x16x32_bf16 v[28:31], v[188:191], v[112:115], v[28:31]
    ds_read_b64_tr_b16 v[206:207], v249 offset:42624
    v_mfma_f32_16x16x32_bf16 v[32:35], v[184:187], v[104:107], 0
    ds_read_b64_tr_b16 v[208:209], v249 offset:33952
    v_mfma_f32_16x16x32_bf16 v[32:35], v[188:191], v[116:119], v[32:35]
    ds_read_b64_tr_b16 v[210:211], v249 offset:34208
    s_waitcnt lgkmcnt(6)
    v_mfma_f32_16x16x32_bf16 v[36:39], v[192:195], v[96:99], 0
    v_mfma_f32_16x16x32_bf16 v[36:39], v[196:199], v[108:111], v[36:39]
    ds_read_b64_tr_b16 v[212:213], v249 offset:42400
    v_mfma_f32_16x16x32_bf16 v[40:43], v[192:195], v[100:103], 0
    ds_read_b64_tr_b16 v[214:215], v249 offset:42656
    v_mfma_f32_16x16x32_bf16 v[40:43], v[196:199], v[112:115], v[40:43]
    ds_read_b64_tr_b16 v[168:169], v249 offset:33984
    v_mfma_f32_16x16x32_bf16 v[44:47], v[192:195], v[104:107], 0
    ds_read_b64_tr_b16 v[170:171], v249 offset:34240
    v_mfma_f32_16x16x32_bf16 v[44:47], v[196:199], v[116:119], v[44:47]
    ds_read_b64_tr_b16 v[172:173], v249 offset:42432
    s_waitcnt lgkmcnt(7)
    v_mfma_f32_16x16x32_bf16 v[48:51], v[200:203], v[96:99], 0
    v_mfma_f32_16x16x32_bf16 v[48:51], v[204:207], v[108:111], v[48:51]
    ds_read_b64_tr_b16 v[174:175], v249 offset:42688
    v_mfma_f32_16x16x32_bf16 v[52:55], v[200:203], v[100:103], 0
    ds_read_b64_tr_b16 v[176:177], v249 offset:34016
    v_mfma_f32_16x16x32_bf16 v[52:55], v[204:207], v[112:115], v[52:55]
    ds_read_b64_tr_b16 v[178:179], v249 offset:34272
    v_mfma_f32_16x16x32_bf16 v[56:59], v[200:203], v[104:107], 0
    ds_read_b64_tr_b16 v[180:181], v249 offset:42464
    v_mfma_f32_16x16x32_bf16 v[56:59], v[204:207], v[116:119], v[56:59]
    ds_read_b64_tr_b16 v[182:183], v249 offset:42720
    s_waitcnt lgkmcnt(8)
    v_mfma_f32_16x16x32_bf16 v[60:63], v[208:211], v[96:99], 0
    v_mfma_f32_16x16x32_bf16 v[60:63], v[212:215], v[108:111], v[60:63]
    v_mfma_f32_16x16x32_bf16 v[64:67], v[208:211], v[100:103], 0
    v_mfma_f32_16x16x32_bf16 v[64:67], v[212:215], v[112:115], v[64:67]
    v_mfma_f32_16x16x32_bf16 v[68:71], v[208:211], v[104:107], 0
    v_mfma_f32_16x16x32_bf16 v[68:71], v[212:215], v[116:119], v[68:71]
    s_waitcnt lgkmcnt(0)
    s_barrier
    v_mfma_f32_16x16x32_bf16 v[72:75], v[168:171], v[96:99], 0
    ds_read_b128 v[144:147], v250 offset:0
    v_mfma_f32_16x16x32_bf16 v[72:75], v[172:175], v[108:111], v[72:75]
    ds_read_b128 v[148:151], v250 offset:2048
    v_mfma_f32_16x16x32_bf16 v[76:79], v[168:171], v[100:103], 0
    ds_read_b128 v[152:155], v250 offset:4096
    v_mfma_f32_16x16x32_bf16 v[76:79], v[172:175], v[112:115], v[76:79]
    ds_read_b128 v[156:159], v251 offset:0
    v_mfma_f32_16x16x32_bf16 v[80:83], v[168:171], v[104:107], 0
    ds_read_b128 v[160:163], v251 offset:2048
    v_mfma_f32_16x16x32_bf16 v[80:83], v[172:175], v[116:119], v[80:83]
    ds_read_b128 v[164:167], v251 offset:4096
    ds_read_b64_tr_b16 v[184:185], v249 offset:50688
    v_mfma_f32_16x16x32_bf16 v[84:87], v[176:179], v[96:99], 0
    ds_read_b64_tr_b16 v[186:187], v249 offset:50944
    v_mfma_f32_16x16x32_bf16 v[84:87], v[180:183], v[108:111], v[84:87]
    ds_read_b64_tr_b16 v[188:189], v249 offset:59136
    v_mfma_f32_16x16x32_bf16 v[88:91], v[176:179], v[100:103], 0
    ds_read_b64_tr_b16 v[190:191], v249 offset:59392
    v_mfma_f32_16x16x32_bf16 v[88:91], v[180:183], v[112:115], v[88:91]
    ds_read_b64_tr_b16 v[192:193], v249 offset:50720
    v_mfma_f32_16x16x32_bf16 v[92:95], v[176:179], v[104:107], 0
    ds_read_b64_tr_b16 v[194:195], v249 offset:50976
    v_mfma_f32_16x16x32_bf16 v[92:95], v[180:183], v[116:119], v[92:95]
    ds_read_b64_tr_b16 v[196:197], v249 offset:59168
    ds_read_b64_tr_b16 v[198:199], v249 offset:59424
    s_waitcnt lgkmcnt(4)
    v_mfma_f32_16x16x32_bf16 v[0:3], v[184:187], v[144:147], v[0:3]
    v_mfma_f32_16x16x32_bf16 v[0:3], v[188:191], v[156:159], v[0:3]
    ds_read_b64_tr_b16 v[200:201], v249 offset:50752
    v_mfma_f32_16x16x32_bf16 v[4:7], v[184:187], v[148:151], v[4:7]
    ds_read_b64_tr_b16 v[202:203], v249 offset:51008
    v_mfma_f32_16x16x32_bf16 v[4:7], v[188:191], v[160:163], v[4:7]
    v_mfma_f32_16x16x32_bf16 v[8:11], v[184:187], v[152:155], v[8:11]
    ds_read_b64_tr_b16 v[204:205], v249 offset:59200
    v_mfma_f32_16x16x32_bf16 v[8:11], v[188:191], v[164:167], v[8:11]
    ds_read_b64_tr_b16 v[206:207], v249 offset:59456
    s_waitcnt lgkmcnt(4)
    v_mfma_f32_16x16x32_bf16 v[12:15], v[192:195], v[144:147], v[12:15]
    v_mfma_f32_16x16x32_bf16 v[12:15], v[196:199], v[156:159], v[12:15]
    ds_read_b64_tr_b16 v[208:209], v249 offset:50784
    v_mfma_f32_16x16x32_bf16 v[16:19], v[192:195], v[148:151], v[16:19]
    ds_read_b64_tr_b16 v[210:211], v249 offset:51040
    v_mfma_f32_16x16x32_bf16 v[16:19], v[196:199], v[160:163], v[16:19]
    ds_read_b64_tr_b16 v[212:213], v249 offset:59232
    v_mfma_f32_16x16x32_bf16 v[20:23], v[192:195], v[152:155], v[20:23]
    ds_read_b64_tr_b16 v[214:215], v249 offset:59488
    v_mfma_f32_16x16x32_bf16 v[20:23], v[196:199], v[164:167], v[20:23]
    ds_read_b64_tr_b16 v[168:169], v249 offset:50816
    s_waitcnt lgkmcnt(5)
    v_mfma_f32_16x16x32_bf16 v[24:27], v[200:203], v[144:147], v[24:27]
    v_mfma_f32_16x16x32_bf16 v[24:27], v[204:207], v[156:159], v[24:27]
    ds_read_b64_tr_b16 v[170:171], v249 offset:51072
    v_mfma_f32_16x16x32_bf16 v[28:31], v[200:203], v[148:151], v[28:31]
    ds_read_b64_tr_b16 v[172:173], v249 offset:59264
    v_mfma_f32_16x16x32_bf16 v[28:31], v[204:207], v[160:163], v[28:31]
    ds_read_b64_tr_b16 v[174:175], v249 offset:59520
    v_mfma_f32_16x16x32_bf16 v[32:35], v[200:203], v[152:155], v[32:35]
    ds_read_b64_tr_b16 v[176:177], v249 offset:50848
    v_mfma_f32_16x16x32_bf16 v[32:35], v[204:207], v[164:167], v[32:35]
    ds_read_b64_tr_b16 v[178:179], v249 offset:51104
    s_waitcnt lgkmcnt(6)
    v_mfma_f32_16x16x32_bf16 v[36:39], v[208:211], v[144:147], v[36:39]
    v_mfma_f32_16x16x32_bf16 v[36:39], v[212:215], v[156:159], v[36:39]
    ds_read_b64_tr_b16 v[180:181], v249 offset:59296
    v_mfma_f32_16x16x32_bf16 v[40:43], v[208:211], v[148:151], v[40:43]
    ds_read_b64_tr_b16 v[182:183], v249 offset:59552
    v_mfma_f32_16x16x32_bf16 v[40:43], v[212:215], v[160:163], v[40:43]
    ds_read_b64_tr_b16 v[184:185], v249 offset:50880
    v_mfma_f32_16x16x32_bf16 v[44:47], v[208:211], v[152:155], v[44:47]
    ds_read_b64_tr_b16 v[186:187], v249 offset:51136
    v_mfma_f32_16x16x32_bf16 v[44:47], v[212:215], v[164:167], v[44:47]
    ds_read_b64_tr_b16 v[188:189], v249 offset:59328
    s_waitcnt lgkmcnt(7)
    v_mfma_f32_16x16x32_bf16 v[48:51], v[168:171], v[144:147], v[48:51]
    v_mfma_f32_16x16x32_bf16 v[48:51], v[172:175], v[156:159], v[48:51]
    ds_read_b64_tr_b16 v[190:191], v249 offset:59584
    v_mfma_f32_16x16x32_bf16 v[52:55], v[168:171], v[148:151], v[52:55]
    ds_read_b64_tr_b16 v[192:193], v249 offset:50912
    v_mfma_f32_16x16x32_bf16 v[52:55], v[172:175], v[160:163], v[52:55]
    ds_read_b64_tr_b16 v[194:195], v249 offset:51168
    v_mfma_f32_16x16x32_bf16 v[56:59], v[168:171], v[152:155], v[56:59]
    ds_read_b64_tr_b16 v[196:197], v249 offset:59360
    v_mfma_f32_16x16x32_bf16 v[56:59], v[172:175], v[164:167], v[56:59]
    ds_read_b64_tr_b16 v[198:199], v249 offset:59616
    s_waitcnt lgkmcnt(8)
    v_mfma_f32_16x16x32_bf16 v[60:63], v[176:179], v[144:147], v[60:63]
    v_mfma_f32_16x16x32_bf16 v[60:63], v[180:183], v[156:159], v[60:63]
    v_mfma_f32_16x16x32_bf16 v[64:67], v[176:179], v[148:151], v[64:67]
    v_mfma_f32_16x16x32_bf16 v[64:67], v[180:183], v[160:163], v[64:67]
    v_mfma_f32_16x16x32_bf16 v[68:71], v[176:179], v[152:155], v[68:71]
    v_mfma_f32_16x16x32_bf16 v[68:71], v[180:183], v[164:167], v[68:71]
    s_waitcnt lgkmcnt(0)
    s_barrier
    v_mfma_f32_16x16x32_bf16 v[72:75], v[184:187], v[144:147], v[72:75]
    ds_read_b128 v[96:99], v247 offset:17408
    v_mfma_f32_16x16x32_bf16 v[72:75], v[188:191], v[156:159], v[72:75]
    ds_read_b128 v[100:103], v247 offset:19456
    v_mfma_f32_16x16x32_bf16 v[76:79], v[184:187], v[148:151], v[76:79]
    ds_read_b128 v[104:107], v247 offset:21504
    v_mfma_f32_16x16x32_bf16 v[76:79], v[188:191], v[160:163], v[76:79]
    ds_read_b128 v[108:111], v248 offset:17408
    v_mfma_f32_16x16x32_bf16 v[80:83], v[184:187], v[152:155], v[80:83]
    ds_read_b128 v[112:115], v248 offset:19456
    v_mfma_f32_16x16x32_bf16 v[80:83], v[188:191], v[164:167], v[80:83]
    ds_read_b128 v[116:119], v248 offset:21504
    ds_read_b64_tr_b16 v[200:201], v249 offset:16896
    v_mfma_f32_16x16x32_bf16 v[84:87], v[192:195], v[144:147], v[84:87]
    ds_read_b64_tr_b16 v[202:203], v249 offset:17152
    v_mfma_f32_16x16x32_bf16 v[84:87], v[196:199], v[156:159], v[84:87]
    ds_read_b64_tr_b16 v[204:205], v249 offset:25344
    v_mfma_f32_16x16x32_bf16 v[88:91], v[192:195], v[148:151], v[88:91]
    ds_read_b64_tr_b16 v[206:207], v249 offset:25600
    v_mfma_f32_16x16x32_bf16 v[88:91], v[196:199], v[160:163], v[88:91]
    ds_read_b64_tr_b16 v[208:209], v249 offset:16928
    v_mfma_f32_16x16x32_bf16 v[92:95], v[192:195], v[152:155], v[92:95]
    ds_read_b64_tr_b16 v[210:211], v249 offset:17184
    v_mfma_f32_16x16x32_bf16 v[92:95], v[196:199], v[164:167], v[92:95]
    ds_read_b64_tr_b16 v[212:213], v249 offset:25376
    ds_read_b64_tr_b16 v[214:215], v249 offset:25632
    s_waitcnt lgkmcnt(4)
    v_mfma_f32_16x16x32_bf16 v[0:3], v[200:203], v[96:99], v[0:3]
    v_mfma_f32_16x16x32_bf16 v[0:3], v[204:207], v[108:111], v[0:3]
    ds_read_b64_tr_b16 v[168:169], v249 offset:16960
    v_mfma_f32_16x16x32_bf16 v[4:7], v[200:203], v[100:103], v[4:7]
    ds_read_b64_tr_b16 v[170:171], v249 offset:17216
    v_mfma_f32_16x16x32_bf16 v[4:7], v[204:207], v[112:115], v[4:7]
    v_mfma_f32_16x16x32_bf16 v[8:11], v[200:203], v[104:107], v[8:11]
    ds_read_b64_tr_b16 v[172:173], v249 offset:25408
    v_mfma_f32_16x16x32_bf16 v[8:11], v[204:207], v[116:119], v[8:11]
    ds_read_b64_tr_b16 v[174:175], v249 offset:25664
    s_waitcnt lgkmcnt(4)
    v_mfma_f32_16x16x32_bf16 v[12:15], v[208:211], v[96:99], v[12:15]
    v_mfma_f32_16x16x32_bf16 v[12:15], v[212:215], v[108:111], v[12:15]
    ds_read_b64_tr_b16 v[176:177], v249 offset:16992
    v_mfma_f32_16x16x32_bf16 v[16:19], v[208:211], v[100:103], v[16:19]
    ds_read_b64_tr_b16 v[178:179], v249 offset:17248
    v_mfma_f32_16x16x32_bf16 v[16:19], v[212:215], v[112:115], v[16:19]
    ds_read_b64_tr_b16 v[180:181], v249 offset:25440
    v_mfma_f32_16x16x32_bf16 v[20:23], v[208:211], v[104:107], v[20:23]
    ds_read_b64_tr_b16 v[182:183], v249 offset:25696
    v_mfma_f32_16x16x32_bf16 v[20:23], v[212:215], v[116:119], v[20:23]
    ds_read_b64_tr_b16 v[184:185], v249 offset:17024
    s_waitcnt lgkmcnt(5)
    v_mfma_f32_16x16x32_bf16 v[24:27], v[168:171], v[96:99], v[24:27]
    v_mfma_f32_16x16x32_bf16 v[24:27], v[172:175], v[108:111], v[24:27]
    ds_read_b64_tr_b16 v[186:187], v249 offset:17280
    v_mfma_f32_16x16x32_bf16 v[28:31], v[168:171], v[100:103], v[28:31]
    ds_read_b64_tr_b16 v[188:189], v249 offset:25472
    v_mfma_f32_16x16x32_bf16 v[28:31], v[172:175], v[112:115], v[28:31]
    ds_read_b64_tr_b16 v[190:191], v249 offset:25728
    v_mfma_f32_16x16x32_bf16 v[32:35], v[168:171], v[104:107], v[32:35]
    ds_read_b64_tr_b16 v[192:193], v249 offset:17056
    v_mfma_f32_16x16x32_bf16 v[32:35], v[172:175], v[116:119], v[32:35]
    ds_read_b64_tr_b16 v[194:195], v249 offset:17312
    s_waitcnt lgkmcnt(6)
    v_mfma_f32_16x16x32_bf16 v[36:39], v[176:179], v[96:99], v[36:39]
    v_mfma_f32_16x16x32_bf16 v[36:39], v[180:183], v[108:111], v[36:39]
    ds_read_b64_tr_b16 v[196:197], v249 offset:25504
    v_mfma_f32_16x16x32_bf16 v[40:43], v[176:179], v[100:103], v[40:43]
    ds_read_b64_tr_b16 v[198:199], v249 offset:25760
    v_mfma_f32_16x16x32_bf16 v[40:43], v[180:183], v[112:115], v[40:43]
    ds_read_b64_tr_b16 v[200:201], v249 offset:17088
    v_mfma_f32_16x16x32_bf16 v[44:47], v[176:179], v[104:107], v[44:47]
    ds_read_b64_tr_b16 v[202:203], v249 offset:17344
    v_mfma_f32_16x16x32_bf16 v[44:47], v[180:183], v[116:119], v[44:47]
    ds_read_b64_tr_b16 v[204:205], v249 offset:25536
    s_waitcnt lgkmcnt(7)
    v_mfma_f32_16x16x32_bf16 v[48:51], v[184:187], v[96:99], v[48:51]
    v_mfma_f32_16x16x32_bf16 v[48:51], v[188:191], v[108:111], v[48:51]
    ds_read_b64_tr_b16 v[206:207], v249 offset:25792
    v_mfma_f32_16x16x32_bf16 v[52:55], v[184:187], v[100:103], v[52:55]
    ds_read_b64_tr_b16 v[208:209], v249 offset:17120
    v_mfma_f32_16x16x32_bf16 v[52:55], v[188:191], v[112:115], v[52:55]
    ds_read_b64_tr_b16 v[210:211], v249 offset:17376
    v_mfma_f32_16x16x32_bf16 v[56:59], v[184:187], v[104:107], v[56:59]
    ds_read_b64_tr_b16 v[212:213], v249 offset:25568
    v_mfma_f32_16x16x32_bf16 v[56:59], v[188:191], v[116:119], v[56:59]
    ds_read_b64_tr_b16 v[214:215], v249 offset:25824
    s_waitcnt lgkmcnt(8)
    v_mfma_f32_16x16x32_bf16 v[60:63], v[192:195], v[96:99], v[60:63]
    v_mfma_f32_16x16x32_bf16 v[60:63], v[196:199], v[108:111], v[60:63]
    v_mfma_f32_16x16x32_bf16 v[64:67], v[192:195], v[100:103], v[64:67]
    v_mfma_f32_16x16x32_bf16 v[64:67], v[196:199], v[112:115], v[64:67]
    v_mfma_f32_16x16x32_bf16 v[68:71], v[192:195], v[104:107], v[68:71]
    v_mfma_f32_16x16x32_bf16 v[68:71], v[196:199], v[116:119], v[68:71]
    s_waitcnt lgkmcnt(0)
    s_barrier
    v_mfma_f32_16x16x32_bf16 v[72:75], v[200:203], v[96:99], v[72:75]
    ds_read_b128 v[144:147], v247 offset:45056
    v_mfma_f32_16x16x32_bf16 v[72:75], v[204:207], v[108:111], v[72:75]
    ds_read_b128 v[148:151], v247 offset:47104
    v_mfma_f32_16x16x32_bf16 v[76:79], v[200:203], v[100:103], v[76:79]
    ds_read_b128 v[152:155], v247 offset:49152
    v_mfma_f32_16x16x32_bf16 v[76:79], v[204:207], v[112:115], v[76:79]
    ds_read_b128 v[156:159], v248 offset:45056
    v_mfma_f32_16x16x32_bf16 v[80:83], v[200:203], v[104:107], v[80:83]
    ds_read_b128 v[160:163], v248 offset:47104
    v_mfma_f32_16x16x32_bf16 v[80:83], v[204:207], v[116:119], v[80:83]
    ds_read_b128 v[164:167], v248 offset:49152
    ds_read_b64_tr_b16 v[168:169], v249 offset:33792
    v_mfma_f32_16x16x32_bf16 v[84:87], v[208:211], v[96:99], v[84:87]
    ds_read_b64_tr_b16 v[170:171], v249 offset:34048
    v_mfma_f32_16x16x32_bf16 v[84:87], v[212:215], v[108:111], v[84:87]
    ds_read_b64_tr_b16 v[172:173], v249 offset:42240
    v_mfma_f32_16x16x32_bf16 v[88:91], v[208:211], v[100:103], v[88:91]
    ds_read_b64_tr_b16 v[174:175], v249 offset:42496
    v_mfma_f32_16x16x32_bf16 v[88:91], v[212:215], v[112:115], v[88:91]
    ds_read_b64_tr_b16 v[176:177], v249 offset:33824
    v_mfma_f32_16x16x32_bf16 v[92:95], v[208:211], v[104:107], v[92:95]
    ds_read_b64_tr_b16 v[178:179], v249 offset:34080
    v_mfma_f32_16x16x32_bf16 v[92:95], v[212:215], v[116:119], v[92:95]
    ds_read_b64_tr_b16 v[180:181], v249 offset:42272
    ds_read_b64_tr_b16 v[182:183], v249 offset:42528
    s_waitcnt lgkmcnt(4)
    v_mfma_f32_16x16x32_bf16 v[0:3], v[168:171], v[144:147], v[0:3]
    v_mfma_f32_16x16x32_bf16 v[0:3], v[172:175], v[156:159], v[0:3]
    ds_read_b64_tr_b16 v[184:185], v249 offset:33856
    v_mfma_f32_16x16x32_bf16 v[4:7], v[168:171], v[148:151], v[4:7]
    ds_read_b64_tr_b16 v[186:187], v249 offset:34112
    v_mfma_f32_16x16x32_bf16 v[4:7], v[172:175], v[160:163], v[4:7]
    v_mfma_f32_16x16x32_bf16 v[8:11], v[168:171], v[152:155], v[8:11]
    ds_read_b64_tr_b16 v[188:189], v249 offset:42304
    v_mfma_f32_16x16x32_bf16 v[8:11], v[172:175], v[164:167], v[8:11]
    ds_read_b64_tr_b16 v[190:191], v249 offset:42560
    s_waitcnt lgkmcnt(4)
    v_mfma_f32_16x16x32_bf16 v[12:15], v[176:179], v[144:147], v[12:15]
    v_mfma_f32_16x16x32_bf16 v[12:15], v[180:183], v[156:159], v[12:15]
    ds_read_b64_tr_b16 v[192:193], v249 offset:33888
    v_mfma_f32_16x16x32_bf16 v[16:19], v[176:179], v[148:151], v[16:19]
    ds_read_b64_tr_b16 v[194:195], v249 offset:34144
    v_mfma_f32_16x16x32_bf16 v[16:19], v[180:183], v[160:163], v[16:19]
    ds_read_b64_tr_b16 v[196:197], v249 offset:42336
    v_mfma_f32_16x16x32_bf16 v[20:23], v[176:179], v[152:155], v[20:23]
    ds_read_b64_tr_b16 v[198:199], v249 offset:42592
    v_mfma_f32_16x16x32_bf16 v[20:23], v[180:183], v[164:167], v[20:23]
    ds_read_b64_tr_b16 v[200:201], v249 offset:33920
    s_waitcnt lgkmcnt(5)
    v_mfma_f32_16x16x32_bf16 v[24:27], v[184:187], v[144:147], v[24:27]
    v_mfma_f32_16x16x32_bf16 v[24:27], v[188:191], v[156:159], v[24:27]
    ds_read_b64_tr_b16 v[202:203], v249 offset:34176
    v_mfma_f32_16x16x32_bf16 v[28:31], v[184:187], v[148:151], v[28:31]
    ds_read_b64_tr_b16 v[204:205], v249 offset:42368
    v_mfma_f32_16x16x32_bf16 v[28:31], v[188:191], v[160:163], v[28:31]
    ds_read_b64_tr_b16 v[206:207], v249 offset:42624
    v_mfma_f32_16x16x32_bf16 v[32:35], v[184:187], v[152:155], v[32:35]
    ds_read_b64_tr_b16 v[208:209], v249 offset:33952
    v_mfma_f32_16x16x32_bf16 v[32:35], v[188:191], v[164:167], v[32:35]
    ds_read_b64_tr_b16 v[210:211], v249 offset:34208
    s_waitcnt lgkmcnt(6)
    v_mfma_f32_16x16x32_bf16 v[36:39], v[192:195], v[144:147], v[36:39]
    v_mfma_f32_16x16x32_bf16 v[36:39], v[196:199], v[156:159], v[36:39]
    ds_read_b64_tr_b16 v[212:213], v249 offset:42400
    v_mfma_f32_16x16x32_bf16 v[40:43], v[192:195], v[148:151], v[40:43]
    ds_read_b64_tr_b16 v[214:215], v249 offset:42656
    v_mfma_f32_16x16x32_bf16 v[40:43], v[196:199], v[160:163], v[40:43]
    ds_read_b64_tr_b16 v[168:169], v249 offset:33984
    v_mfma_f32_16x16x32_bf16 v[44:47], v[192:195], v[152:155], v[44:47]
    ds_read_b64_tr_b16 v[170:171], v249 offset:34240
    v_mfma_f32_16x16x32_bf16 v[44:47], v[196:199], v[164:167], v[44:47]
    ds_read_b64_tr_b16 v[172:173], v249 offset:42432
    s_waitcnt lgkmcnt(7)
    v_mfma_f32_16x16x32_bf16 v[48:51], v[200:203], v[144:147], v[48:51]
    v_mfma_f32_16x16x32_bf16 v[48:51], v[204:207], v[156:159], v[48:51]
    ds_read_b64_tr_b16 v[174:175], v249 offset:42688
    v_mfma_f32_16x16x32_bf16 v[52:55], v[200:203], v[148:151], v[52:55]
    ds_read_b64_tr_b16 v[176:177], v249 offset:34016
    v_mfma_f32_16x16x32_bf16 v[52:55], v[204:207], v[160:163], v[52:55]
    ds_read_b64_tr_b16 v[178:179], v249 offset:34272
    v_mfma_f32_16x16x32_bf16 v[56:59], v[200:203], v[152:155], v[56:59]
    ds_read_b64_tr_b16 v[180:181], v249 offset:42464
    v_mfma_f32_16x16x32_bf16 v[56:59], v[204:207], v[164:167], v[56:59]
    ds_read_b64_tr_b16 v[182:183], v249 offset:42720
    s_waitcnt lgkmcnt(8)
    v_mfma_f32_16x16x32_bf16 v[60:63], v[208:211], v[144:147], v[60:63]
    v_mfma_f32_16x16x32_bf16 v[60:63], v[212:215], v[156:159], v[60:63]
    v_mfma_f32_16x16x32_bf16 v[64:67], v[208:211], v[148:151], v[64:67]
    v_mfma_f32_16x16x32_bf16 v[64:67], v[212:215], v[160:163], v[64:67]
    v_mfma_f32_16x16x32_bf16 v[68:71], v[208:211], v[152:155], v[68:71]
    v_mfma_f32_16x16x32_bf16 v[68:71], v[212:215], v[164:167], v[68:71]
    s_waitcnt lgkmcnt(0)
    s_barrier
    v_mfma_f32_16x16x32_bf16 v[72:75], v[168:171], v[144:147], v[72:75]
    ds_read_b128 v[96:99], v250 offset:0
    v_mfma_f32_16x16x32_bf16 v[72:75], v[172:175], v[156:159], v[72:75]
    ds_read_b128 v[100:103], v250 offset:2048
    v_mfma_f32_16x16x32_bf16 v[76:79], v[168:171], v[148:151], v[76:79]
    ds_read_b128 v[104:107], v250 offset:4096
    v_mfma_f32_16x16x32_bf16 v[76:79], v[172:175], v[160:163], v[76:79]
    ds_read_b128 v[108:111], v251 offset:0
    v_mfma_f32_16x16x32_bf16 v[80:83], v[168:171], v[152:155], v[80:83]
    ds_read_b128 v[112:115], v251 offset:2048
    v_mfma_f32_16x16x32_bf16 v[80:83], v[172:175], v[164:167], v[80:83]
    ds_read_b128 v[116:119], v251 offset:4096
    ds_read_b64_tr_b16 v[184:185], v249 offset:50688
    v_mfma_f32_16x16x32_bf16 v[84:87], v[176:179], v[144:147], v[84:87]
    ds_read_b64_tr_b16 v[186:187], v249 offset:50944
    v_mfma_f32_16x16x32_bf16 v[84:87], v[180:183], v[156:159], v[84:87]
    ds_read_b64_tr_b16 v[188:189], v249 offset:59136
    v_mfma_f32_16x16x32_bf16 v[88:91], v[176:179], v[148:151], v[88:91]
    ds_read_b64_tr_b16 v[190:191], v249 offset:59392
    v_mfma_f32_16x16x32_bf16 v[88:91], v[180:183], v[160:163], v[88:91]
    ds_read_b64_tr_b16 v[192:193], v249 offset:50720
    v_mfma_f32_16x16x32_bf16 v[92:95], v[176:179], v[152:155], v[92:95]
    ds_read_b64_tr_b16 v[194:195], v249 offset:50976
    v_mfma_f32_16x16x32_bf16 v[92:95], v[180:183], v[164:167], v[92:95]
    ds_read_b64_tr_b16 v[196:197], v249 offset:59168
    ds_read_b64_tr_b16 v[198:199], v249 offset:59424
    s_waitcnt lgkmcnt(4)
    v_mfma_f32_16x16x32_bf16 v[0:3], v[184:187], v[96:99], v[0:3]
    v_mfma_f32_16x16x32_bf16 v[0:3], v[188:191], v[108:111], v[0:3]
    ds_read_b64_tr_b16 v[200:201], v249 offset:50752
    v_mfma_f32_16x16x32_bf16 v[4:7], v[184:187], v[100:103], v[4:7]
    ds_read_b64_tr_b16 v[202:203], v249 offset:51008
    v_mfma_f32_16x16x32_bf16 v[4:7], v[188:191], v[112:115], v[4:7]
    v_mfma_f32_16x16x32_bf16 v[8:11], v[184:187], v[104:107], v[8:11]
    ds_read_b64_tr_b16 v[204:205], v249 offset:59200
    v_mfma_f32_16x16x32_bf16 v[8:11], v[188:191], v[116:119], v[8:11]
    ds_read_b64_tr_b16 v[206:207], v249 offset:59456
    s_waitcnt lgkmcnt(4)
    v_mfma_f32_16x16x32_bf16 v[12:15], v[192:195], v[96:99], v[12:15]
    v_mfma_f32_16x16x32_bf16 v[12:15], v[196:199], v[108:111], v[12:15]
    ds_read_b64_tr_b16 v[208:209], v249 offset:50784
    v_mfma_f32_16x16x32_bf16 v[16:19], v[192:195], v[100:103], v[16:19]
    ds_read_b64_tr_b16 v[210:211], v249 offset:51040
    v_mfma_f32_16x16x32_bf16 v[16:19], v[196:199], v[112:115], v[16:19]
    ds_read_b64_tr_b16 v[212:213], v249 offset:59232
    v_mfma_f32_16x16x32_bf16 v[20:23], v[192:195], v[104:107], v[20:23]
    ds_read_b64_tr_b16 v[214:215], v249 offset:59488
    v_mfma_f32_16x16x32_bf16 v[20:23], v[196:199], v[116:119], v[20:23]
    ds_read_b64_tr_b16 v[168:169], v249 offset:50816
    s_waitcnt lgkmcnt(5)
    v_mfma_f32_16x16x32_bf16 v[24:27], v[200:203], v[96:99], v[24:27]
    v_mfma_f32_16x16x32_bf16 v[24:27], v[204:207], v[108:111], v[24:27]
    ds_read_b64_tr_b16 v[170:171], v249 offset:51072
    v_mfma_f32_16x16x32_bf16 v[28:31], v[200:203], v[100:103], v[28:31]
    ds_read_b64_tr_b16 v[172:173], v249 offset:59264
    v_mfma_f32_16x16x32_bf16 v[28:31], v[204:207], v[112:115], v[28:31]
    ds_read_b64_tr_b16 v[174:175], v249 offset:59520
    v_mfma_f32_16x16x32_bf16 v[32:35], v[200:203], v[104:107], v[32:35]
    ds_read_b64_tr_b16 v[176:177], v249 offset:50848
    v_mfma_f32_16x16x32_bf16 v[32:35], v[204:207], v[116:119], v[32:35]
    ds_read_b64_tr_b16 v[178:179], v249 offset:51104
    s_waitcnt lgkmcnt(6)
    v_mfma_f32_16x16x32_bf16 v[36:39], v[208:211], v[96:99], v[36:39]
    v_mfma_f32_16x16x32_bf16 v[36:39], v[212:215], v[108:111], v[36:39]
    ds_read_b64_tr_b16 v[180:181], v249 offset:59296
    v_mfma_f32_16x16x32_bf16 v[40:43], v[208:211], v[100:103], v[40:43]
    ds_read_b64_tr_b16 v[182:183], v249 offset:59552
    v_mfma_f32_16x16x32_bf16 v[40:43], v[212:215], v[112:115], v[40:43]
    ds_read_b64_tr_b16 v[184:185], v249 offset:50880
    v_mfma_f32_16x16x32_bf16 v[44:47], v[208:211], v[104:107], v[44:47]
    ds_read_b64_tr_b16 v[186:187], v249 offset:51136
    v_mfma_f32_16x16x32_bf16 v[44:47], v[212:215], v[116:119], v[44:47]
    ds_read_b64_tr_b16 v[188:189], v249 offset:59328
    s_waitcnt lgkmcnt(7)
    v_mfma_f32_16x16x32_bf16 v[48:51], v[168:171], v[96:99], v[48:51]
    v_mfma_f32_16x16x32_bf16 v[48:51], v[172:175], v[108:111], v[48:51]
    ds_read_b64_tr_b16 v[190:191], v249 offset:59584
    v_mfma_f32_16x16x32_bf16 v[52:55], v[168:171], v[100:103], v[52:55]
    ds_read_b64_tr_b16 v[192:193], v249 offset:50912
    v_mfma_f32_16x16x32_bf16 v[52:55], v[172:175], v[112:115], v[52:55]
    ds_read_b64_tr_b16 v[194:195], v249 offset:51168
    v_mfma_f32_16x16x32_bf16 v[56:59], v[168:171], v[104:107], v[56:59]
    ds_read_b64_tr_b16 v[196:197], v249 offset:59360
    v_mfma_f32_16x16x32_bf16 v[56:59], v[172:175], v[116:119], v[56:59]
    ds_read_b64_tr_b16 v[198:199], v249 offset:59616
    s_waitcnt lgkmcnt(8)
    v_mfma_f32_16x16x32_bf16 v[60:63], v[176:179], v[96:99], v[60:63]
    v_mfma_f32_16x16x32_bf16 v[60:63], v[180:183], v[108:111], v[60:63]
    v_mfma_f32_16x16x32_bf16 v[64:67], v[176:179], v[100:103], v[64:67]
    v_mfma_f32_16x16x32_bf16 v[64:67], v[180:183], v[112:115], v[64:67]
    v_mfma_f32_16x16x32_bf16 v[68:71], v[176:179], v[104:107], v[68:71]
    v_mfma_f32_16x16x32_bf16 v[68:71], v[180:183], v[116:119], v[68:71]
    s_waitcnt lgkmcnt(0)
    s_barrier
    v_mfma_f32_16x16x32_bf16 v[72:75], v[184:187], v[96:99], v[72:75]
    ds_read_b128 v[144:147], v247 offset:17408
    v_mfma_f32_16x16x32_bf16 v[72:75], v[188:191], v[108:111], v[72:75]
    ds_read_b128 v[148:151], v247 offset:19456
    v_mfma_f32_16x16x32_bf16 v[76:79], v[184:187], v[100:103], v[76:79]
    ds_read_b128 v[152:155], v247 offset:21504
    v_mfma_f32_16x16x32_bf16 v[76:79], v[188:191], v[112:115], v[76:79]
    ds_read_b128 v[156:159], v248 offset:17408
    v_mfma_f32_16x16x32_bf16 v[80:83], v[184:187], v[104:107], v[80:83]
    ds_read_b128 v[160:163], v248 offset:19456
    v_mfma_f32_16x16x32_bf16 v[80:83], v[188:191], v[116:119], v[80:83]
    ds_read_b128 v[164:167], v248 offset:21504
    ds_read_b64_tr_b16 v[200:201], v249 offset:16896
    v_mfma_f32_16x16x32_bf16 v[84:87], v[192:195], v[96:99], v[84:87]
    ds_read_b64_tr_b16 v[202:203], v249 offset:17152
    v_mfma_f32_16x16x32_bf16 v[84:87], v[196:199], v[108:111], v[84:87]
    ds_read_b64_tr_b16 v[204:205], v249 offset:25344
    v_mfma_f32_16x16x32_bf16 v[88:91], v[192:195], v[100:103], v[88:91]
    ds_read_b64_tr_b16 v[206:207], v249 offset:25600
    v_mfma_f32_16x16x32_bf16 v[88:91], v[196:199], v[112:115], v[88:91]
    ds_read_b64_tr_b16 v[208:209], v249 offset:16928
    v_mfma_f32_16x16x32_bf16 v[92:95], v[192:195], v[104:107], v[92:95]
    ds_read_b64_tr_b16 v[210:211], v249 offset:17184
    v_mfma_f32_16x16x32_bf16 v[92:95], v[196:199], v[116:119], v[92:95]
    ds_read_b64_tr_b16 v[212:213], v249 offset:25376
    ds_read_b64_tr_b16 v[214:215], v249 offset:25632
    s_waitcnt lgkmcnt(4)
    v_mfma_f32_16x16x32_bf16 v[0:3], v[200:203], v[144:147], v[0:3]
    v_mfma_f32_16x16x32_bf16 v[0:3], v[204:207], v[156:159], v[0:3]
    ds_read_b64_tr_b16 v[168:169], v249 offset:16960
    v_mfma_f32_16x16x32_bf16 v[4:7], v[200:203], v[148:151], v[4:7]
    ds_read_b64_tr_b16 v[170:171], v249 offset:17216
    v_mfma_f32_16x16x32_bf16 v[4:7], v[204:207], v[160:163], v[4:7]
    v_mfma_f32_16x16x32_bf16 v[8:11], v[200:203], v[152:155], v[8:11]
    ds_read_b64_tr_b16 v[172:173], v249 offset:25408
    v_mfma_f32_16x16x32_bf16 v[8:11], v[204:207], v[164:167], v[8:11]
    ds_read_b64_tr_b16 v[174:175], v249 offset:25664
    s_waitcnt lgkmcnt(4)
    v_mfma_f32_16x16x32_bf16 v[12:15], v[208:211], v[144:147], v[12:15]
    v_mfma_f32_16x16x32_bf16 v[12:15], v[212:215], v[156:159], v[12:15]
    ds_read_b64_tr_b16 v[176:177], v249 offset:16992
    v_mfma_f32_16x16x32_bf16 v[16:19], v[208:211], v[148:151], v[16:19]
    ds_read_b64_tr_b16 v[178:179], v249 offset:17248
    v_mfma_f32_16x16x32_bf16 v[16:19], v[212:215], v[160:163], v[16:19]
    ds_read_b64_tr_b16 v[180:181], v249 offset:25440
    v_mfma_f32_16x16x32_bf16 v[20:23], v[208:211], v[152:155], v[20:23]
    ds_read_b64_tr_b16 v[182:183], v249 offset:25696
    v_mfma_f32_16x16x32_bf16 v[20:23], v[212:215], v[164:167], v[20:23]
    ds_read_b64_tr_b16 v[184:185], v249 offset:17024
    s_waitcnt lgkmcnt(5)
    v_mfma_f32_16x16x32_bf16 v[24:27], v[168:171], v[144:147], v[24:27]
    v_mfma_f32_16x16x32_bf16 v[24:27], v[172:175], v[156:159], v[24:27]
    ds_read_b64_tr_b16 v[186:187], v249 offset:17280
    v_mfma_f32_16x16x32_bf16 v[28:31], v[168:171], v[148:151], v[28:31]
    ds_read_b64_tr_b16 v[188:189], v249 offset:25472
    v_mfma_f32_16x16x32_bf16 v[28:31], v[172:175], v[160:163], v[28:31]
    ds_read_b64_tr_b16 v[190:191], v249 offset:25728
    v_mfma_f32_16x16x32_bf16 v[32:35], v[168:171], v[152:155], v[32:35]
    ds_read_b64_tr_b16 v[192:193], v249 offset:17056
    v_mfma_f32_16x16x32_bf16 v[32:35], v[172:175], v[164:167], v[32:35]
    ds_read_b64_tr_b16 v[194:195], v249 offset:17312
    s_waitcnt lgkmcnt(6)
    v_mfma_f32_16x16x32_bf16 v[36:39], v[176:179], v[144:147], v[36:39]
    v_mfma_f32_16x16x32_bf16 v[36:39], v[180:183], v[156:159], v[36:39]
    ds_read_b64_tr_b16 v[196:197], v249 offset:25504
    v_mfma_f32_16x16x32_bf16 v[40:43], v[176:179], v[148:151], v[40:43]
    ds_read_b64_tr_b16 v[198:199], v249 offset:25760
    v_mfma_f32_16x16x32_bf16 v[40:43], v[180:183], v[160:163], v[40:43]
    ds_read_b64_tr_b16 v[200:201], v249 offset:17088
    v_mfma_f32_16x16x32_bf16 v[44:47], v[176:179], v[152:155], v[44:47]
    ds_read_b64_tr_b16 v[202:203], v249 offset:17344
    v_mfma_f32_16x16x32_bf16 v[44:47], v[180:183], v[164:167], v[44:47]
    ds_read_b64_tr_b16 v[204:205], v249 offset:25536
    s_waitcnt lgkmcnt(7)
    v_mfma_f32_16x16x32_bf16 v[48:51], v[184:187], v[144:147], v[48:51]
    v_mfma_f32_16x16x32_bf16 v[48:51], v[188:191], v[156:159], v[48:51]
    ds_read_b64_tr_b16 v[206:207], v249 offset:25792
    v_mfma_f32_16x16x32_bf16 v[52:55], v[184:187], v[148:151], v[52:55]
    ds_read_b64_tr_b16 v[208:209], v249 offset:17120
    v_mfma_f32_16x16x32_bf16 v[52:55], v[188:191], v[160:163], v[52:55]
    ds_read_b64_tr_b16 v[210:211], v249 offset:17376
    v_mfma_f32_16x16x32_bf16 v[56:59], v[184:187], v[152:155], v[56:59]
    ds_read_b64_tr_b16 v[212:213], v249 offset:25568
    v_mfma_f32_16x16x32_bf16 v[56:59], v[188:191], v[164:167], v[56:59]
    ds_read_b64_tr_b16 v[214:215], v249 offset:25824
    s_waitcnt lgkmcnt(8)
    v_mfma_f32_16x16x32_bf16 v[60:63], v[192:195], v[144:147], v[60:63]
    v_mfma_f32_16x16x32_bf16 v[60:63], v[196:199], v[156:159], v[60:63]
    v_mfma_f32_16x16x32_bf16 v[64:67], v[192:195], v[148:151], v[64:67]
    v_mfma_f32_16x16x32_bf16 v[64:67], v[196:199], v[160:163], v[64:67]
    v_mfma_f32_16x16x32_bf16 v[68:71], v[192:195], v[152:155], v[68:71]
    v_mfma_f32_16x16x32_bf16 v[68:71], v[196:199], v[164:167], v[68:71]
    s_waitcnt lgkmcnt(0)
    s_barrier
    v_mfma_f32_16x16x32_bf16 v[72:75], v[200:203], v[144:147], v[72:75]
    ds_read_b128 v[96:99], v247 offset:45056
    v_mfma_f32_16x16x32_bf16 v[72:75], v[204:207], v[156:159], v[72:75]
    ds_read_b128 v[100:103], v247 offset:47104
    v_mfma_f32_16x16x32_bf16 v[76:79], v[200:203], v[148:151], v[76:79]
    ds_read_b128 v[104:107], v247 offset:49152
    v_mfma_f32_16x16x32_bf16 v[76:79], v[204:207], v[160:163], v[76:79]
    ds_read_b128 v[108:111], v248 offset:45056
    v_mfma_f32_16x16x32_bf16 v[80:83], v[200:203], v[152:155], v[80:83]
    ds_read_b128 v[112:115], v248 offset:47104
    v_mfma_f32_16x16x32_bf16 v[80:83], v[204:207], v[164:167], v[80:83]
    ds_read_b128 v[116:119], v248 offset:49152
    ds_read_b64_tr_b16 v[168:169], v249 offset:33792
    v_mfma_f32_16x16x32_bf16 v[84:87], v[208:211], v[144:147], v[84:87]
    ds_read_b64_tr_b16 v[170:171], v249 offset:34048
    v_mfma_f32_16x16x32_bf16 v[84:87], v[212:215], v[156:159], v[84:87]
    ds_read_b64_tr_b16 v[172:173], v249 offset:42240
    v_mfma_f32_16x16x32_bf16 v[88:91], v[208:211], v[148:151], v[88:91]
    ds_read_b64_tr_b16 v[174:175], v249 offset:42496
    v_mfma_f32_16x16x32_bf16 v[88:91], v[212:215], v[160:163], v[88:91]
    ds_read_b64_tr_b16 v[176:177], v249 offset:33824
    v_mfma_f32_16x16x32_bf16 v[92:95], v[208:211], v[152:155], v[92:95]
    ds_read_b64_tr_b16 v[178:179], v249 offset:34080
    v_mfma_f32_16x16x32_bf16 v[92:95], v[212:215], v[164:167], v[92:95]
    ds_read_b64_tr_b16 v[180:181], v249 offset:42272
    ds_read_b64_tr_b16 v[182:183], v249 offset:42528
    s_waitcnt lgkmcnt(4)
    v_mfma_f32_16x16x32_bf16 v[0:3], v[168:171], v[96:99], v[0:3]
    v_mfma_f32_16x16x32_bf16 v[0:3], v[172:175], v[108:111], v[0:3]
    ds_read_b64_tr_b16 v[184:185], v249 offset:33856
    v_mfma_f32_16x16x32_bf16 v[4:7], v[168:171], v[100:103], v[4:7]
    ds_read_b64_tr_b16 v[186:187], v249 offset:34112
    v_mfma_f32_16x16x32_bf16 v[4:7], v[172:175], v[112:115], v[4:7]
    v_mfma_f32_16x16x32_bf16 v[8:11], v[168:171], v[104:107], v[8:11]
    ds_read_b64_tr_b16 v[188:189], v249 offset:42304
    v_mfma_f32_16x16x32_bf16 v[8:11], v[172:175], v[116:119], v[8:11]
    ds_read_b64_tr_b16 v[190:191], v249 offset:42560
    s_waitcnt lgkmcnt(4)
    v_mfma_f32_16x16x32_bf16 v[12:15], v[176:179], v[96:99], v[12:15]
    v_mfma_f32_16x16x32_bf16 v[12:15], v[180:183], v[108:111], v[12:15]
    ds_read_b64_tr_b16 v[192:193], v249 offset:33888
    v_mfma_f32_16x16x32_bf16 v[16:19], v[176:179], v[100:103], v[16:19]
    ds_read_b64_tr_b16 v[194:195], v249 offset:34144
    v_mfma_f32_16x16x32_bf16 v[16:19], v[180:183], v[112:115], v[16:19]
    ds_read_b64_tr_b16 v[196:197], v249 offset:42336
    v_mfma_f32_16x16x32_bf16 v[20:23], v[176:179], v[104:107], v[20:23]
    ds_read_b64_tr_b16 v[198:199], v249 offset:42592
    v_mfma_f32_16x16x32_bf16 v[20:23], v[180:183], v[116:119], v[20:23]
    ds_read_b64_tr_b16 v[200:201], v249 offset:33920
    s_waitcnt lgkmcnt(5)
    v_mfma_f32_16x16x32_bf16 v[24:27], v[184:187], v[96:99], v[24:27]
    v_mfma_f32_16x16x32_bf16 v[24:27], v[188:191], v[108:111], v[24:27]
    ds_read_b64_tr_b16 v[202:203], v249 offset:34176
    v_mfma_f32_16x16x32_bf16 v[28:31], v[184:187], v[100:103], v[28:31]
    ds_read_b64_tr_b16 v[204:205], v249 offset:42368
    v_mfma_f32_16x16x32_bf16 v[28:31], v[188:191], v[112:115], v[28:31]
    ds_read_b64_tr_b16 v[206:207], v249 offset:42624
    v_mfma_f32_16x16x32_bf16 v[32:35], v[184:187], v[104:107], v[32:35]
    ds_read_b64_tr_b16 v[208:209], v249 offset:33952
    v_mfma_f32_16x16x32_bf16 v[32:35], v[188:191], v[116:119], v[32:35]
    ds_read_b64_tr_b16 v[210:211], v249 offset:34208
    s_waitcnt lgkmcnt(6)
    v_mfma_f32_16x16x32_bf16 v[36:39], v[192:195], v[96:99], v[36:39]
    v_mfma_f32_16x16x32_bf16 v[36:39], v[196:199], v[108:111], v[36:39]
    ds_read_b64_tr_b16 v[212:213], v249 offset:42400
    v_mfma_f32_16x16x32_bf16 v[40:43], v[192:195], v[100:103], v[40:43]
    ds_read_b64_tr_b16 v[214:215], v249 offset:42656
    v_mfma_f32_16x16x32_bf16 v[40:43], v[196:199], v[112:115], v[40:43]
    ds_read_b64_tr_b16 v[168:169], v249 offset:33984
    v_mfma_f32_16x16x32_bf16 v[44:47], v[192:195], v[104:107], v[44:47]
    ds_read_b64_tr_b16 v[170:171], v249 offset:34240
    v_mfma_f32_16x16x32_bf16 v[44:47], v[196:199], v[116:119], v[44:47]
    ds_read_b64_tr_b16 v[172:173], v249 offset:42432
    s_waitcnt lgkmcnt(7)
    v_mfma_f32_16x16x32_bf16 v[48:51], v[200:203], v[96:99], v[48:51]
    v_mfma_f32_16x16x32_bf16 v[48:51], v[204:207], v[108:111], v[48:51]
    ds_read_b64_tr_b16 v[174:175], v249 offset:42688
    v_mfma_f32_16x16x32_bf16 v[52:55], v[200:203], v[100:103], v[52:55]
    ds_read_b64_tr_b16 v[176:177], v249 offset:34016
    v_mfma_f32_16x16x32_bf16 v[52:55], v[204:207], v[112:115], v[52:55]
    ds_read_b64_tr_b16 v[178:179], v249 offset:34272
    v_mfma_f32_16x16x32_bf16 v[56:59], v[200:203], v[104:107], v[56:59]
    ds_read_b64_tr_b16 v[180:181], v249 offset:42464
    v_mfma_f32_16x16x32_bf16 v[56:59], v[204:207], v[116:119], v[56:59]
    ds_read_b64_tr_b16 v[182:183], v249 offset:42720
    s_waitcnt lgkmcnt(8)
    v_mfma_f32_16x16x32_bf16 v[60:63], v[208:211], v[96:99], v[60:63]
    v_mfma_f32_16x16x32_bf16 v[60:63], v[212:215], v[108:111], v[60:63]
    v_mfma_f32_16x16x32_bf16 v[64:67], v[208:211], v[100:103], v[64:67]
    v_mfma_f32_16x16x32_bf16 v[64:67], v[212:215], v[112:115], v[64:67]
    v_mfma_f32_16x16x32_bf16 v[68:71], v[208:211], v[104:107], v[68:71]
    v_mfma_f32_16x16x32_bf16 v[68:71], v[212:215], v[116:119], v[68:71]
    s_waitcnt lgkmcnt(0)
    s_barrier
    v_mfma_f32_16x16x32_bf16 v[72:75], v[168:171], v[96:99], v[72:75]
    ds_read_b128 v[144:147], v250 offset:0
    v_mfma_f32_16x16x32_bf16 v[72:75], v[172:175], v[108:111], v[72:75]
    ds_read_b128 v[148:151], v250 offset:2048
    v_mfma_f32_16x16x32_bf16 v[76:79], v[168:171], v[100:103], v[76:79]
    ds_read_b128 v[152:155], v250 offset:4096
    v_mfma_f32_16x16x32_bf16 v[76:79], v[172:175], v[112:115], v[76:79]
    ds_read_b128 v[156:159], v251 offset:0
    v_mfma_f32_16x16x32_bf16 v[80:83], v[168:171], v[104:107], v[80:83]
    ds_read_b128 v[160:163], v251 offset:2048
    v_mfma_f32_16x16x32_bf16 v[80:83], v[172:175], v[116:119], v[80:83]
    ds_read_b128 v[164:167], v251 offset:4096
    ds_read_b64_tr_b16 v[184:185], v249 offset:50688
    v_mfma_f32_16x16x32_bf16 v[84:87], v[176:179], v[96:99], v[84:87]
    ds_read_b64_tr_b16 v[186:187], v249 offset:50944
    v_mfma_f32_16x16x32_bf16 v[84:87], v[180:183], v[108:111], v[84:87]
    ds_read_b64_tr_b16 v[188:189], v249 offset:59136
    v_mfma_f32_16x16x32_bf16 v[88:91], v[176:179], v[100:103], v[88:91]
    ds_read_b64_tr_b16 v[190:191], v249 offset:59392
    v_mfma_f32_16x16x32_bf16 v[88:91], v[180:183], v[112:115], v[88:91]
    ds_read_b64_tr_b16 v[192:193], v249 offset:50720
    v_mfma_f32_16x16x32_bf16 v[92:95], v[176:179], v[104:107], v[92:95]
    ds_read_b64_tr_b16 v[194:195], v249 offset:50976
    v_mfma_f32_16x16x32_bf16 v[92:95], v[180:183], v[116:119], v[92:95]
    ds_read_b64_tr_b16 v[196:197], v249 offset:59168
    ds_read_b64_tr_b16 v[198:199], v249 offset:59424
    s_waitcnt lgkmcnt(4)
    v_mfma_f32_16x16x32_bf16 v[0:3], v[184:187], v[144:147], v[0:3]
    v_mfma_f32_16x16x32_bf16 v[0:3], v[188:191], v[156:159], v[0:3]
    ds_read_b64_tr_b16 v[200:201], v249 offset:50752
    v_mfma_f32_16x16x32_bf16 v[4:7], v[184:187], v[148:151], v[4:7]
    ds_read_b64_tr_b16 v[202:203], v249 offset:51008
    v_mfma_f32_16x16x32_bf16 v[4:7], v[188:191], v[160:163], v[4:7]
    v_mfma_f32_16x16x32_bf16 v[8:11], v[184:187], v[152:155], v[8:11]
    ds_read_b64_tr_b16 v[204:205], v249 offset:59200
    v_mfma_f32_16x16x32_bf16 v[8:11], v[188:191], v[164:167], v[8:11]
    ds_read_b64_tr_b16 v[206:207], v249 offset:59456
    s_waitcnt lgkmcnt(4)
    v_mfma_f32_16x16x32_bf16 v[12:15], v[192:195], v[144:147], v[12:15]
    v_mfma_f32_16x16x32_bf16 v[12:15], v[196:199], v[156:159], v[12:15]
    ds_read_b64_tr_b16 v[208:209], v249 offset:50784
    v_mfma_f32_16x16x32_bf16 v[16:19], v[192:195], v[148:151], v[16:19]
    ds_read_b64_tr_b16 v[210:211], v249 offset:51040
    v_mfma_f32_16x16x32_bf16 v[16:19], v[196:199], v[160:163], v[16:19]
    ds_read_b64_tr_b16 v[212:213], v249 offset:59232
    v_mfma_f32_16x16x32_bf16 v[20:23], v[192:195], v[152:155], v[20:23]
    ds_read_b64_tr_b16 v[214:215], v249 offset:59488
    v_mfma_f32_16x16x32_bf16 v[20:23], v[196:199], v[164:167], v[20:23]
    ds_read_b64_tr_b16 v[168:169], v249 offset:50816
    s_waitcnt lgkmcnt(5)
    v_mfma_f32_16x16x32_bf16 v[24:27], v[200:203], v[144:147], v[24:27]
    v_pk_mul_f32 v[0:1], v[0:1], s[54:55] op_sel_hi:[1,0]
    v_pk_mul_f32 v[2:3], v[2:3], s[54:55] op_sel_hi:[1,0]
    ds_read_b64_tr_b16 v[170:171], v249 offset:51072
    v_mfma_f32_16x16x32_bf16 v[24:27], v[204:207], v[156:159], v[24:27]
    v_pk_mul_f32 v[12:13], v[12:13], s[54:55] op_sel_hi:[1,0]
    v_pk_mul_f32 v[14:15], v[14:15], s[54:55] op_sel_hi:[1,0]
    v_cvt_pk_bf16_f32 v96, v0, v1
    v_mfma_f32_16x16x32_bf16 v[28:31], v[200:203], v[148:151], v[28:31]
    ds_read_b64_tr_b16 v[172:173], v249 offset:59264
    v_cvt_pk_bf16_f32 v97, v2, v3
    v_cvt_pk_bf16_f32 v98, v12, v13
    v_cvt_pk_bf16_f32 v99, v14, v15
    v_mfma_f32_16x16x32_bf16 v[28:31], v[204:207], v[160:163], v[28:31]
    ds_read_b64_tr_b16 v[174:175], v249 offset:59520
    v_pk_mul_f32 v[4:5], v[4:5], s[54:55] op_sel_hi:[1,0]
    v_pk_mul_f32 v[6:7], v[6:7], s[54:55] op_sel_hi:[1,0]
    v_mfma_f32_16x16x32_bf16 v[32:35], v[200:203], v[152:155], v[32:35]
    v_pk_mul_f32 v[16:17], v[16:17], s[54:55] op_sel_hi:[1,0]
    ds_read_b64_tr_b16 v[176:177], v249 offset:50848
    v_pk_mul_f32 v[18:19], v[18:19], s[54:55] op_sel_hi:[1,0]
    v_mfma_f32_16x16x32_bf16 v[32:35], v[204:207], v[164:167], v[32:35]
    v_cvt_pk_bf16_f32 v100, v4, v5
    v_cvt_pk_bf16_f32 v101, v6, v7
    ds_read_b64_tr_b16 v[178:179], v249 offset:51104
    v_cvt_pk_bf16_f32 v102, v16, v17
    s_waitcnt lgkmcnt(6)
    v_mfma_f32_16x16x32_bf16 v[36:39], v[208:211], v[144:147], v[36:39]
    v_cvt_pk_bf16_f32 v103, v18, v19
    v_pk_mul_f32 v[8:9], v[8:9], s[54:55] op_sel_hi:[1,0]
    ds_read_b64_tr_b16 v[180:181], v249 offset:59296
    v_mfma_f32_16x16x32_bf16 v[36:39], v[212:215], v[156:159], v[36:39]
    v_pk_mul_f32 v[10:11], v[10:11], s[54:55] op_sel_hi:[1,0]
    v_pk_mul_f32 v[20:21], v[20:21], s[54:55] op_sel_hi:[1,0]
    v_pk_mul_f32 v[22:23], v[22:23], s[54:55] op_sel_hi:[1,0]
    v_mfma_f32_16x16x32_bf16 v[40:43], v[208:211], v[148:151], v[40:43]
    ds_read_b64_tr_b16 v[182:183], v249 offset:59552
    v_cvt_pk_bf16_f32 v104, v8, v9
    v_cvt_pk_bf16_f32 v105, v10, v11
    v_cvt_pk_bf16_f32 v106, v20, v21
    v_mfma_f32_16x16x32_bf16 v[40:43], v[212:215], v[160:163], v[40:43]
    ds_read_b64_tr_b16 v[184:185], v249 offset:50880
    v_cvt_pk_bf16_f32 v107, v22, v23
    v_permlane16_swap_b32 v96, v98
    v_mfma_f32_16x16x32_bf16 v[44:47], v[208:211], v[152:155], v[44:47]
    v_permlane16_swap_b32 v97, v99
    ds_read_b64_tr_b16 v[186:187], v249 offset:51136
    v_permlane16_swap_b32 v100, v102
    v_mfma_f32_16x16x32_bf16 v[44:47], v[212:215], v[164:167], v[44:47]
    v_permlane16_swap_b32 v101, v103
    v_permlane16_swap_b32 v104, v106
    ds_read_b64_tr_b16 v[188:189], v249 offset:59328
    v_permlane16_swap_b32 v105, v107
    s_waitcnt lgkmcnt(7)
    v_mfma_f32_16x16x32_bf16 v[48:51], v[168:171], v[144:147], v[48:51]
    v_pk_mul_f32 v[24:25], v[24:25], s[54:55] op_sel_hi:[1,0]
    v_pk_mul_f32 v[26:27], v[26:27], s[54:55] op_sel_hi:[1,0]
    ds_read_b64_tr_b16 v[190:191], v249 offset:59584
    v_mfma_f32_16x16x32_bf16 v[48:51], v[172:175], v[156:159], v[48:51]
    v_pk_mul_f32 v[36:37], v[36:37], s[54:55] op_sel_hi:[1,0]
    v_pk_mul_f32 v[38:39], v[38:39], s[54:55] op_sel_hi:[1,0]
    v_cvt_pk_bf16_f32 v108, v24, v25
    v_mfma_f32_16x16x32_bf16 v[52:55], v[168:171], v[148:151], v[52:55]
    ds_read_b64_tr_b16 v[192:193], v249 offset:50912
    v_cvt_pk_bf16_f32 v109, v26, v27
    v_cvt_pk_bf16_f32 v110, v36, v37
    v_cvt_pk_bf16_f32 v111, v38, v39
    v_mfma_f32_16x16x32_bf16 v[52:55], v[172:175], v[160:163], v[52:55]
    ds_read_b64_tr_b16 v[194:195], v249 offset:51168
    v_pk_mul_f32 v[28:29], v[28:29], s[54:55] op_sel_hi:[1,0]
    v_pk_mul_f32 v[30:31], v[30:31], s[54:55] op_sel_hi:[1,0]
    v_mfma_f32_16x16x32_bf16 v[56:59], v[168:171], v[152:155], v[56:59]
    v_pk_mul_f32 v[40:41], v[40:41], s[54:55] op_sel_hi:[1,0]
    ds_read_b64_tr_b16 v[196:197], v249 offset:59360
    v_pk_mul_f32 v[42:43], v[42:43], s[54:55] op_sel_hi:[1,0]
    v_mfma_f32_16x16x32_bf16 v[56:59], v[172:175], v[164:167], v[56:59]
    v_cvt_pk_bf16_f32 v112, v28, v29
    v_cvt_pk_bf16_f32 v113, v30, v31
    ds_read_b64_tr_b16 v[198:199], v249 offset:59616
    v_cvt_pk_bf16_f32 v114, v40, v41
    s_waitcnt lgkmcnt(8)
    v_mfma_f32_16x16x32_bf16 v[60:63], v[176:179], v[144:147], v[60:63]
    v_cvt_pk_bf16_f32 v115, v42, v43
    v_pk_mul_f32 v[32:33], v[32:33], s[54:55] op_sel_hi:[1,0]
    v_mfma_f32_16x16x32_bf16 v[60:63], v[180:183], v[156:159], v[60:63]
    v_pk_mul_f32 v[34:35], v[34:35], s[54:55] op_sel_hi:[1,0]
    v_pk_mul_f32 v[44:45], v[44:45], s[54:55] op_sel_hi:[1,0]
    v_pk_mul_f32 v[46:47], v[46:47], s[54:55] op_sel_hi:[1,0]
    v_mfma_f32_16x16x32_bf16 v[64:67], v[176:179], v[148:151], v[64:67]
    v_cvt_pk_bf16_f32 v116, v32, v33
    v_cvt_pk_bf16_f32 v117, v34, v35
    v_mfma_f32_16x16x32_bf16 v[64:67], v[180:183], v[160:163], v[64:67]
    v_cvt_pk_bf16_f32 v118, v44, v45
    v_cvt_pk_bf16_f32 v119, v46, v47
    v_permlane16_swap_b32 v108, v110
    v_mfma_f32_16x16x32_bf16 v[68:71], v[176:179], v[152:155], v[68:71]
    v_permlane16_swap_b32 v109, v111
    v_permlane16_swap_b32 v112, v114
    v_mfma_f32_16x16x32_bf16 v[68:71], v[180:183], v[164:167], v[68:71]
    v_permlane16_swap_b32 v113, v115
    v_permlane16_swap_b32 v116, v118
    v_permlane16_swap_b32 v117, v119
    s_waitcnt lgkmcnt(0)
    s_barrier
    v_mfma_f32_16x16x32_bf16 v[72:75], v[184:187], v[144:147], v[72:75]
    v_pk_mul_f32 v[48:49], v[48:49], s[54:55] op_sel_hi:[1,0]
    v_pk_mul_f32 v[50:51], v[50:51], s[54:55] op_sel_hi:[1,0]
    v_pk_mul_f32 v[60:61], v[60:61], s[54:55] op_sel_hi:[1,0]
    v_mfma_f32_16x16x32_bf16 v[72:75], v[188:191], v[156:159], v[72:75]
    ds_read_b128 v[220:223], v244 offset:0
    v_pk_mul_f32 v[62:63], v[62:63], s[54:55] op_sel_hi:[1,0]
    v_cvt_pk_bf16_f32 v120, v48, v49
    v_mfma_f32_16x16x32_bf16 v[76:79], v[184:187], v[148:151], v[76:79]
    v_cvt_pk_bf16_f32 v121, v50, v51
    v_cvt_pk_bf16_f32 v122, v60, v61
    ds_read_b128 v[224:227], v244 offset:4352
    v_mfma_f32_16x16x32_bf16 v[76:79], v[188:191], v[160:163], v[76:79]
    v_cvt_pk_bf16_f32 v123, v62, v63
    v_pk_mul_f32 v[52:53], v[52:53], s[54:55] op_sel_hi:[1,0]
    v_pk_mul_f32 v[54:55], v[54:55], s[54:55] op_sel_hi:[1,0]
    v_mfma_f32_16x16x32_bf16 v[80:83], v[184:187], v[152:155], v[80:83]
    v_pk_mul_f32 v[64:65], v[64:65], s[54:55] op_sel_hi:[1,0]
    ds_read_b128 v[228:231], v244 offset:64
    v_pk_mul_f32 v[66:67], v[66:67], s[54:55] op_sel_hi:[1,0]
    v_mfma_f32_16x16x32_bf16 v[80:83], v[188:191], v[164:167], v[80:83]
    v_cvt_pk_bf16_f32 v124, v52, v53
    v_cvt_pk_bf16_f32 v125, v54, v55
    ds_read_b128 v[232:235], v244 offset:4416
    v_cvt_pk_bf16_f32 v126, v64, v65
    v_mfma_f32_16x16x32_bf16 v[84:87], v[192:195], v[144:147], v[84:87]
    v_cvt_pk_bf16_f32 v127, v66, v67
    v_pk_mul_f32 v[56:57], v[56:57], s[54:55] op_sel_hi:[1,0]
    v_pk_mul_f32 v[58:59], v[58:59], s[54:55] op_sel_hi:[1,0]
    v_mfma_f32_16x16x32_bf16 v[84:87], v[196:199], v[156:159], v[84:87]
    ds_read_b128 v[236:239], v244 offset:128
    v_pk_mul_f32 v[68:69], v[68:69], s[54:55] op_sel_hi:[1,0]
    v_pk_mul_f32 v[70:71], v[70:71], s[54:55] op_sel_hi:[1,0]
    v_mfma_f32_16x16x32_bf16 v[88:91], v[192:195], v[148:151], v[88:91]
    v_cvt_pk_bf16_f32 v128, v56, v57
    v_cvt_pk_bf16_f32 v129, v58, v59
    ds_read_b128 v[240:243], v244 offset:4480
    v_mfma_f32_16x16x32_bf16 v[88:91], v[196:199], v[160:163], v[88:91]
    v_cvt_pk_bf16_f32 v130, v68, v69
    v_cvt_pk_bf16_f32 v131, v70, v71
    v_permlane16_swap_b32 v120, v122
    v_mfma_f32_16x16x32_bf16 v[92:95], v[192:195], v[152:155], v[92:95]
    v_permlane16_swap_b32 v121, v123
    ds_read_b128 v[0:3], v244 offset:192
    v_permlane16_swap_b32 v124, v126
    v_mfma_f32_16x16x32_bf16 v[92:95], v[196:199], v[164:167], v[92:95]
    v_permlane16_swap_b32 v125, v127
    v_permlane16_swap_b32 v128, v130
    ds_read_b128 v[4:7], v244 offset:4544
    v_permlane16_swap_b32 v129, v131
    s_waitcnt lgkmcnt(6)
    v_mfma_f32_16x16x32_bf16 v[144:147], v[220:223], v[96:99], 0
    v_pk_mul_f32 v[72:73], v[72:73], s[54:55] op_sel_hi:[1,0]
    v_mfma_f32_16x16x32_bf16 v[148:151], v[220:223], v[100:103], 0
    v_pk_mul_f32 v[74:75], v[74:75], s[54:55] op_sel_hi:[1,0]
    v_pk_mul_f32 v[84:85], v[84:85], s[54:55] op_sel_hi:[1,0]
    v_mfma_f32_16x16x32_bf16 v[152:155], v[220:223], v[104:107], 0
    v_pk_mul_f32 v[86:87], v[86:87], s[54:55] op_sel_hi:[1,0]
    v_cvt_pk_bf16_f32 v132, v72, v73
    v_mfma_f32_16x16x32_bf16 v[156:159], v[224:227], v[96:99], 0
    v_cvt_pk_bf16_f32 v133, v74, v75
    v_mfma_f32_16x16x32_bf16 v[160:163], v[224:227], v[100:103], 0
    v_cvt_pk_bf16_f32 v134, v84, v85
    v_cvt_pk_bf16_f32 v135, v86, v87
    v_mfma_f32_16x16x32_bf16 v[164:167], v[224:227], v[104:107], 0
    v_pk_mul_f32 v[76:77], v[76:77], s[54:55] op_sel_hi:[1,0]
    v_pk_mul_f32 v[78:79], v[78:79], s[54:55] op_sel_hi:[1,0]
    s_waitcnt lgkmcnt(4)
    v_mfma_f32_16x16x32_bf16 v[144:147], v[228:231], v[108:111], v[144:147]
    v_pk_mul_f32 v[88:89], v[88:89], s[54:55] op_sel_hi:[1,0]
    v_mfma_f32_16x16x32_bf16 v[148:151], v[228:231], v[112:115], v[148:151]
    v_pk_mul_f32 v[90:91], v[90:91], s[54:55] op_sel_hi:[1,0]
    v_cvt_pk_bf16_f32 v136, v76, v77
    v_mfma_f32_16x16x32_bf16 v[152:155], v[228:231], v[116:119], v[152:155]
    v_cvt_pk_bf16_f32 v137, v78, v79
    v_cvt_pk_bf16_f32 v138, v88, v89
    v_mfma_f32_16x16x32_bf16 v[156:159], v[232:235], v[108:111], v[156:159]
    v_cvt_pk_bf16_f32 v139, v90, v91
    v_mfma_f32_16x16x32_bf16 v[160:163], v[232:235], v[112:115], v[160:163]
    v_pk_mul_f32 v[80:81], v[80:81], s[54:55] op_sel_hi:[1,0]
    v_pk_mul_f32 v[82:83], v[82:83], s[54:55] op_sel_hi:[1,0]
    v_mfma_f32_16x16x32_bf16 v[164:167], v[232:235], v[116:119], v[164:167]
    v_pk_mul_f32 v[92:93], v[92:93], s[54:55] op_sel_hi:[1,0]
    v_pk_mul_f32 v[94:95], v[94:95], s[54:55] op_sel_hi:[1,0]
    s_waitcnt lgkmcnt(2)
    v_mfma_f32_16x16x32_bf16 v[144:147], v[236:239], v[120:123], v[144:147]
    v_cvt_pk_bf16_f32 v140, v80, v81
    v_mfma_f32_16x16x32_bf16 v[148:151], v[236:239], v[124:127], v[148:151]
    v_cvt_pk_bf16_f32 v141, v82, v83
    v_cvt_pk_bf16_f32 v142, v92, v93
    v_mfma_f32_16x16x32_bf16 v[152:155], v[236:239], v[128:131], v[152:155]
    v_cvt_pk_bf16_f32 v143, v94, v95
    v_permlane16_swap_b32 v132, v134
    v_mfma_f32_16x16x32_bf16 v[156:159], v[240:243], v[120:123], v[156:159]
    v_permlane16_swap_b32 v133, v135
    v_mfma_f32_16x16x32_bf16 v[160:163], v[240:243], v[124:127], v[160:163]
    v_permlane16_swap_b32 v136, v138
    v_permlane16_swap_b32 v137, v139
    v_mfma_f32_16x16x32_bf16 v[164:167], v[240:243], v[128:131], v[164:167]
    v_permlane16_swap_b32 v140, v142
    v_permlane16_swap_b32 v141, v143
    s_waitcnt lgkmcnt(0)
    v_mfma_f32_16x16x32_bf16 v[144:147], v[0:3], v[132:135], v[144:147]
    v_mfma_f32_16x16x32_bf16 v[148:151], v[0:3], v[136:139], v[148:151]
    ds_read_b128 v[220:223], v244 offset:8704
    v_mfma_f32_16x16x32_bf16 v[152:155], v[0:3], v[140:143], v[152:155]
    ds_read_b128 v[224:227], v244 offset:8768
    v_mfma_f32_16x16x32_bf16 v[156:159], v[4:7], v[132:135], v[156:159]
    v_mfma_f32_16x16x32_bf16 v[160:163], v[4:7], v[136:139], v[160:163]
    ds_read_b128 v[228:231], v244 offset:8832
    v_mfma_f32_16x16x32_bf16 v[164:167], v[4:7], v[140:143], v[164:167]
    ds_read_b128 v[232:235], v244 offset:8896
    v_max3_f32 v180, v144, v145, v146
    s_nop 2
    v_max3_f32 v180, v180, v147, v156
    v_max3_f32 v180, v180, v157, v158
    v_max_f32 v180, v180, v159
    v_max3_f32 v182, v148, v149, v150
    v_max3_f32 v182, v182, v151, v160
    v_max3_f32 v182, v182, v161, v162
    v_max_f32 v182, v182, v163
    v_max3_f32 v184, v152, v153, v154
    v_max3_f32 v184, v184, v155, v164
    v_max3_f32 v184, v184, v165, v166
    v_max_f32 v184, v184, v167
    v_mov_b32 v181, v180
    v_mov_b32 v183, v182
    v_mov_b32 v185, v184
    v_permlane16_swap_b32 v180, v181
    v_permlane16_swap_b32 v182, v183
    v_permlane16_swap_b32 v184, v185
    v_max_f32 v180, v180, v181
    v_max_f32 v182, v182, v183
    v_max_f32 v184, v184, v185
    v_mov_b32 v181, v180
    v_mov_b32 v183, v182
    v_mov_b32 v185, v184
    v_permlane32_swap_b32 v180, v181
    v_permlane32_swap_b32 v182, v183
    v_permlane32_swap_b32 v184, v185
    v_max_f32 v180, v180, v181
    v_max_f32 v182, v182, v183
    v_max_f32 v184, v184, v185
    v_add_f32 v180, 0x41800000, v180
    v_add_f32 v182, 0x41800000, v182
    v_add_f32 v184, 0x41800000, v184
    v_sub_f32 v192, 0, v180
    v_sub_f32 v193, 0, v180
    v_sub_f32 v194, 0, v180
    v_sub_f32 v195, 0, v180
    v_sub_f32 v144, v144, v180
    v_sub_f32 v145, v145, v180
    v_sub_f32 v146, v146, v180
    v_sub_f32 v147, v147, v180
    v_sub_f32 v156, v156, v180
    v_sub_f32 v157, v157, v180
    v_sub_f32 v158, v158, v180
    v_sub_f32 v159, v159, v180
    v_sub_f32 v196, 0, v182
    v_sub_f32 v197, 0, v182
    v_sub_f32 v198, 0, v182
    v_sub_f32 v199, 0, v182
    v_sub_f32 v148, v148, v182
    v_sub_f32 v149, v149, v182
    v_sub_f32 v150, v150, v182
    v_sub_f32 v151, v151, v182
    v_sub_f32 v160, v160, v182
    v_sub_f32 v161, v161, v182
    v_sub_f32 v162, v162, v182
    v_sub_f32 v163, v163, v182
    v_sub_f32 v200, 0, v184
    v_sub_f32 v201, 0, v184
    v_sub_f32 v202, 0, v184
    v_sub_f32 v203, 0, v184
    v_sub_f32 v152, v152, v184
    v_sub_f32 v153, v153, v184
    v_sub_f32 v154, v154, v184
    v_sub_f32 v155, v155, v184
    v_sub_f32 v164, v164, v184
    v_sub_f32 v165, v165, v184
    v_sub_f32 v166, v166, v184
    v_sub_f32 v167, v167, v184
    v_exp_f32 v144, v144
    v_exp_f32 v145, v145
    v_exp_f32 v146, v146
    v_exp_f32 v147, v147
    v_exp_f32 v148, v148
    v_exp_f32 v149, v149
    v_exp_f32 v150, v150
    v_exp_f32 v151, v151
    v_exp_f32 v152, v152
    v_exp_f32 v153, v153
    v_exp_f32 v154, v154
    v_exp_f32 v155, v155
    v_exp_f32 v156, v156
    v_exp_f32 v157, v157
    v_exp_f32 v158, v158
    v_exp_f32 v159, v159
    v_exp_f32 v160, v160
    v_exp_f32 v161, v161
    v_exp_f32 v162, v162
    v_exp_f32 v163, v163
    v_exp_f32 v164, v164
    v_exp_f32 v165, v165
    v_exp_f32 v166, v166
    v_exp_f32 v167, v167
    v_cvt_pk_bf16_f32 v168, v144, v145
    v_cvt_pk_bf16_f32 v169, v146, v147
    v_cvt_pk_bf16_f32 v172, v148, v149
    v_cvt_pk_bf16_f32 v173, v150, v151
    v_cvt_pk_bf16_f32 v176, v152, v153
    v_cvt_pk_bf16_f32 v177, v154, v155
    v_cvt_pk_bf16_f32 v170, v156, v157
    v_cvt_pk_bf16_f32 v171, v158, v159
    v_cvt_pk_bf16_f32 v174, v160, v161
    v_cvt_pk_bf16_f32 v175, v162, v163
    v_cvt_pk_bf16_f32 v178, v164, v165
    v_cvt_pk_bf16_f32 v179, v166, v167
    s_mov_b32 s53, 0
    s_cmp_lg_u32 s44, 0
    s_cbranch_scc1 A_noarr
    s_and_b32 s46, s2, 3
    s_lshl_b32 s46, s46, 6
    v_mov_b32 v246, s46
    v_mov_b32 v247, 1
    s_waitcnt vmcnt(0)
    s_mov_b64 exec, 1
    global_atomic_add v246, v247, s[16:17] sc1
    s_mov_b64 exec, -1
A_noarr:
    s_waitcnt lgkmcnt(0)
    v_mfma_f32_16x16x32_bf16 v[144:147], v[220:223], v[96:99], v[192:195]
    ds_read_b128 v[236:239], v244 offset:13056
    ds_read_b128 v[240:243], v244 offset:13120
    v_mfma_f32_16x16x32_bf16 v[144:147], v[224:227], v[108:111], v[144:147]
    ds_read_b128 v[248:251], v244 offset:13184
    v_mfma_f32_16x16x32_bf16 v[148:151], v[220:223], v[100:103], v[196:199]
    v_mfma_f32_16x16x32_bf16 v[148:151], v[224:227], v[112:115], v[148:151]
    v_mfma_f32_16x16x32_bf16 v[152:155], v[220:223], v[104:107], v[200:203]
    v_mfma_f32_16x16x32_bf16 v[152:155], v[224:227], v[116:119], v[152:155]
    ds_read_b128 v[220:223], v244 offset:13248
    v_mfma_f32_16x16x32_bf16 v[144:147], v[228:231], v[120:123], v[144:147]
    ds_read_b64_tr_b16 v[224:225], v245 offset:64
    ds_read_b64_tr_b16 v[226:227], v245 offset:576
    v_mfma_f32_16x16x32_bf16 v[144:147], v[232:235], v[132:135], v[144:147]
    v_mfma_f32_16x16x32_bf16 v[148:151], v[228:231], v[124:127], v[148:151]
    v_mfma_f32_16x16x32_bf16 v[148:151], v[232:235], v[136:139], v[148:151]
    v_mfma_f32_16x16x32_bf16 v[152:155], v[228:231], v[128:131], v[152:155]
    v_mfma_f32_16x16x32_bf16 v[152:155], v[232:235], v[140:143], v[152:155]
    s_waitcnt lgkmcnt(3)
    v_mfma_f32_16x16x32_bf16 v[156:159], v[236:239], v[96:99], v[192:195]
    ds_read_b64_tr_b16 v[228:229], v245 offset:96
    ds_read_b64_tr_b16 v[230:231], v245 offset:608
    v_mfma_f32_16x16x32_bf16 v[156:159], v[240:243], v[108:111], v[156:159]
    ds_read_b64_tr_b16 v[232:233], v245 offset:128
    ds_read_b64_tr_b16 v[234:235], v245 offset:640
    v_mfma_f32_16x16x32_bf16 v[160:163], v[236:239], v[100:103], v[196:199]
    v_exp_f32 v144, v144
    v_mfma_f32_16x16x32_bf16 v[160:163], v[240:243], v[112:115], v[160:163]
    v_exp_f32 v145, v145
    v_mfma_f32_16x16x32_bf16 v[164:167], v[236:239], v[104:107], v[200:203]
    v_exp_f32 v146, v146
    v_mfma_f32_16x16x32_bf16 v[164:167], v[240:243], v[116:119], v[164:167]
    s_waitcnt lgkmcnt(6)
    v_mfma_f32_16x16x32_bf16 v[156:159], v[248:251], v[120:123], v[156:159]
    ds_read_b64_tr_b16 v[236:237], v245 offset:0
    ds_read_b64_tr_b16 v[238:239], v245 offset:512
    v_mfma_f32_16x16x32_bf16 v[156:159], v[220:223], v[132:135], v[156:159]
    ds_read_b64_tr_b16 v[240:241], v245 offset:32
    ds_read_b64_tr_b16 v[242:243], v245 offset:544
    v_mfma_f32_16x16x32_bf16 v[160:163], v[248:251], v[124:127], v[160:163]
    v_exp_f32 v147, v147
    v_mfma_f32_16x16x32_bf16 v[160:163], v[220:223], v[136:139], v[160:163]
    v_exp_f32 v148, v148
    v_mfma_f32_16x16x32_bf16 v[164:167], v[248:251], v[128:131], v[164:167]
    v_exp_f32 v149, v149
    v_mfma_f32_16x16x32_bf16 v[164:167], v[220:223], v[140:143], v[164:167]
    v_mfma_f32_16x16x32_bf16 v[204:207], v[216:219], v[168:171], 0
    ds_read_b64_tr_b16 v[248:249], v245 offset:160
    ds_read_b64_tr_b16 v[250:251], v245 offset:672
    v_mfma_f32_16x16x32_bf16 v[208:211], v[216:219], v[172:175], 0
    v_exp_f32 v150, v150
    v_mfma_f32_16x16x32_bf16 v[212:215], v[216:219], v[176:179], 0
    v_cvt_pk_bf16_f32 v180, v144, v145
    s_waitcnt lgkmcnt(2)
    v_mfma_f32_16x16x32_bf16 v[0:3], v[236:239], v[168:171], 0
    v_exp_f32 v151, v151
    v_mfma_f32_16x16x32_bf16 v[4:7], v[236:239], v[172:175], 0
    v_exp_f32 v152, v152
    v_mfma_f32_16x16x32_bf16 v[8:11], v[236:239], v[176:179], 0
    ds_read_b64_tr_b16 v[236:237], v245 offset:192
    ds_read_b64_tr_b16 v[238:239], v245 offset:704
    v_mfma_f32_16x16x32_bf16 v[12:15], v[240:243], v[168:171], 0
    v_exp_f32 v153, v153
    v_mfma_f32_16x16x32_bf16 v[16:19], v[240:243], v[172:175], 0
    v_exp_f32 v154, v154
    v_mfma_f32_16x16x32_bf16 v[20:23], v[240:243], v[176:179], 0
    ds_read_b64_tr_b16 v[240:241], v245 offset:224
    ds_read_b64_tr_b16 v[242:243], v245 offset:736
    v_mfma_f32_16x16x32_bf16 v[24:27], v[224:227], v[168:171], 0
    v_exp_f32 v155, v155
    v_mfma_f32_16x16x32_bf16 v[28:31], v[224:227], v[172:175], 0
    v_cvt_pk_bf16_f32 v181, v146, v147
    v_cvt_pk_bf16_f32 v184, v148, v149
    v_mfma_f32_16x16x32_bf16 v[32:35], v[224:227], v[176:179], 0
    v_exp_f32 v156, v156
    v_mfma_f32_16x16x32_bf16 v[36:39], v[228:231], v[168:171], 0
    s_barrier
    ds_read_b128 v[220:223], v244 offset:17408
    v_mfma_f32_16x16x32_bf16 v[40:43], v[228:231], v[172:175], 0
    ds_read_b128 v[224:227], v244 offset:17472
    v_cvt_pk_bf16_f32 v185, v150, v151
    v_mfma_f32_16x16x32_bf16 v[44:47], v[228:231], v[176:179], 0
    ds_read_b128 v[228:231], v244 offset:17536
    v_cvt_pk_bf16_f32 v188, v152, v153
    v_mfma_f32_16x16x32_bf16 v[48:51], v[232:235], v[168:171], 0
    v_exp_f32 v157, v157
    v_mfma_f32_16x16x32_bf16 v[52:55], v[232:235], v[172:175], 0
    v_cvt_pk_bf16_f32 v189, v154, v155
    v_mfma_f32_16x16x32_bf16 v[56:59], v[232:235], v[176:179], 0
    ds_read_b128 v[232:235], v244 offset:17600
    s_waitcnt lgkmcnt(4)
    v_mfma_f32_16x16x32_bf16 v[60:63], v[248:251], v[168:171], 0
    v_exp_f32 v158, v158
    v_mfma_f32_16x16x32_bf16 v[64:67], v[248:251], v[172:175], 0
    v_exp_f32 v159, v159
    v_mfma_f32_16x16x32_bf16 v[68:71], v[248:251], v[176:179], 0
    v_exp_f32 v160, v160
    v_mfma_f32_16x16x32_bf16 v[72:75], v[236:239], v[168:171], 0
    v_exp_f32 v161, v161
    v_mfma_f32_16x16x32_bf16 v[76:79], v[236:239], v[172:175], 0
    v_exp_f32 v162, v162
    v_mfma_f32_16x16x32_bf16 v[80:83], v[236:239], v[176:179], 0
    v_exp_f32 v163, v163
    v_mfma_f32_16x16x32_bf16 v[84:87], v[240:243], v[168:171], 0
    v_exp_f32 v164, v164
    v_mfma_f32_16x16x32_bf16 v[88:91], v[240:243], v[172:175], 0
    v_exp_f32 v165, v165
    v_mfma_f32_16x16x32_bf16 v[92:95], v[240:243], v[176:179], 0
    s_branch A_loop1
A_loop:
    s_waitcnt lgkmcnt(0)
    v_mfma_f32_16x16x32_bf16 v[144:147], v[220:223], v[96:99], v[192:195]
    ds_read_b128 v[236:239], v244 offset:13056
    ds_read_b128 v[240:243], v244 offset:13120
    v_mfma_f32_16x16x32_bf16 v[144:147], v[224:227], v[108:111], v[144:147]
    ds_read_b128 v[248:251], v244 offset:13184
    v_cvt_pk_bf16_f32 v170, v156, v157
    v_mfma_f32_16x16x32_bf16 v[148:151], v[220:223], v[100:103], v[196:199]
    v_exp_f32 v166, v166
    v_mfma_f32_16x16x32_bf16 v[148:151], v[224:227], v[112:115], v[148:151]
    v_exp_f32 v167, v167
    v_mfma_f32_16x16x32_bf16 v[152:155], v[220:223], v[104:107], v[200:203]
    v_cvt_pk_bf16_f32 v171, v158, v159
    v_cvt_pk_bf16_f32 v174, v160, v161
    v_mfma_f32_16x16x32_bf16 v[152:155], v[224:227], v[116:119], v[152:155]
    ds_read_b128 v[220:223], v244 offset:13248
    v_cvt_pk_bf16_f32 v175, v162, v163
    v_mfma_f32_16x16x32_bf16 v[144:147], v[228:231], v[120:123], v[144:147]
    ds_read_b64_tr_b16 v[224:225], v245 offset:64
    ds_read_b64_tr_b16 v[226:227], v245 offset:576
    v_mfma_f32_16x16x32_bf16 v[144:147], v[232:235], v[132:135], v[144:147]
    v_cvt_pk_bf16_f32 v178, v164, v165
    v_cvt_pk_bf16_f32 v179, v166, v167
    v_mfma_f32_16x16x32_bf16 v[148:151], v[228:231], v[124:127], v[148:151]
    v_or3_b32 v246, v168, v169, v172
    v_or3_b32 v246, v246, v173, v176
    v_mfma_f32_16x16x32_bf16 v[148:151], v[232:235], v[136:139], v[148:151]
    v_or3_b32 v246, v246, v177, v170
    v_or3_b32 v246, v246, v171, v174
    v_mfma_f32_16x16x32_bf16 v[152:155], v[228:231], v[128:131], v[152:155]
    v_or3_b32 v246, v246, v175, v178
    v_bitop3_b32 v246, v246, v179, s55 bitop3:0xa8
    v_mfma_f32_16x16x32_bf16 v[152:155], v[232:235], v[140:143], v[152:155]
    v_cmp_ne_u32 vcc, 0, v246
    s_waitcnt lgkmcnt(3)
    v_mfma_f32_16x16x32_bf16 v[156:159], v[236:239], v[96:99], v[192:195]
    ds_read_b64_tr_b16 v[228:229], v245 offset:96
    ds_read_b64_tr_b16 v[230:231], v245 offset:608
    v_mfma_f32_16x16x32_bf16 v[156:159], v[240:243], v[108:111], v[156:159]
    ds_read_b64_tr_b16 v[232:233], v245 offset:128
    ds_read_b64_tr_b16 v[234:235], v245 offset:640
    v_mfma_f32_16x16x32_bf16 v[160:163], v[236:239], v[100:103], v[196:199]
    v_exp_f32 v144, v144
    v_mfma_f32_16x16x32_bf16 v[160:163], v[240:243], v[112:115], v[160:163]
    v_exp_f32 v145, v145
    v_mfma_f32_16x16x32_bf16 v[164:167], v[236:239], v[104:107], v[200:203]
    v_exp_f32 v146, v146
    v_mfma_f32_16x16x32_bf16 v[164:167], v[240:243], v[116:119], v[164:167]
    s_waitcnt lgkmcnt(6)
    v_mfma_f32_16x16x32_bf16 v[156:159], v[248:251], v[120:123], v[156:159]
    ds_read_b64_tr_b16 v[236:237], v245 offset:0
    ds_read_b64_tr_b16 v[238:239], v245 offset:512
    v_mfma_f32_16x16x32_bf16 v[156:159], v[220:223], v[132:135], v[156:159]
    ds_read_b64_tr_b16 v[240:241], v245 offset:32
    ds_read_b64_tr_b16 v[242:243], v245 offset:544
    v_mfma_f32_16x16x32_bf16 v[160:163], v[248:251], v[124:127], v[160:163]
    v_exp_f32 v147, v147
    v_mfma_f32_16x16x32_bf16 v[160:163], v[220:223], v[136:139], v[160:163]
    v_exp_f32 v148, v148
    v_mfma_f32_16x16x32_bf16 v[164:167], v[248:251], v[128:131], v[164:167]
    v_exp_f32 v149, v149
    v_mfma_f32_16x16x32_bf16 v[164:167], v[220:223], v[140:143], v[164:167]
    s_cbranch_vccnz A_rare0
A_back0:
    v_mfma_f32_16x16x32_bf16 v[204:207], v[216:219], v[168:171], v[204:207]
    ds_read_b64_tr_b16 v[248:249], v245 offset:160
    ds_read_b64_tr_b16 v[250:251], v245 offset:672
    v_mfma_f32_16x16x32_bf16 v[208:211], v[216:219], v[172:175], v[208:211]
    v_exp_f32 v150, v150
    v_mfma_f32_16x16x32_bf16 v[212:215], v[216:219], v[176:179], v[212:215]
    v_cvt_pk_bf16_f32 v180, v144, v145
    s_waitcnt lgkmcnt(2)
    v_mfma_f32_16x16x32_bf16 v[0:3], v[236:239], v[168:171], v[0:3]
    v_exp_f32 v151, v151
    v_mfma_f32_16x16x32_bf16 v[4:7], v[236:239], v[172:175], v[4:7]
    v_exp_f32 v152, v152
    v_mfma_f32_16x16x32_bf16 v[8:11], v[236:239], v[176:179], v[8:11]
    ds_read_b64_tr_b16 v[236:237], v245 offset:192
    ds_read_b64_tr_b16 v[238:239], v245 offset:704
    v_mfma_f32_16x16x32_bf16 v[12:15], v[240:243], v[168:171], v[12:15]
    v_exp_f32 v153, v153
    v_mfma_f32_16x16x32_bf16 v[16:19], v[240:243], v[172:175], v[16:19]
    v_exp_f32 v154, v154
    v_mfma_f32_16x16x32_bf16 v[20:23], v[240:243], v[176:179], v[20:23]
    ds_read_b64_tr_b16 v[240:241], v245 offset:224
    ds_read_b64_tr_b16 v[242:243], v245 offset:736
    v_mfma_f32_16x16x32_bf16 v[24:27], v[224:227], v[168:171], v[24:27]
    v_exp_f32 v155, v155
    v_mfma_f32_16x16x32_bf16 v[28:31], v[224:227], v[172:175], v[28:31]
    v_cvt_pk_bf16_f32 v181, v146, v147
    v_cvt_pk_bf16_f32 v184, v148, v149
    v_mfma_f32_16x16x32_bf16 v[32:35], v[224:227], v[176:179], v[32:35]
    v_exp_f32 v156, v156
    v_mfma_f32_16x16x32_bf16 v[36:39], v[228:231], v[168:171], v[36:39]
    s_barrier
    ds_read_b128 v[220:223], v244 offset:17408
    v_mfma_f32_16x16x32_bf16 v[40:43], v[228:231], v[172:175], v[40:43]
    ds_read_b128 v[224:227], v244 offset:17472
    v_cvt_pk_bf16_f32 v185, v150, v151
    v_mfma_f32_16x16x32_bf16 v[44:47], v[228:231], v[176:179], v[44:47]
    ds_read_b128 v[228:231], v244 offset:17536
    v_cvt_pk_bf16_f32 v188, v152, v153
    v_mfma_f32_16x16x32_bf16 v[48:51], v[232:235], v[168:171], v[48:51]
    v_exp_f32 v157, v157
    v_mfma_f32_16x16x32_bf16 v[52:55], v[232:235], v[172:175], v[52:55]
    v_cvt_pk_bf16_f32 v189, v154, v155
    v_mfma_f32_16x16x32_bf16 v[56:59], v[232:235], v[176:179], v[56:59]
    ds_read_b128 v[232:235], v244 offset:17600
    s_waitcnt lgkmcnt(4)
    v_mfma_f32_16x16x32_bf16 v[60:63], v[248:251], v[168:171], v[60:63]
    v_exp_f32 v158, v158
    v_mfma_f32_16x16x32_bf16 v[64:67], v[248:251], v[172:175], v[64:67]
    v_exp_f32 v159, v159
    v_mfma_f32_16x16x32_bf16 v[68:71], v[248:251], v[176:179], v[68:71]
    v_exp_f32 v160, v160
    v_mfma_f32_16x16x32_bf16 v[72:75], v[236:239], v[168:171], v[72:75]
    v_exp_f32 v161, v161
    v_mfma_f32_16x16x32_bf16 v[76:79], v[236:239], v[172:175], v[76:79]
    v_exp_f32 v162, v162
    v_mfma_f32_16x16x32_bf16 v[80:83], v[236:239], v[176:179], v[80:83]
    v_exp_f32 v163, v163
    v_mfma_f32_16x16x32_bf16 v[84:87], v[240:243], v[168:171], v[84:87]
    v_exp_f32 v164, v164
    v_mfma_f32_16x16x32_bf16 v[88:91], v[240:243], v[172:175], v[88:91]
    v_exp_f32 v165, v165
    v_mfma_f32_16x16x32_bf16 v[92:95], v[240:243], v[176:179], v[92:95]
A_loop1:
    s_waitcnt lgkmcnt(0)
    v_mfma_f32_16x16x32_bf16 v[144:147], v[220:223], v[96:99], v[192:195]
    ds_read_b128 v[236:239], v244 offset:21760
    ds_read_b128 v[240:243], v244 offset:21824
    v_mfma_f32_16x16x32_bf16 v[144:147], v[224:227], v[108:111], v[144:147]
    ds_read_b128 v[248:251], v244 offset:21888
    v_cvt_pk_bf16_f32 v182, v156, v157
    v_mfma_f32_16x16x32_bf16 v[148:151], v[220:223], v[100:103], v[196:199]
    v_exp_f32 v166, v166
    v_mfma_f32_16x16x32_bf16 v[148:151], v[224:227], v[112:115], v[148:151]
    v_exp_f32 v167, v167
    v_mfma_f32_16x16x32_bf16 v[152:155], v[220:223], v[104:107], v[200:203]
    v_cvt_pk_bf16_f32 v183, v158, v159
    v_cvt_pk_bf16_f32 v186, v160, v161
    v_mfma_f32_16x16x32_bf16 v[152:155], v[224:227], v[116:119], v[152:155]
    ds_read_b128 v[220:223], v244 offset:21952
    v_cvt_pk_bf16_f32 v187, v162, v163
    v_mfma_f32_16x16x32_bf16 v[144:147], v[228:231], v[120:123], v[144:147]
    ds_read_b64_tr_b16 v[224:225], v245 offset:8512
    ds_read_b64_tr_b16 v[226:227], v245 offset:9024
    v_mfma_f32_16x16x32_bf16 v[144:147], v[232:235], v[132:135], v[144:147]
    v_cvt_pk_bf16_f32 v190, v164, v165
    v_cvt_pk_bf16_f32 v191, v166, v167
    v_mfma_f32_16x16x32_bf16 v[148:151], v[228:231], v[124:127], v[148:151]
    v_or3_b32 v246, v180, v181, v184
    v_or3_b32 v246, v246, v185, v188
    v_mfma_f32_16x16x32_bf16 v[148:151], v[232:235], v[136:139], v[148:151]
    v_or3_b32 v246, v246, v189, v182
    v_or3_b32 v246, v246, v183, v186
    v_mfma_f32_16x16x32_bf16 v[152:155], v[228:231], v[128:131], v[152:155]
    v_or3_b32 v246, v246, v187, v190
    v_bitop3_b32 v246, v246, v191, s55 bitop3:0xa8
    v_mfma_f32_16x16x32_bf16 v[152:155], v[232:235], v[140:143], v[152:155]
    v_cmp_ne_u32 vcc, 0, v246
    s_waitcnt lgkmcnt(3)
    v_mfma_f32_16x16x32_bf16 v[156:159], v[236:239], v[96:99], v[192:195]
    ds_read_b64_tr_b16 v[228:229], v245 offset:8544
    ds_read_b64_tr_b16 v[230:231], v245 offset:9056
    v_mfma_f32_16x16x32_bf16 v[156:159], v[240:243], v[108:111], v[156:159]
    ds_read_b64_tr_b16 v[232:233], v245 offset:8576
    ds_read_b64_tr_b16 v[234:235], v245 offset:9088
    v_mfma_f32_16x16x32_bf16 v[160:163], v[236:239], v[100:103], v[196:199]
    v_exp_f32 v144, v144
    v_mfma_f32_16x16x32_bf16 v[160:163], v[240:243], v[112:115], v[160:163]
    v_exp_f32 v145, v145
    v_mfma_f32_16x16x32_bf16 v[164:167], v[236:239], v[104:107], v[200:203]
    v_exp_f32 v146, v146
    v_mfma_f32_16x16x32_bf16 v[164:167], v[240:243], v[116:119], v[164:167]
    s_waitcnt lgkmcnt(6)
    v_mfma_f32_16x16x32_bf16 v[156:159], v[248:251], v[120:123], v[156:159]
    ds_read_b64_tr_b16 v[236:237], v245 offset:8448
    ds_read_b64_tr_b16 v[238:239], v245 offset:8960
    v_mfma_f32_16x16x32_bf16 v[156:159], v[220:223], v[132:135], v[156:159]
    ds_read_b64_tr_b16 v[240:241], v245 offset:8480
    ds_read_b64_tr_b16 v[242:243], v245 offset:8992
    v_mfma_f32_16x16x32_bf16 v[160:163], v[248:251], v[124:127], v[160:163]
    v_exp_f32 v147, v147
    v_mfma_f32_16x16x32_bf16 v[160:163], v[220:223], v[136:139], v[160:163]
    v_exp_f32 v148, v148
    v_mfma_f32_16x16x32_bf16 v[164:167], v[248:251], v[128:131], v[164:167]
    v_exp_f32 v149, v149
    v_mfma_f32_16x16x32_bf16 v[164:167], v[220:223], v[140:143], v[164:167]
    s_cbranch_vccnz A_rare1
A_back1:
    v_mfma_f32_16x16x32_bf16 v[204:207], v[216:219], v[180:183], v[204:207]
    ds_read_b64_tr_b16 v[248:249], v245 offset:8608
    ds_read_b64_tr_b16 v[250:251], v245 offset:9120
    v_mfma_f32_16x16x32_bf16 v[208:211], v[216:219], v[184:187], v[208:211]
    v_exp_f32 v150, v150
    v_mfma_f32_16x16x32_bf16 v[212:215], v[216:219], v[188:191], v[212:215]
    v_cvt_pk_bf16_f32 v168, v144, v145
    s_waitcnt lgkmcnt(2)
    v_mfma_f32_16x16x32_bf16 v[0:3], v[236:239], v[180:183], v[0:3]
    v_exp_f32 v151, v151
    v_mfma_f32_16x16x32_bf16 v[4:7], v[236:239], v[184:187], v[4:7]
    v_exp_f32 v152, v152
    v_mfma_f32_16x16x32_bf16 v[8:11], v[236:239], v[188:191], v[8:11]
    ds_read_b64_tr_b16 v[236:237], v245 offset:8640
    ds_read_b64_tr_b16 v[238:239], v245 offset:9152
    v_mfma_f32_16x16x32_bf16 v[12:15], v[240:243], v[180:183], v[12:15]
    v_exp_f32 v153, v153
    v_mfma_f32_16x16x32_bf16 v[16:19], v[240:243], v[184:187], v[16:19]
    v_exp_f32 v154, v154
    v_mfma_f32_16x16x32_bf16 v[20:23], v[240:243], v[188:191], v[20:23]
    ds_read_b64_tr_b16 v[240:241], v245 offset:8672
    ds_read_b64_tr_b16 v[242:243], v245 offset:9184
    v_mfma_f32_16x16x32_bf16 v[24:27], v[224:227], v[180:183], v[24:27]
    v_exp_f32 v155, v155
    v_mfma_f32_16x16x32_bf16 v[28:31], v[224:227], v[184:187], v[28:31]
    v_cvt_pk_bf16_f32 v169, v146, v147
    v_cvt_pk_bf16_f32 v172, v148, v149
    v_mfma_f32_16x16x32_bf16 v[32:35], v[224:227], v[188:191], v[32:35]
    v_exp_f32 v156, v156
    v_mfma_f32_16x16x32_bf16 v[36:39], v[228:231], v[180:183], v[36:39]
    ds_read_b128 v[220:223], v244 offset:26112
    v_mfma_f32_16x16x32_bf16 v[40:43], v[228:231], v[184:187], v[40:43]
    ds_read_b128 v[224:227], v244 offset:26176
    v_cvt_pk_bf16_f32 v173, v150, v151
    v_mfma_f32_16x16x32_bf16 v[44:47], v[228:231], v[188:191], v[44:47]
    ds_read_b128 v[228:231], v244 offset:26240
    v_cvt_pk_bf16_f32 v176, v152, v153
    v_mfma_f32_16x16x32_bf16 v[48:51], v[232:235], v[180:183], v[48:51]
    v_exp_f32 v157, v157
    v_mfma_f32_16x16x32_bf16 v[52:55], v[232:235], v[184:187], v[52:55]
    v_cvt_pk_bf16_f32 v177, v154, v155
    v_mfma_f32_16x16x32_bf16 v[56:59], v[232:235], v[188:191], v[56:59]
    ds_read_b128 v[232:235], v244 offset:26304
    s_waitcnt lgkmcnt(4)
    v_mfma_f32_16x16x32_bf16 v[60:63], v[248:251], v[180:183], v[60:63]
    v_exp_f32 v158, v158
    v_mfma_f32_16x16x32_bf16 v[64:67], v[248:251], v[184:187], v[64:67]
    v_exp_f32 v159, v159
    v_mfma_f32_16x16x32_bf16 v[68:71], v[248:251], v[188:191], v[68:71]
    v_exp_f32 v160, v160
    v_mfma_f32_16x16x32_bf16 v[72:75], v[236:239], v[180:183], v[72:75]
    v_exp_f32 v161, v161
    v_mfma_f32_16x16x32_bf16 v[76:79], v[236:239], v[184:187], v[76:79]
    v_exp_f32 v162, v162
    v_mfma_f32_16x16x32_bf16 v[80:83], v[236:239], v[188:191], v[80:83]
    v_exp_f32 v163, v163
    v_mfma_f32_16x16x32_bf16 v[84:87], v[240:243], v[180:183], v[84:87]
    v_exp_f32 v164, v164
    v_mfma_f32_16x16x32_bf16 v[88:91], v[240:243], v[184:187], v[88:91]
    v_exp_f32 v165, v165
    v_mfma_f32_16x16x32_bf16 v[92:95], v[240:243], v[188:191], v[92:95]
    s_waitcnt lgkmcnt(0)
    v_mfma_f32_16x16x32_bf16 v[144:147], v[220:223], v[96:99], v[192:195]
    ds_read_b128 v[236:239], v244 offset:30464
    ds_read_b128 v[240:243], v244 offset:30528
    v_mfma_f32_16x16x32_bf16 v[144:147], v[224:227], v[108:111], v[144:147]
    ds_read_b128 v[248:251], v244 offset:30592
    v_cvt_pk_bf16_f32 v170, v156, v157
    v_mfma_f32_16x16x32_bf16 v[148:151], v[220:223], v[100:103], v[196:199]
    v_exp_f32 v166, v166
    v_mfma_f32_16x16x32_bf16 v[148:151], v[224:227], v[112:115], v[148:151]
    v_exp_f32 v167, v167
    v_mfma_f32_16x16x32_bf16 v[152:155], v[220:223], v[104:107], v[200:203]
    v_cvt_pk_bf16_f32 v171, v158, v159
    v_cvt_pk_bf16_f32 v174, v160, v161
    v_mfma_f32_16x16x32_bf16 v[152:155], v[224:227], v[116:119], v[152:155]
    ds_read_b128 v[220:223], v244 offset:30656
    v_cvt_pk_bf16_f32 v175, v162, v163
    v_mfma_f32_16x16x32_bf16 v[144:147], v[228:231], v[120:123], v[144:147]
    ds_read_b64_tr_b16 v[224:225], v245 offset:16960
    ds_read_b64_tr_b16 v[226:227], v245 offset:17472
    v_mfma_f32_16x16x32_bf16 v[144:147], v[232:235], v[132:135], v[144:147]
    v_cvt_pk_bf16_f32 v178, v164, v165
    v_cvt_pk_bf16_f32 v179, v166, v167
    v_mfma_f32_16x16x32_bf16 v[148:151], v[228:231], v[124:127], v[148:151]
    v_or3_b32 v246, v168, v169, v172
    v_or3_b32 v246, v246, v173, v176
    v_mfma_f32_16x16x32_bf16 v[148:151], v[232:235], v[136:139], v[148:151]
    v_or3_b32 v246, v246, v177, v170
    v_or3_b32 v246, v246, v171, v174
    v_mfma_f32_16x16x32_bf16 v[152:155], v[228:231], v[128:131], v[152:155]
    v_or3_b32 v246, v246, v175, v178
    v_bitop3_b32 v246, v246, v179, s55 bitop3:0xa8
    v_mfma_f32_16x16x32_bf16 v[152:155], v[232:235], v[140:143], v[152:155]
    v_cmp_ne_u32 vcc, 0, v246
    s_waitcnt lgkmcnt(3)
    v_mfma_f32_16x16x32_bf16 v[156:159], v[236:239], v[96:99], v[192:195]
    ds_read_b64_tr_b16 v[228:229], v245 offset:16992
    ds_read_b64_tr_b16 v[230:231], v245 offset:17504
    v_mfma_f32_16x16x32_bf16 v[156:159], v[240:243], v[108:111], v[156:159]
    ds_read_b64_tr_b16 v[232:233], v245 offset:17024
    ds_read_b64_tr_b16 v[234:235], v245 offset:17536
    v_mfma_f32_16x16x32_bf16 v[160:163], v[236:239], v[100:103], v[196:199]
    v_exp_f32 v144, v144
    v_mfma_f32_16x16x32_bf16 v[160:163], v[240:243], v[112:115], v[160:163]
    v_exp_f32 v145, v145
    v_mfma_f32_16x16x32_bf16 v[164:167], v[236:239], v[104:107], v[200:203]
    v_exp_f32 v146, v146
    v_mfma_f32_16x16x32_bf16 v[164:167], v[240:243], v[116:119], v[164:167]
    s_waitcnt lgkmcnt(6)
    v_mfma_f32_16x16x32_bf16 v[156:159], v[248:251], v[120:123], v[156:159]
    ds_read_b64_tr_b16 v[236:237], v245 offset:16896
    ds_read_b64_tr_b16 v[238:239], v245 offset:17408
    v_mfma_f32_16x16x32_bf16 v[156:159], v[220:223], v[132:135], v[156:159]
    ds_read_b64_tr_b16 v[240:241], v245 offset:16928
    ds_read_b64_tr_b16 v[242:243], v245 offset:17440
    v_mfma_f32_16x16x32_bf16 v[160:163], v[248:251], v[124:127], v[160:163]
    v_exp_f32 v147, v147
    v_mfma_f32_16x16x32_bf16 v[160:163], v[220:223], v[136:139], v[160:163]
    v_exp_f32 v148, v148
    v_mfma_f32_16x16x32_bf16 v[164:167], v[248:251], v[128:131], v[164:167]
    v_exp_f32 v149, v149
    v_mfma_f32_16x16x32_bf16 v[164:167], v[220:223], v[140:143], v[164:167]
    s_cbranch_vccnz A_rare2
A_back2:
    v_mfma_f32_16x16x32_bf16 v[204:207], v[216:219], v[168:171], v[204:207]
    ds_read_b64_tr_b16 v[248:249], v245 offset:17056
    ds_read_b64_tr_b16 v[250:251], v245 offset:17568
    v_mfma_f32_16x16x32_bf16 v[208:211], v[216:219], v[172:175], v[208:211]
    v_exp_f32 v150, v150
    v_mfma_f32_16x16x32_bf16 v[212:215], v[216:219], v[176:179], v[212:215]
    v_cvt_pk_bf16_f32 v180, v144, v145
    s_waitcnt lgkmcnt(2)
    v_mfma_f32_16x16x32_bf16 v[0:3], v[236:239], v[168:171], v[0:3]
    v_exp_f32 v151, v151
    v_mfma_f32_16x16x32_bf16 v[4:7], v[236:239], v[172:175], v[4:7]
    v_exp_f32 v152, v152
    v_mfma_f32_16x16x32_bf16 v[8:11], v[236:239], v[176:179], v[8:11]
    ds_read_b64_tr_b16 v[236:237], v245 offset:17088
    ds_read_b64_tr_b16 v[238:239], v245 offset:17600
    v_mfma_f32_16x16x32_bf16 v[12:15], v[240:243], v[168:171], v[12:15]
    v_exp_f32 v153, v153
    v_mfma_f32_16x16x32_bf16 v[16:19], v[240:243], v[172:175], v[16:19]
    v_exp_f32 v154, v154
    v_mfma_f32_16x16x32_bf16 v[20:23], v[240:243], v[176:179], v[20:23]
    ds_read_b64_tr_b16 v[240:241], v245 offset:17120
    ds_read_b64_tr_b16 v[242:243], v245 offset:17632
    v_mfma_f32_16x16x32_bf16 v[24:27], v[224:227], v[168:171], v[24:27]
    v_exp_f32 v155, v155
    v_mfma_f32_16x16x32_bf16 v[28:31], v[224:227], v[172:175], v[28:31]
    v_cvt_pk_bf16_f32 v181, v146, v147
    v_cvt_pk_bf16_f32 v184, v148, v149
    v_mfma_f32_16x16x32_bf16 v[32:35], v[224:227], v[176:179], v[32:35]
    v_exp_f32 v156, v156
    v_mfma_f32_16x16x32_bf16 v[36:39], v[228:231], v[168:171], v[36:39]
    s_barrier
    ds_read_b128 v[220:223], v244 offset:34816
    v_mfma_f32_16x16x32_bf16 v[40:43], v[228:231], v[172:175], v[40:43]
    ds_read_b128 v[224:227], v244 offset:34880
    v_cvt_pk_bf16_f32 v185, v150, v151
    v_mfma_f32_16x16x32_bf16 v[44:47], v[228:231], v[176:179], v[44:47]
    ds_read_b128 v[228:231], v244 offset:34944
    v_cvt_pk_bf16_f32 v188, v152, v153
    v_mfma_f32_16x16x32_bf16 v[48:51], v[232:235], v[168:171], v[48:51]
    v_exp_f32 v157, v157
    v_mfma_f32_16x16x32_bf16 v[52:55], v[232:235], v[172:175], v[52:55]
    v_cvt_pk_bf16_f32 v189, v154, v155
    v_mfma_f32_16x16x32_bf16 v[56:59], v[232:235], v[176:179], v[56:59]
    ds_read_b128 v[232:235], v244 offset:35008
    s_waitcnt lgkmcnt(4)
    v_mfma_f32_16x16x32_bf16 v[60:63], v[248:251], v[168:171], v[60:63]
    v_exp_f32 v158, v158
    v_mfma_f32_16x16x32_bf16 v[64:67], v[248:251], v[172:175], v[64:67]
    v_exp_f32 v159, v159
    v_mfma_f32_16x16x32_bf16 v[68:71], v[248:251], v[176:179], v[68:71]
    v_exp_f32 v160, v160
    v_mfma_f32_16x16x32_bf16 v[72:75], v[236:239], v[168:171], v[72:75]
    v_exp_f32 v161, v161
    v_mfma_f32_16x16x32_bf16 v[76:79], v[236:239], v[172:175], v[76:79]
    v_exp_f32 v162, v162
    v_mfma_f32_16x16x32_bf16 v[80:83], v[236:239], v[176:179], v[80:83]
    v_exp_f32 v163, v163
    v_mfma_f32_16x16x32_bf16 v[84:87], v[240:243], v[168:171], v[84:87]
    v_exp_f32 v164, v164
    v_mfma_f32_16x16x32_bf16 v[88:91], v[240:243], v[172:175], v[88:91]
    v_exp_f32 v165, v165
    v_mfma_f32_16x16x32_bf16 v[92:95], v[240:243], v[176:179], v[92:95]
    s_waitcnt lgkmcnt(0)
    v_mfma_f32_16x16x32_bf16 v[144:147], v[220:223], v[96:99], v[192:195]
    ds_read_b128 v[236:239], v244 offset:39168
    ds_read_b128 v[240:243], v244 offset:39232
    v_mfma_f32_16x16x32_bf16 v[144:147], v[224:227], v[108:111], v[144:147]
    ds_read_b128 v[248:251], v244 offset:39296
    v_cvt_pk_bf16_f32 v182, v156, v157
    v_mfma_f32_16x16x32_bf16 v[148:151], v[220:223], v[100:103], v[196:199]
    v_exp_f32 v166, v166
    v_mfma_f32_16x16x32_bf16 v[148:151], v[224:227], v[112:115], v[148:151]
    v_exp_f32 v167, v167
    v_mfma_f32_16x16x32_bf16 v[152:155], v[220:223], v[104:107], v[200:203]
    v_cvt_pk_bf16_f32 v183, v158, v159
    v_cvt_pk_bf16_f32 v186, v160, v161
    v_mfma_f32_16x16x32_bf16 v[152:155], v[224:227], v[116:119], v[152:155]
    ds_read_b128 v[220:223], v244 offset:39360
    v_cvt_pk_bf16_f32 v187, v162, v163
    v_mfma_f32_16x16x32_bf16 v[144:147], v[228:231], v[120:123], v[144:147]
    ds_read_b64_tr_b16 v[224:225], v245 offset:25408
    ds_read_b64_tr_b16 v[226:227], v245 offset:25920
    v_mfma_f32_16x16x32_bf16 v[144:147], v[232:235], v[132:135], v[144:147]
    v_cvt_pk_bf16_f32 v190, v164, v165
    v_cvt_pk_bf16_f32 v191, v166, v167
    v_mfma_f32_16x16x32_bf16 v[148:151], v[228:231], v[124:127], v[148:151]
    v_or3_b32 v246, v180, v181, v184
    v_or3_b32 v246, v246, v185, v188
    v_mfma_f32_16x16x32_bf16 v[148:151], v[232:235], v[136:139], v[148:151]
    v_or3_b32 v246, v246, v189, v182
    v_or3_b32 v246, v246, v183, v186
    v_mfma_f32_16x16x32_bf16 v[152:155], v[228:231], v[128:131], v[152:155]
    v_or3_b32 v246, v246, v187, v190
    v_bitop3_b32 v246, v246, v191, s55 bitop3:0xa8
    v_mfma_f32_16x16x32_bf16 v[152:155], v[232:235], v[140:143], v[152:155]
    v_cmp_ne_u32 vcc, 0, v246
    s_waitcnt lgkmcnt(3)
    v_mfma_f32_16x16x32_bf16 v[156:159], v[236:239], v[96:99], v[192:195]
    ds_read_b64_tr_b16 v[228:229], v245 offset:25440
    ds_read_b64_tr_b16 v[230:231], v245 offset:25952
    v_mfma_f32_16x16x32_bf16 v[156:159], v[240:243], v[108:111], v[156:159]
    ds_read_b64_tr_b16 v[232:233], v245 offset:25472
    ds_read_b64_tr_b16 v[234:235], v245 offset:25984
    v_mfma_f32_16x16x32_bf16 v[160:163], v[236:239], v[100:103], v[196:199]
    v_exp_f32 v144, v144
    v_mfma_f32_16x16x32_bf16 v[160:163], v[240:243], v[112:115], v[160:163]
    v_exp_f32 v145, v145
    v_mfma_f32_16x16x32_bf16 v[164:167], v[236:239], v[104:107], v[200:203]
    v_exp_f32 v146, v146
    v_mfma_f32_16x16x32_bf16 v[164:167], v[240:243], v[116:119], v[164:167]
    s_waitcnt lgkmcnt(6)
    v_mfma_f32_16x16x32_bf16 v[156:159], v[248:251], v[120:123], v[156:159]
    ds_read_b64_tr_b16 v[236:237], v245 offset:25344
    ds_read_b64_tr_b16 v[238:239], v245 offset:25856
    v_mfma_f32_16x16x32_bf16 v[156:159], v[220:223], v[132:135], v[156:159]
    ds_read_b64_tr_b16 v[240:241], v245 offset:25376
    ds_read_b64_tr_b16 v[242:243], v245 offset:25888
    v_mfma_f32_16x16x32_bf16 v[160:163], v[248:251], v[124:127], v[160:163]
    v_exp_f32 v147, v147
    v_mfma_f32_16x16x32_bf16 v[160:163], v[220:223], v[136:139], v[160:163]
    v_exp_f32 v148, v148
    v_mfma_f32_16x16x32_bf16 v[164:167], v[248:251], v[128:131], v[164:167]
    v_exp_f32 v149, v149
    v_mfma_f32_16x16x32_bf16 v[164:167], v[220:223], v[140:143], v[164:167]
    s_cbranch_vccnz A_rare3
A_back3:
    v_mfma_f32_16x16x32_bf16 v[204:207], v[216:219], v[180:183], v[204:207]
    ds_read_b64_tr_b16 v[248:249], v245 offset:25504
    ds_read_b64_tr_b16 v[250:251], v245 offset:26016
    v_mfma_f32_16x16x32_bf16 v[208:211], v[216:219], v[184:187], v[208:211]
    v_exp_f32 v150, v150
    v_mfma_f32_16x16x32_bf16 v[212:215], v[216:219], v[188:191], v[212:215]
    v_cvt_pk_bf16_f32 v168, v144, v145
    s_waitcnt lgkmcnt(2)
    v_mfma_f32_16x16x32_bf16 v[0:3], v[236:239], v[180:183], v[0:3]
    v_exp_f32 v151, v151
    v_mfma_f32_16x16x32_bf16 v[4:7], v[236:239], v[184:187], v[4:7]
    v_exp_f32 v152, v152
    v_mfma_f32_16x16x32_bf16 v[8:11], v[236:239], v[188:191], v[8:11]
    ds_read_b64_tr_b16 v[236:237], v245 offset:25536
    ds_read_b64_tr_b16 v[238:239], v245 offset:26048
    v_mfma_f32_16x16x32_bf16 v[12:15], v[240:243], v[180:183], v[12:15]
    v_exp_f32 v153, v153
    v_mfma_f32_16x16x32_bf16 v[16:19], v[240:243], v[184:187], v[16:19]
    v_exp_f32 v154, v154
    v_mfma_f32_16x16x32_bf16 v[20:23], v[240:243], v[188:191], v[20:23]
    ds_read_b64_tr_b16 v[240:241], v245 offset:25568
    ds_read_b64_tr_b16 v[242:243], v245 offset:26080
    v_mfma_f32_16x16x32_bf16 v[24:27], v[224:227], v[180:183], v[24:27]
    v_exp_f32 v155, v155
    v_mfma_f32_16x16x32_bf16 v[28:31], v[224:227], v[184:187], v[28:31]
    v_cvt_pk_bf16_f32 v169, v146, v147
    v_cvt_pk_bf16_f32 v172, v148, v149
    v_mfma_f32_16x16x32_bf16 v[32:35], v[224:227], v[188:191], v[32:35]
    v_exp_f32 v156, v156
    v_mfma_f32_16x16x32_bf16 v[36:39], v[228:231], v[180:183], v[36:39]
    ds_read_b128 v[220:223], v244 offset:43520
    v_mfma_f32_16x16x32_bf16 v[40:43], v[228:231], v[184:187], v[40:43]
    ds_read_b128 v[224:227], v244 offset:43584
    v_cvt_pk_bf16_f32 v173, v150, v151
    v_mfma_f32_16x16x32_bf16 v[44:47], v[228:231], v[188:191], v[44:47]
    ds_read_b128 v[228:231], v244 offset:43648
    v_cvt_pk_bf16_f32 v176, v152, v153
    v_mfma_f32_16x16x32_bf16 v[48:51], v[232:235], v[180:183], v[48:51]
    v_exp_f32 v157, v157
    v_mfma_f32_16x16x32_bf16 v[52:55], v[232:235], v[184:187], v[52:55]
    v_cvt_pk_bf16_f32 v177, v154, v155
    v_mfma_f32_16x16x32_bf16 v[56:59], v[232:235], v[188:191], v[56:59]
    ds_read_b128 v[232:235], v244 offset:43712
    s_waitcnt lgkmcnt(4)
    v_mfma_f32_16x16x32_bf16 v[60:63], v[248:251], v[180:183], v[60:63]
    v_exp_f32 v158, v158
    v_mfma_f32_16x16x32_bf16 v[64:67], v[248:251], v[184:187], v[64:67]
    v_exp_f32 v159, v159
    v_mfma_f32_16x16x32_bf16 v[68:71], v[248:251], v[188:191], v[68:71]
    v_exp_f32 v160, v160
    v_mfma_f32_16x16x32_bf16 v[72:75], v[236:239], v[180:183], v[72:75]
    v_exp_f32 v161, v161
    v_mfma_f32_16x16x32_bf16 v[76:79], v[236:239], v[184:187], v[76:79]
    v_exp_f32 v162, v162
    v_mfma_f32_16x16x32_bf16 v[80:83], v[236:239], v[188:191], v[80:83]
    v_exp_f32 v163, v163
    v_mfma_f32_16x16x32_bf16 v[84:87], v[240:243], v[180:183], v[84:87]
    v_exp_f32 v164, v164
    v_mfma_f32_16x16x32_bf16 v[88:91], v[240:243], v[184:187], v[88:91]
    v_exp_f32 v165, v165
    v_mfma_f32_16x16x32_bf16 v[92:95], v[240:243], v[188:191], v[92:95]
    s_waitcnt lgkmcnt(0)
    v_mfma_f32_16x16x32_bf16 v[144:147], v[220:223], v[96:99], v[192:195]
    ds_read_b128 v[236:239], v244 offset:47872
    ds_read_b128 v[240:243], v244 offset:47936
    v_mfma_f32_16x16x32_bf16 v[144:147], v[224:227], v[108:111], v[144:147]
    ds_read_b128 v[248:251], v244 offset:48000
    v_cvt_pk_bf16_f32 v170, v156, v157
    v_mfma_f32_16x16x32_bf16 v[148:151], v[220:223], v[100:103], v[196:199]
    v_exp_f32 v166, v166
    v_mfma_f32_16x16x32_bf16 v[148:151], v[224:227], v[112:115], v[148:151]
    v_exp_f32 v167, v167
    v_mfma_f32_16x16x32_bf16 v[152:155], v[220:223], v[104:107], v[200:203]
    v_cvt_pk_bf16_f32 v171, v158, v159
    v_cvt_pk_bf16_f32 v174, v160, v161
    v_mfma_f32_16x16x32_bf16 v[152:155], v[224:227], v[116:119], v[152:155]
    ds_read_b128 v[220:223], v244 offset:48064
    v_cvt_pk_bf16_f32 v175, v162, v163
    v_mfma_f32_16x16x32_bf16 v[144:147], v[228:231], v[120:123], v[144:147]
    ds_read_b64_tr_b16 v[224:225], v245 offset:33856
    ds_read_b64_tr_b16 v[226:227], v245 offset:34368
    v_mfma_f32_16x16x32_bf16 v[144:147], v[232:235], v[132:135], v[144:147]
    v_cvt_pk_bf16_f32 v178, v164, v165
    v_cvt_pk_bf16_f32 v179, v166, v167
    v_mfma_f32_16x16x32_bf16 v[148:151], v[228:231], v[124:127], v[148:151]
    v_or3_b32 v246, v168, v169, v172
    v_or3_b32 v246, v246, v173, v176
    v_mfma_f32_16x16x32_bf16 v[148:151], v[232:235], v[136:139], v[148:151]
    v_or3_b32 v246, v246, v177, v170
    v_or3_b32 v246, v246, v171, v174
    v_mfma_f32_16x16x32_bf16 v[152:155], v[228:231], v[128:131], v[152:155]
    v_or3_b32 v246, v246, v175, v178
    v_bitop3_b32 v246, v246, v179, s55 bitop3:0xa8
    v_mfma_f32_16x16x32_bf16 v[152:155], v[232:235], v[140:143], v[152:155]
    v_cmp_ne_u32 vcc, 0, v246
    s_waitcnt lgkmcnt(3)
    v_mfma_f32_16x16x32_bf16 v[156:159], v[236:239], v[96:99], v[192:195]
    ds_read_b64_tr_b16 v[228:229], v245 offset:33888
    ds_read_b64_tr_b16 v[230:231], v245 offset:34400
    v_mfma_f32_16x16x32_bf16 v[156:159], v[240:243], v[108:111], v[156:159]
    ds_read_b64_tr_b16 v[232:233], v245 offset:33920
    ds_read_b64_tr_b16 v[234:235], v245 offset:34432
    v_mfma_f32_16x16x32_bf16 v[160:163], v[236:239], v[100:103], v[196:199]
    v_exp_f32 v144, v144
    v_mfma_f32_16x16x32_bf16 v[160:163], v[240:243], v[112:115], v[160:163]
    v_exp_f32 v145, v145
    v_mfma_f32_16x16x32_bf16 v[164:167], v[236:239], v[104:107], v[200:203]
    v_exp_f32 v146, v146
    v_mfma_f32_16x16x32_bf16 v[164:167], v[240:243], v[116:119], v[164:167]
    s_waitcnt lgkmcnt(6)
    v_mfma_f32_16x16x32_bf16 v[156:159], v[248:251], v[120:123], v[156:159]
    ds_read_b64_tr_b16 v[236:237], v245 offset:33792
    ds_read_b64_tr_b16 v[238:239], v245 offset:34304
    v_mfma_f32_16x16x32_bf16 v[156:159], v[220:223], v[132:135], v[156:159]
    ds_read_b64_tr_b16 v[240:241], v245 offset:33824
    ds_read_b64_tr_b16 v[242:243], v245 offset:34336
    v_mfma_f32_16x16x32_bf16 v[160:163], v[248:251], v[124:127], v[160:163]
    v_exp_f32 v147, v147
    v_mfma_f32_16x16x32_bf16 v[160:163], v[220:223], v[136:139], v[160:163]
    v_exp_f32 v148, v148
    v_mfma_f32_16x16x32_bf16 v[164:167], v[248:251], v[128:131], v[164:167]
    v_exp_f32 v149, v149
    v_mfma_f32_16x16x32_bf16 v[164:167], v[220:223], v[140:143], v[164:167]
    s_cbranch_vccnz A_rare4
A_back4:
    v_mfma_f32_16x16x32_bf16 v[204:207], v[216:219], v[168:171], v[204:207]
    ds_read_b64_tr_b16 v[248:249], v245 offset:33952
    ds_read_b64_tr_b16 v[250:251], v245 offset:34464
    v_mfma_f32_16x16x32_bf16 v[208:211], v[216:219], v[172:175], v[208:211]
    v_exp_f32 v150, v150
    v_mfma_f32_16x16x32_bf16 v[212:215], v[216:219], v[176:179], v[212:215]
    v_cvt_pk_bf16_f32 v180, v144, v145
    s_waitcnt lgkmcnt(2)
    v_mfma_f32_16x16x32_bf16 v[0:3], v[236:239], v[168:171], v[0:3]
    v_exp_f32 v151, v151
    v_mfma_f32_16x16x32_bf16 v[4:7], v[236:239], v[172:175], v[4:7]
    v_exp_f32 v152, v152
    v_mfma_f32_16x16x32_bf16 v[8:11], v[236:239], v[176:179], v[8:11]
    ds_read_b64_tr_b16 v[236:237], v245 offset:33984
    ds_read_b64_tr_b16 v[238:239], v245 offset:34496
    v_mfma_f32_16x16x32_bf16 v[12:15], v[240:243], v[168:171], v[12:15]
    v_exp_f32 v153, v153
    v_mfma_f32_16x16x32_bf16 v[16:19], v[240:243], v[172:175], v[16:19]
    v_exp_f32 v154, v154
    v_mfma_f32_16x16x32_bf16 v[20:23], v[240:243], v[176:179], v[20:23]
    ds_read_b64_tr_b16 v[240:241], v245 offset:34016
    ds_read_b64_tr_b16 v[242:243], v245 offset:34528
    v_mfma_f32_16x16x32_bf16 v[24:27], v[224:227], v[168:171], v[24:27]
    v_exp_f32 v155, v155
    v_mfma_f32_16x16x32_bf16 v[28:31], v[224:227], v[172:175], v[28:31]
    v_cvt_pk_bf16_f32 v181, v146, v147
    v_cvt_pk_bf16_f32 v184, v148, v149
    v_mfma_f32_16x16x32_bf16 v[32:35], v[224:227], v[176:179], v[32:35]
    v_exp_f32 v156, v156
    v_mfma_f32_16x16x32_bf16 v[36:39], v[228:231], v[168:171], v[36:39]
    s_barrier
    ds_read_b128 v[220:223], v244 offset:52224
    v_mfma_f32_16x16x32_bf16 v[40:43], v[228:231], v[172:175], v[40:43]
    ds_read_b128 v[224:227], v244 offset:52288
    v_cvt_pk_bf16_f32 v185, v150, v151
    v_mfma_f32_16x16x32_bf16 v[44:47], v[228:231], v[176:179], v[44:47]
    ds_read_b128 v[228:231], v244 offset:52352
    v_cvt_pk_bf16_f32 v188, v152, v153
    v_mfma_f32_16x16x32_bf16 v[48:51], v[232:235], v[168:171], v[48:51]
    v_exp_f32 v157, v157
    v_mfma_f32_16x16x32_bf16 v[52:55], v[232:235], v[172:175], v[52:55]
    v_cvt_pk_bf16_f32 v189, v154, v155
    v_mfma_f32_16x16x32_bf16 v[56:59], v[232:235], v[176:179], v[56:59]
    ds_read_b128 v[232:235], v244 offset:52416
    s_waitcnt lgkmcnt(4)
    v_mfma_f32_16x16x32_bf16 v[60:63], v[248:251], v[168:171], v[60:63]
    v_exp_f32 v158, v158
    v_mfma_f32_16x16x32_bf16 v[64:67], v[248:251], v[172:175], v[64:67]
    v_exp_f32 v159, v159
    v_mfma_f32_16x16x32_bf16 v[68:71], v[248:251], v[176:179], v[68:71]
    v_exp_f32 v160, v160
    v_mfma_f32_16x16x32_bf16 v[72:75], v[236:239], v[168:171], v[72:75]
    v_exp_f32 v161, v161
    v_mfma_f32_16x16x32_bf16 v[76:79], v[236:239], v[172:175], v[76:79]
    v_exp_f32 v162, v162
    v_mfma_f32_16x16x32_bf16 v[80:83], v[236:239], v[176:179], v[80:83]
    v_exp_f32 v163, v163
    v_mfma_f32_16x16x32_bf16 v[84:87], v[240:243], v[168:171], v[84:87]
    v_exp_f32 v164, v164
    v_mfma_f32_16x16x32_bf16 v[88:91], v[240:243], v[172:175], v[88:91]
    v_exp_f32 v165, v165
    v_mfma_f32_16x16x32_bf16 v[92:95], v[240:243], v[176:179], v[92:95]
    s_waitcnt lgkmcnt(0)
    v_mfma_f32_16x16x32_bf16 v[144:147], v[220:223], v[96:99], v[192:195]
    ds_read_b128 v[236:239], v244 offset:56576
    ds_read_b128 v[240:243], v244 offset:56640
    v_mfma_f32_16x16x32_bf16 v[144:147], v[224:227], v[108:111], v[144:147]
    ds_read_b128 v[248:251], v244 offset:56704
    v_cvt_pk_bf16_f32 v182, v156, v157
    v_mfma_f32_16x16x32_bf16 v[148:151], v[220:223], v[100:103], v[196:199]
    v_exp_f32 v166, v166
    v_mfma_f32_16x16x32_bf16 v[148:151], v[224:227], v[112:115], v[148:151]
    v_exp_f32 v167, v167
    v_mfma_f32_16x16x32_bf16 v[152:155], v[220:223], v[104:107], v[200:203]
    v_cvt_pk_bf16_f32 v183, v158, v159
    v_cvt_pk_bf16_f32 v186, v160, v161
    v_mfma_f32_16x16x32_bf16 v[152:155], v[224:227], v[116:119], v[152:155]
    ds_read_b128 v[220:223], v244 offset:56768
    v_cvt_pk_bf16_f32 v187, v162, v163
    v_mfma_f32_16x16x32_bf16 v[144:147], v[228:231], v[120:123], v[144:147]
    ds_read_b64_tr_b16 v[224:225], v245 offset:42304
    ds_read_b64_tr_b16 v[226:227], v245 offset:42816
    v_mfma_f32_16x16x32_bf16 v[144:147], v[232:235], v[132:135], v[144:147]
    v_cvt_pk_bf16_f32 v190, v164, v165
    v_cvt_pk_bf16_f32 v191, v166, v167
    v_mfma_f32_16x16x32_bf16 v[148:151], v[228:231], v[124:127], v[148:151]
    v_or3_b32 v246, v180, v181, v184
    v_or3_b32 v246, v246, v185, v188
    v_mfma_f32_16x16x32_bf16 v[148:151], v[232:235], v[136:139], v[148:151]
    v_or3_b32 v246, v246, v189, v182
    v_or3_b32 v246, v246, v183, v186
    v_mfma_f32_16x16x32_bf16 v[152:155], v[228:231], v[128:131], v[152:155]
    v_or3_b32 v246, v246, v187, v190
    v_bitop3_b32 v246, v246, v191, s55 bitop3:0xa8
    v_mfma_f32_16x16x32_bf16 v[152:155], v[232:235], v[140:143], v[152:155]
    v_cmp_ne_u32 vcc, 0, v246
    s_waitcnt lgkmcnt(3)
    v_mfma_f32_16x16x32_bf16 v[156:159], v[236:239], v[96:99], v[192:195]
    ds_read_b64_tr_b16 v[228:229], v245 offset:42336
    ds_read_b64_tr_b16 v[230:231], v245 offset:42848
    v_mfma_f32_16x16x32_bf16 v[156:159], v[240:243], v[108:111], v[156:159]
    ds_read_b64_tr_b16 v[232:233], v245 offset:42368
    ds_read_b64_tr_b16 v[234:235], v245 offset:42880
    v_mfma_f32_16x16x32_bf16 v[160:163], v[236:239], v[100:103], v[196:199]
    v_exp_f32 v144, v144
    v_mfma_f32_16x16x32_bf16 v[160:163], v[240:243], v[112:115], v[160:163]
    v_exp_f32 v145, v145
    v_mfma_f32_16x16x32_bf16 v[164:167], v[236:239], v[104:107], v[200:203]
    v_exp_f32 v146, v146
    v_mfma_f32_16x16x32_bf16 v[164:167], v[240:243], v[116:119], v[164:167]
    s_waitcnt lgkmcnt(6)
    v_mfma_f32_16x16x32_bf16 v[156:159], v[248:251], v[120:123], v[156:159]
    ds_read_b64_tr_b16 v[236:237], v245 offset:42240
    ds_read_b64_tr_b16 v[238:239], v245 offset:42752
    v_mfma_f32_16x16x32_bf16 v[156:159], v[220:223], v[132:135], v[156:159]
    ds_read_b64_tr_b16 v[240:241], v245 offset:42272
    ds_read_b64_tr_b16 v[242:243], v245 offset:42784
    v_mfma_f32_16x16x32_bf16 v[160:163], v[248:251], v[124:127], v[160:163]
    v_exp_f32 v147, v147
    v_mfma_f32_16x16x32_bf16 v[160:163], v[220:223], v[136:139], v[160:163]
    v_exp_f32 v148, v148
    v_mfma_f32_16x16x32_bf16 v[164:167], v[248:251], v[128:131], v[164:167]
    v_exp_f32 v149, v149
    v_mfma_f32_16x16x32_bf16 v[164:167], v[220:223], v[140:143], v[164:167]
    s_cbranch_vccnz A_rare5
A_back5:
    v_mfma_f32_16x16x32_bf16 v[204:207], v[216:219], v[180:183], v[204:207]
    ds_read_b64_tr_b16 v[248:249], v245 offset:42400
    ds_read_b64_tr_b16 v[250:251], v245 offset:42912
    v_mfma_f32_16x16x32_bf16 v[208:211], v[216:219], v[184:187], v[208:211]
    v_exp_f32 v150, v150
    v_mfma_f32_16x16x32_bf16 v[212:215], v[216:219], v[188:191], v[212:215]
    v_cvt_pk_bf16_f32 v168, v144, v145
    s_waitcnt lgkmcnt(2)
    v_mfma_f32_16x16x32_bf16 v[0:3], v[236:239], v[180:183], v[0:3]
    v_exp_f32 v151, v151
    v_mfma_f32_16x16x32_bf16 v[4:7], v[236:239], v[184:187], v[4:7]
    v_exp_f32 v152, v152
    v_mfma_f32_16x16x32_bf16 v[8:11], v[236:239], v[188:191], v[8:11]
    ds_read_b64_tr_b16 v[236:237], v245 offset:42432
    ds_read_b64_tr_b16 v[238:239], v245 offset:42944
    v_mfma_f32_16x16x32_bf16 v[12:15], v[240:243], v[180:183], v[12:15]
    v_exp_f32 v153, v153
    v_mfma_f32_16x16x32_bf16 v[16:19], v[240:243], v[184:187], v[16:19]
    v_exp_f32 v154, v154
    v_mfma_f32_16x16x32_bf16 v[20:23], v[240:243], v[188:191], v[20:23]
    ds_read_b64_tr_b16 v[240:241], v245 offset:42464
    ds_read_b64_tr_b16 v[242:243], v245 offset:42976
    v_mfma_f32_16x16x32_bf16 v[24:27], v[224:227], v[180:183], v[24:27]
    v_exp_f32 v155, v155
    v_mfma_f32_16x16x32_bf16 v[28:31], v[224:227], v[184:187], v[28:31]
    v_cvt_pk_bf16_f32 v169, v146, v147
    v_cvt_pk_bf16_f32 v172, v148, v149
    v_mfma_f32_16x16x32_bf16 v[32:35], v[224:227], v[188:191], v[32:35]
    v_exp_f32 v156, v156
    v_mfma_f32_16x16x32_bf16 v[36:39], v[228:231], v[180:183], v[36:39]
    ds_read_b128 v[220:223], v244 offset:60928
    v_mfma_f32_16x16x32_bf16 v[40:43], v[228:231], v[184:187], v[40:43]
    ds_read_b128 v[224:227], v244 offset:60992
    v_cvt_pk_bf16_f32 v173, v150, v151
    v_mfma_f32_16x16x32_bf16 v[44:47], v[228:231], v[188:191], v[44:47]
    ds_read_b128 v[228:231], v244 offset:61056
    v_cvt_pk_bf16_f32 v176, v152, v153
    v_mfma_f32_16x16x32_bf16 v[48:51], v[232:235], v[180:183], v[48:51]
    v_exp_f32 v157, v157
    v_mfma_f32_16x16x32_bf16 v[52:55], v[232:235], v[184:187], v[52:55]
    v_cvt_pk_bf16_f32 v177, v154, v155
    v_mfma_f32_16x16x32_bf16 v[56:59], v[232:235], v[188:191], v[56:59]
    ds_read_b128 v[232:235], v244 offset:61120
    s_waitcnt lgkmcnt(4)
    v_mfma_f32_16x16x32_bf16 v[60:63], v[248:251], v[180:183], v[60:63]
    v_exp_f32 v158, v158
    v_mfma_f32_16x16x32_bf16 v[64:67], v[248:251], v[184:187], v[64:67]
    v_exp_f32 v159, v159
    v_mfma_f32_16x16x32_bf16 v[68:71], v[248:251], v[188:191], v[68:71]
    v_exp_f32 v160, v160
    v_mfma_f32_16x16x32_bf16 v[72:75], v[236:239], v[180:183], v[72:75]
    v_exp_f32 v161, v161
    v_mfma_f32_16x16x32_bf16 v[76:79], v[236:239], v[184:187], v[76:79]
    v_exp_f32 v162, v162
    v_mfma_f32_16x16x32_bf16 v[80:83], v[236:239], v[188:191], v[80:83]
    v_exp_f32 v163, v163
    v_mfma_f32_16x16x32_bf16 v[84:87], v[240:243], v[180:183], v[84:87]
    v_exp_f32 v164, v164
    v_mfma_f32_16x16x32_bf16 v[88:91], v[240:243], v[184:187], v[88:91]
    v_exp_f32 v165, v165
    v_mfma_f32_16x16x32_bf16 v[92:95], v[240:243], v[188:191], v[92:95]
    s_waitcnt lgkmcnt(0)
    v_mfma_f32_16x16x32_bf16 v[144:147], v[220:223], v[96:99], v[192:195]
    ds_read_b128 v[236:239], v244 offset:65280
    ds_read_b128 v[240:243], v244 offset:65344
    v_mfma_f32_16x16x32_bf16 v[144:147], v[224:227], v[108:111], v[144:147]
    ds_read_b128 v[248:251], v244 offset:65408
    v_cvt_pk_bf16_f32 v170, v156, v157
    v_mfma_f32_16x16x32_bf16 v[148:151], v[220:223], v[100:103], v[196:199]
    v_exp_f32 v166, v166
    v_mfma_f32_16x16x32_bf16 v[148:151], v[224:227], v[112:115], v[148:151]
    v_exp_f32 v167, v167
    v_mfma_f32_16x16x32_bf16 v[152:155], v[220:223], v[104:107], v[200:203]
    v_cvt_pk_bf16_f32 v171, v158, v159
    v_cvt_pk_bf16_f32 v174, v160, v161
    v_mfma_f32_16x16x32_bf16 v[152:155], v[224:227], v[116:119], v[152:155]
    ds_read_b128 v[220:223], v244 offset:65472
    v_cvt_pk_bf16_f32 v175, v162, v163
    v_mfma_f32_16x16x32_bf16 v[144:147], v[228:231], v[120:123], v[144:147]
    ds_read_b64_tr_b16 v[224:225], v245 offset:50752
    ds_read_b64_tr_b16 v[226:227], v245 offset:51264
    v_mfma_f32_16x16x32_bf16 v[144:147], v[232:235], v[132:135], v[144:147]
    v_cvt_pk_bf16_f32 v178, v164, v165
    v_cvt_pk_bf16_f32 v179, v166, v167
    v_mfma_f32_16x16x32_bf16 v[148:151], v[228:231], v[124:127], v[148:151]
    v_or3_b32 v246, v168, v169, v172
    v_or3_b32 v246, v246, v173, v176
    v_mfma_f32_16x16x32_bf16 v[148:151], v[232:235], v[136:139], v[148:151]
    v_or3_b32 v246, v246, v177, v170
    v_or3_b32 v246, v246, v171, v174
    v_mfma_f32_16x16x32_bf16 v[152:155], v[228:231], v[128:131], v[152:155]
    v_or3_b32 v246, v246, v175, v178
    v_bitop3_b32 v246, v246, v179, s55 bitop3:0xa8
    v_mfma_f32_16x16x32_bf16 v[152:155], v[232:235], v[140:143], v[152:155]
    v_cmp_ne_u32 vcc, 0, v246
    s_waitcnt lgkmcnt(3)
    v_mfma_f32_16x16x32_bf16 v[156:159], v[236:239], v[96:99], v[192:195]
    ds_read_b64_tr_b16 v[228:229], v245 offset:50784
    ds_read_b64_tr_b16 v[230:231], v245 offset:51296
    v_mfma_f32_16x16x32_bf16 v[156:159], v[240:243], v[108:111], v[156:159]
    ds_read_b64_tr_b16 v[232:233], v245 offset:50816
    ds_read_b64_tr_b16 v[234:235], v245 offset:51328
    v_mfma_f32_16x16x32_bf16 v[160:163], v[236:239], v[100:103], v[196:199]
    v_exp_f32 v144, v144
    v_mfma_f32_16x16x32_bf16 v[160:163], v[240:243], v[112:115], v[160:163]
    v_exp_f32 v145, v145
    v_mfma_f32_16x16x32_bf16 v[164:167], v[236:239], v[104:107], v[200:203]
    v_exp_f32 v146, v146
    v_mfma_f32_16x16x32_bf16 v[164:167], v[240:243], v[116:119], v[164:167]
    s_waitcnt lgkmcnt(6)
    v_mfma_f32_16x16x32_bf16 v[156:159], v[248:251], v[120:123], v[156:159]
    ds_read_b64_tr_b16 v[236:237], v245 offset:50688
    ds_read_b64_tr_b16 v[238:239], v245 offset:51200
    v_mfma_f32_16x16x32_bf16 v[156:159], v[220:223], v[132:135], v[156:159]
    ds_read_b64_tr_b16 v[240:241], v245 offset:50720
    ds_read_b64_tr_b16 v[242:243], v245 offset:51232
    v_mfma_f32_16x16x32_bf16 v[160:163], v[248:251], v[124:127], v[160:163]
    v_exp_f32 v147, v147
    v_mfma_f32_16x16x32_bf16 v[160:163], v[220:223], v[136:139], v[160:163]
    v_exp_f32 v148, v148
    v_mfma_f32_16x16x32_bf16 v[164:167], v[248:251], v[128:131], v[164:167]
    v_exp_f32 v149, v149
    v_mfma_f32_16x16x32_bf16 v[164:167], v[220:223], v[140:143], v[164:167]
    s_cbranch_vccnz A_rare6
A_back6:
    v_mfma_f32_16x16x32_bf16 v[204:207], v[216:219], v[168:171], v[204:207]
    ds_read_b64_tr_b16 v[248:249], v245 offset:50848
    ds_read_b64_tr_b16 v[250:251], v245 offset:51360
    v_mfma_f32_16x16x32_bf16 v[208:211], v[216:219], v[172:175], v[208:211]
    v_exp_f32 v150, v150
    v_mfma_f32_16x16x32_bf16 v[212:215], v[216:219], v[176:179], v[212:215]
    v_cvt_pk_bf16_f32 v180, v144, v145
    s_waitcnt lgkmcnt(2)
    v_mfma_f32_16x16x32_bf16 v[0:3], v[236:239], v[168:171], v[0:3]
    v_exp_f32 v151, v151
    v_mfma_f32_16x16x32_bf16 v[4:7], v[236:239], v[172:175], v[4:7]
    v_exp_f32 v152, v152
    v_mfma_f32_16x16x32_bf16 v[8:11], v[236:239], v[176:179], v[8:11]
    ds_read_b64_tr_b16 v[236:237], v245 offset:50880
    ds_read_b64_tr_b16 v[238:239], v245 offset:51392
    v_mfma_f32_16x16x32_bf16 v[12:15], v[240:243], v[168:171], v[12:15]
    v_exp_f32 v153, v153
    v_mfma_f32_16x16x32_bf16 v[16:19], v[240:243], v[172:175], v[16:19]
    v_exp_f32 v154, v154
    v_mfma_f32_16x16x32_bf16 v[20:23], v[240:243], v[176:179], v[20:23]
    ds_read_b64_tr_b16 v[240:241], v245 offset:50912
    ds_read_b64_tr_b16 v[242:243], v245 offset:51424
    v_mfma_f32_16x16x32_bf16 v[24:27], v[224:227], v[168:171], v[24:27]
    v_exp_f32 v155, v155
    v_mfma_f32_16x16x32_bf16 v[28:31], v[224:227], v[172:175], v[28:31]
    v_cvt_pk_bf16_f32 v181, v146, v147
    v_cvt_pk_bf16_f32 v184, v148, v149
    v_mfma_f32_16x16x32_bf16 v[32:35], v[224:227], v[176:179], v[32:35]
    v_exp_f32 v156, v156
    v_mfma_f32_16x16x32_bf16 v[36:39], v[228:231], v[168:171], v[36:39]
    s_cmp_eq_u32 s53, 3
    s_cbranch_scc1 A_nob16
    s_barrier
A_nob16:
    ds_read_b128 v[220:223], v244 offset:0
    v_mfma_f32_16x16x32_bf16 v[40:43], v[228:231], v[172:175], v[40:43]
    ds_read_b128 v[224:227], v244 offset:64
    v_cvt_pk_bf16_f32 v185, v150, v151
    v_mfma_f32_16x16x32_bf16 v[44:47], v[228:231], v[176:179], v[44:47]
    ds_read_b128 v[228:231], v244 offset:128
    v_cvt_pk_bf16_f32 v188, v152, v153
    v_mfma_f32_16x16x32_bf16 v[48:51], v[232:235], v[168:171], v[48:51]
    v_exp_f32 v157, v157
    v_mfma_f32_16x16x32_bf16 v[52:55], v[232:235], v[172:175], v[52:55]
    v_cvt_pk_bf16_f32 v189, v154, v155
    v_mfma_f32_16x16x32_bf16 v[56:59], v[232:235], v[176:179], v[56:59]
    ds_read_b128 v[232:235], v244 offset:192
    s_waitcnt lgkmcnt(4)
    v_mfma_f32_16x16x32_bf16 v[60:63], v[248:251], v[168:171], v[60:63]
    v_exp_f32 v158, v158
    v_mfma_f32_16x16x32_bf16 v[64:67], v[248:251], v[172:175], v[64:67]
    v_exp_f32 v159, v159
    v_mfma_f32_16x16x32_bf16 v[68:71], v[248:251], v[176:179], v[68:71]
    v_exp_f32 v160, v160
    v_mfma_f32_16x16x32_bf16 v[72:75], v[236:239], v[168:171], v[72:75]
    v_exp_f32 v161, v161
    v_mfma_f32_16x16x32_bf16 v[76:79], v[236:239], v[172:175], v[76:79]
    v_exp_f32 v162, v162
    v_mfma_f32_16x16x32_bf16 v[80:83], v[236:239], v[176:179], v[80:83]
    v_exp_f32 v163, v163
    v_mfma_f32_16x16x32_bf16 v[84:87], v[240:243], v[168:171], v[84:87]
    v_exp_f32 v164, v164
    v_mfma_f32_16x16x32_bf16 v[88:91], v[240:243], v[172:175], v[88:91]
    v_exp_f32 v165, v165
    v_mfma_f32_16x16x32_bf16 v[92:95], v[240:243], v[176:179], v[92:95]
    s_add_u32 s53, s53, 1
    s_cmp_eq_u32 s53, 4
    s_cbranch_scc1 A_last
    s_waitcnt lgkmcnt(0)
    v_mfma_f32_16x16x32_bf16 v[144:147], v[220:223], v[96:99], v[192:195]
    ds_read_b128 v[236:239], v244 offset:4352
    ds_read_b128 v[240:243], v244 offset:4416
    v_mfma_f32_16x16x32_bf16 v[144:147], v[224:227], v[108:111], v[144:147]
    ds_read_b128 v[248:251], v244 offset:4480
    v_cvt_pk_bf16_f32 v182, v156, v157
    v_mfma_f32_16x16x32_bf16 v[148:151], v[220:223], v[100:103], v[196:199]
    v_exp_f32 v166, v166
    v_mfma_f32_16x16x32_bf16 v[148:151], v[224:227], v[112:115], v[148:151]
    v_exp_f32 v167, v167
    v_mfma_f32_16x16x32_bf16 v[152:155], v[220:223], v[104:107], v[200:203]
    v_cvt_pk_bf16_f32 v183, v158, v159
    v_cvt_pk_bf16_f32 v186, v160, v161
    v_mfma_f32_16x16x32_bf16 v[152:155], v[224:227], v[116:119], v[152:155]
    ds_read_b128 v[220:223], v244 offset:4544
    v_cvt_pk_bf16_f32 v187, v162, v163
    v_mfma_f32_16x16x32_bf16 v[144:147], v[228:231], v[120:123], v[144:147]
    ds_read_b64_tr_b16 v[224:225], v245 offset:59200
    ds_read_b64_tr_b16 v[226:227], v245 offset:59712
    v_mfma_f32_16x16x32_bf16 v[144:147], v[232:235], v[132:135], v[144:147]
    v_cvt_pk_bf16_f32 v190, v164, v165
    v_cvt_pk_bf16_f32 v191, v166, v167
    v_mfma_f32_16x16x32_bf16 v[148:151], v[228:231], v[124:127], v[148:151]
    v_or3_b32 v246, v180, v181, v184
    v_or3_b32 v246, v246, v185, v188
    v_mfma_f32_16x16x32_bf16 v[148:151], v[232:235], v[136:139], v[148:151]
    v_or3_b32 v246, v246, v189, v182
    v_or3_b32 v246, v246, v183, v186
    v_mfma_f32_16x16x32_bf16 v[152:155], v[228:231], v[128:131], v[152:155]
    v_or3_b32 v246, v246, v187, v190
    v_bitop3_b32 v246, v246, v191, s55 bitop3:0xa8
    v_mfma_f32_16x16x32_bf16 v[152:155], v[232:235], v[140:143], v[152:155]
    v_cmp_ne_u32 vcc, 0, v246
    s_waitcnt lgkmcnt(3)
    v_mfma_f32_16x16x32_bf16 v[156:159], v[236:239], v[96:99], v[192:195]
    ds_read_b64_tr_b16 v[228:229], v245 offset:59232
    ds_read_b64_tr_b16 v[230:231], v245 offset:59744
    v_mfma_f32_16x16x32_bf16 v[156:159], v[240:243], v[108:111], v[156:159]
    ds_read_b64_tr_b16 v[232:233], v245 offset:59264
    ds_read_b64_tr_b16 v[234:235], v245 offset:59776
    v_mfma_f32_16x16x32_bf16 v[160:163], v[236:239], v[100:103], v[196:199]
    v_exp_f32 v144, v144
    v_mfma_f32_16x16x32_bf16 v[160:163], v[240:243], v[112:115], v[160:163]
    v_exp_f32 v145, v145
    v_mfma_f32_16x16x32_bf16 v[164:167], v[236:239], v[104:107], v[200:203]
    v_exp_f32 v146, v146
    v_mfma_f32_16x16x32_bf16 v[164:167], v[240:243], v[116:119], v[164:167]
    s_waitcnt lgkmcnt(6)
    v_mfma_f32_16x16x32_bf16 v[156:159], v[248:251], v[120:123], v[156:159]
    ds_read_b64_tr_b16 v[236:237], v245 offset:59136
    ds_read_b64_tr_b16 v[238:239], v245 offset:59648
    v_mfma_f32_16x16x32_bf16 v[156:159], v[220:223], v[132:135], v[156:159]
    ds_read_b64_tr_b16 v[240:241], v245 offset:59168
    ds_read_b64_tr_b16 v[242:243], v245 offset:59680
    v_mfma_f32_16x16x32_bf16 v[160:163], v[248:251], v[124:127], v[160:163]
    v_exp_f32 v147, v147
    v_mfma_f32_16x16x32_bf16 v[160:163], v[220:223], v[136:139], v[160:163]
    v_exp_f32 v148, v148
    v_mfma_f32_16x16x32_bf16 v[164:167], v[248:251], v[128:131], v[164:167]
    v_exp_f32 v149, v149
    v_mfma_f32_16x16x32_bf16 v[164:167], v[220:223], v[140:143], v[164:167]
    s_cbranch_vccnz A_rare7
A_back7:
    v_mfma_f32_16x16x32_bf16 v[204:207], v[216:219], v[180:183], v[204:207]
    ds_read_b64_tr_b16 v[248:249], v245 offset:59296
    ds_read_b64_tr_b16 v[250:251], v245 offset:59808
    v_mfma_f32_16x16x32_bf16 v[208:211], v[216:219], v[184:187], v[208:211]
    v_exp_f32 v150, v150
    v_mfma_f32_16x16x32_bf16 v[212:215], v[216:219], v[188:191], v[212:215]
    v_cvt_pk_bf16_f32 v168, v144, v145
    s_waitcnt lgkmcnt(2)
    v_mfma_f32_16x16x32_bf16 v[0:3], v[236:239], v[180:183], v[0:3]
    v_exp_f32 v151, v151
    v_mfma_f32_16x16x32_bf16 v[4:7], v[236:239], v[184:187], v[4:7]
    v_exp_f32 v152, v152
    v_mfma_f32_16x16x32_bf16 v[8:11], v[236:239], v[188:191], v[8:11]
    ds_read_b64_tr_b16 v[236:237], v245 offset:59328
    ds_read_b64_tr_b16 v[238:239], v245 offset:59840
    v_mfma_f32_16x16x32_bf16 v[12:15], v[240:243], v[180:183], v[12:15]
    v_exp_f32 v153, v153
    v_mfma_f32_16x16x32_bf16 v[16:19], v[240:243], v[184:187], v[16:19]
    v_exp_f32 v154, v154
    v_mfma_f32_16x16x32_bf16 v[20:23], v[240:243], v[188:191], v[20:23]
    ds_read_b64_tr_b16 v[240:241], v245 offset:59360
    ds_read_b64_tr_b16 v[242:243], v245 offset:59872
    v_mfma_f32_16x16x32_bf16 v[24:27], v[224:227], v[180:183], v[24:27]
    v_exp_f32 v155, v155
    v_mfma_f32_16x16x32_bf16 v[28:31], v[224:227], v[184:187], v[28:31]
    v_cvt_pk_bf16_f32 v169, v146, v147
    v_cvt_pk_bf16_f32 v172, v148, v149
    v_mfma_f32_16x16x32_bf16 v[32:35], v[224:227], v[188:191], v[32:35]
    v_exp_f32 v156, v156
    v_mfma_f32_16x16x32_bf16 v[36:39], v[228:231], v[180:183], v[36:39]
    ds_read_b128 v[220:223], v244 offset:8704
    v_mfma_f32_16x16x32_bf16 v[40:43], v[228:231], v[184:187], v[40:43]
    ds_read_b128 v[224:227], v244 offset:8768
    v_cvt_pk_bf16_f32 v173, v150, v151
    v_mfma_f32_16x16x32_bf16 v[44:47], v[228:231], v[188:191], v[44:47]
    ds_read_b128 v[228:231], v244 offset:8832
    v_cvt_pk_bf16_f32 v176, v152, v153
    v_mfma_f32_16x16x32_bf16 v[48:51], v[232:235], v[180:183], v[48:51]
    v_exp_f32 v157, v157
    v_mfma_f32_16x16x32_bf16 v[52:55], v[232:235], v[184:187], v[52:55]
    v_cvt_pk_bf16_f32 v177, v154, v155
    v_mfma_f32_16x16x32_bf16 v[56:59], v[232:235], v[188:191], v[56:59]
    ds_read_b128 v[232:235], v244 offset:8896
    s_waitcnt lgkmcnt(4)
    v_mfma_f32_16x16x32_bf16 v[60:63], v[248:251], v[180:183], v[60:63]
    v_exp_f32 v158, v158
    v_mfma_f32_16x16x32_bf16 v[64:67], v[248:251], v[184:187], v[64:67]
    v_exp_f32 v159, v159
    v_mfma_f32_16x16x32_bf16 v[68:71], v[248:251], v[188:191], v[68:71]
    v_exp_f32 v160, v160
    v_mfma_f32_16x16x32_bf16 v[72:75], v[236:239], v[180:183], v[72:75]
    v_exp_f32 v161, v161
    v_mfma_f32_16x16x32_bf16 v[76:79], v[236:239], v[184:187], v[76:79]
    v_exp_f32 v162, v162
    v_mfma_f32_16x16x32_bf16 v[80:83], v[236:239], v[188:191], v[80:83]
    v_exp_f32 v163, v163
    v_mfma_f32_16x16x32_bf16 v[84:87], v[240:243], v[180:183], v[84:87]
    v_exp_f32 v164, v164
    v_mfma_f32_16x16x32_bf16 v[88:91], v[240:243], v[184:187], v[88:91]
    v_exp_f32 v165, v165
    v_mfma_f32_16x16x32_bf16 v[92:95], v[240:243], v[188:191], v[92:95]
    s_branch A_loop
A_last:
    s_waitcnt lgkmcnt(2)
    ds_read_b64_tr_b16 v[224:225], v245 offset:59200
    ds_read_b64_tr_b16 v[226:227], v245 offset:59712
    ds_read_b64_tr_b16 v[228:229], v245 offset:59232
    ds_read_b64_tr_b16 v[230:231], v245 offset:59744
    ds_read_b64_tr_b16 v[232:233], v245 offset:59264
    ds_read_b64_tr_b16 v[234:235], v245 offset:59776
    ds_read_b64_tr_b16 v[236:237], v245 offset:59136
    ds_read_b64_tr_b16 v[238:239], v245 offset:59648
    ds_read_b64_tr_b16 v[240:241], v245 offset:59168
    ds_read_b64_tr_b16 v[242:243], v245 offset:59680
    v_cvt_pk_bf16_f32 v182, v156, v157
    v_exp_f32 v166, v166
    v_exp_f32 v167, v167
    v_cvt_pk_bf16_f32 v183, v158, v159
    v_cvt_pk_bf16_f32 v186, v160, v161
    v_cvt_pk_bf16_f32 v187, v162, v163
    v_cvt_pk_bf16_f32 v190, v164, v165
    v_cvt_pk_bf16_f32 v191, v166, v167
    v_or3_b32 v246, v180, v181, v184
    v_or3_b32 v246, v246, v185, v188
    v_or3_b32 v246, v246, v189, v182
    v_or3_b32 v246, v246, v183, v186
    v_or3_b32 v246, v246, v187, v190
    v_bitop3_b32 v246, v246, v191, s55 bitop3:0xa8
    v_cmp_ne_u32 vcc, 0, v246
    s_cbranch_vccnz A_rareL
A_backL:
    v_mfma_f32_16x16x32_bf16 v[204:207], v[216:219], v[180:183], v[204:207]
    ds_read_b64_tr_b16 v[248:249], v245 offset:59296
    ds_read_b64_tr_b16 v[250:251], v245 offset:59808
    v_mfma_f32_16x16x32_bf16 v[208:211], v[216:219], v[184:187], v[208:211]
    v_mfma_f32_16x16x32_bf16 v[212:215], v[216:219], v[188:191], v[212:215]
    s_waitcnt lgkmcnt(2)
    v_mfma_f32_16x16x32_bf16 v[0:3], v[236:239], v[180:183], v[0:3]
    v_lshlrev_b32 v247, 4, v255
    s_mul_i32 s46, s45, 12
    s_mul_i32 s47, s44, 3
    s_add_u32 s46, s46, s47
    s_lshl_b32 s46, s46, 5
    s_add_u32 s46, s46, s50
    s_lshl_b32 s46, s46, 12
    s_add_u32 s47, s46, 131072
    s_add_u32 s48, s46, 262144
    v_mfma_f32_16x16x32_bf16 v[4:7], v[236:239], v[184:187], v[4:7]
    v_mfma_f32_16x16x32_bf16 v[8:11], v[236:239], v[188:191], v[8:11]
    ds_read_b64_tr_b16 v[236:237], v245 offset:59328
    ds_read_b64_tr_b16 v[238:239], v245 offset:59840
    v_mfma_f32_16x16x32_bf16 v[12:15], v[240:243], v[180:183], v[12:15]
    v_rcp_f32 v192, v204
    v_mfma_f32_16x16x32_bf16 v[16:19], v[240:243], v[184:187], v[16:19]
    v_rcp_f32 v194, v208
    v_mfma_f32_16x16x32_bf16 v[20:23], v[240:243], v[188:191], v[20:23]
    ds_read_b64_tr_b16 v[240:241], v245 offset:59360
    ds_read_b64_tr_b16 v[242:243], v245 offset:59872
    v_rcp_f32 v196, v212
    v_mfma_f32_16x16x32_bf16 v[24:27], v[224:227], v[180:183], v[24:27]
    v_mfma_f32_16x16x32_bf16 v[28:31], v[224:227], v[184:187], v[28:31]
    v_mfma_f32_16x16x32_bf16 v[32:35], v[224:227], v[188:191], v[32:35]
    v_pk_mul_f32 v[0:1], v[0:1], v[192:193] op_sel_hi:[1,0]
    v_pk_mul_f32 v[2:3], v[2:3], v[192:193] op_sel_hi:[1,0]
    v_pk_mul_f32 v[12:13], v[12:13], v[192:193] op_sel_hi:[1,0]
    v_pk_mul_f32 v[14:15], v[14:15], v[192:193] op_sel_hi:[1,0]
    v_mfma_f32_16x16x32_bf16 v[36:39], v[228:231], v[180:183], v[36:39]
    v_cvt_pk_bf16_f32 v96, v0, v1
    v_cvt_pk_bf16_f32 v97, v2, v3
    v_cvt_pk_bf16_f32 v98, v12, v13
    v_cvt_pk_bf16_f32 v99, v14, v15
    buffer_store_dwordx4 v[96:99], v247, s[36:39], s46 offen offset:0 sc1
    v_mfma_f32_16x16x32_bf16 v[40:43], v[228:231], v[184:187], v[40:43]
    v_pk_mul_f32 v[4:5], v[4:5], v[194:195] op_sel_hi:[1,0]
    v_pk_mul_f32 v[6:7], v[6:7], v[194:195] op_sel_hi:[1,0]
    v_pk_mul_f32 v[16:17], v[16:17], v[194:195] op_sel_hi:[1,0]
    v_pk_mul_f32 v[18:19], v[18:19], v[194:195] op_sel_hi:[1,0]
    v_mfma_f32_16x16x32_bf16 v[44:47], v[228:231], v[188:191], v[44:47]
    v_cvt_pk_bf16_f32 v112, v4, v5
    v_cvt_pk_bf16_f32 v113, v6, v7
    v_cvt_pk_bf16_f32 v114, v16, v17
    v_cvt_pk_bf16_f32 v115, v18, v19
    buffer_store_dwordx4 v[112:115], v247, s[36:39], s47 offen offset:0 sc1
    v_mfma_f32_16x16x32_bf16 v[48:51], v[232:235], v[180:183], v[48:51]
    v_pk_mul_f32 v[8:9], v[8:9], v[196:197] op_sel_hi:[1,0]
    v_pk_mul_f32 v[10:11], v[10:11], v[196:197] op_sel_hi:[1,0]
    v_pk_mul_f32 v[20:21], v[20:21], v[196:197] op_sel_hi:[1,0]
    v_pk_mul_f32 v[22:23], v[22:23], v[196:197] op_sel_hi:[1,0]
    v_mfma_f32_16x16x32_bf16 v[52:55], v[232:235], v[184:187], v[52:55]
    v_cvt_pk_bf16_f32 v128, v8, v9
    v_cvt_pk_bf16_f32 v129, v10, v11
    v_cvt_pk_bf16_f32 v130, v20, v21
    v_cvt_pk_bf16_f32 v131, v22, v23
    buffer_store_dwordx4 v[128:131], v247, s[36:39], s48 offen offset:0 sc1
    v_mfma_f32_16x16x32_bf16 v[56:59], v[232:235], v[188:191], v[56:59]
    v_pk_mul_f32 v[24:25], v[24:25], v[192:193] op_sel_hi:[1,0]
    v_pk_mul_f32 v[26:27], v[26:27], v[192:193] op_sel_hi:[1,0]
    v_pk_mul_f32 v[36:37], v[36:37], v[192:193] op_sel_hi:[1,0]
    v_pk_mul_f32 v[38:39], v[38:39], v[192:193] op_sel_hi:[1,0]
    s_waitcnt lgkmcnt(0)
    v_mfma_f32_16x16x32_bf16 v[60:63], v[248:251], v[180:183], v[60:63]
    v_cvt_pk_bf16_f32 v100, v24, v25
    v_cvt_pk_bf16_f32 v101, v26, v27
    v_cvt_pk_bf16_f32 v102, v36, v37
    v_cvt_pk_bf16_f32 v103, v38, v39
    buffer_store_dwordx4 v[100:103], v247, s[36:39], s46 offen offset:1024 sc1
    v_mfma_f32_16x16x32_bf16 v[64:67], v[248:251], v[184:187], v[64:67]
    v_pk_mul_f32 v[28:29], v[28:29], v[194:195] op_sel_hi:[1,0]
    v_pk_mul_f32 v[30:31], v[30:31], v[194:195] op_sel_hi:[1,0]
    v_pk_mul_f32 v[40:41], v[40:41], v[194:195] op_sel_hi:[1,0]
    v_pk_mul_f32 v[42:43], v[42:43], v[194:195] op_sel_hi:[1,0]
    v_mfma_f32_16x16x32_bf16 v[68:71], v[248:251], v[188:191], v[68:71]
    v_cvt_pk_bf16_f32 v116, v28, v29
    v_cvt_pk_bf16_f32 v117, v30, v31
    v_cvt_pk_bf16_f32 v118, v40, v41
    v_cvt_pk_bf16_f32 v119, v42, v43
    buffer_store_dwordx4 v[116:119], v247, s[36:39], s47 offen offset:1024 sc1
    v_mfma_f32_16x16x32_bf16 v[72:75], v[236:239], v[180:183], v[72:75]
    v_pk_mul_f32 v[32:33], v[32:33], v[196:197] op_sel_hi:[1,0]
    v_pk_mul_f32 v[34:35], v[34:35], v[196:197] op_sel_hi:[1,0]
    v_pk_mul_f32 v[44:45], v[44:45], v[196:197] op_sel_hi:[1,0]
    v_pk_mul_f32 v[46:47], v[46:47], v[196:197] op_sel_hi:[1,0]
    v_mfma_f32_16x16x32_bf16 v[76:79], v[236:239], v[184:187], v[76:79]
    v_cvt_pk_bf16_f32 v132, v32, v33
    v_cvt_pk_bf16_f32 v133, v34, v35
    v_cvt_pk_bf16_f32 v134, v44, v45
    v_cvt_pk_bf16_f32 v135, v46, v47
    buffer_store_dwordx4 v[132:135], v247, s[36:39], s48 offen offset:1024 sc1
    v_mfma_f32_16x16x32_bf16 v[80:83], v[236:239], v[188:191], v[80:83]
    v_pk_mul_f32 v[48:49], v[48:49], v[192:193] op_sel_hi:[1,0]
    v_pk_mul_f32 v[50:51], v[50:51], v[192:193] op_sel_hi:[1,0]
    v_pk_mul_f32 v[60:61], v[60:61], v[192:193] op_sel_hi:[1,0]
    v_pk_mul_f32 v[62:63], v[62:63], v[192:193] op_sel_hi:[1,0]
    v_cvt_pk_bf16_f32 v104, v48, v49
    v_cvt_pk_bf16_f32 v105, v50, v51
    v_mfma_f32_16x16x32_bf16 v[84:87], v[240:243], v[180:183], v[84:87]
    v_cvt_pk_bf16_f32 v106, v60, v61
    v_cvt_pk_bf16_f32 v107, v62, v63
    buffer_store_dwordx4 v[104:107], v247, s[36:39], s46 offen offset:2048 sc1
    v_pk_mul_f32 v[52:53], v[52:53], v[194:195] op_sel_hi:[1,0]
    v_pk_mul_f32 v[54:55], v[54:55], v[194:195] op_sel_hi:[1,0]
    v_pk_mul_f32 v[64:65], v[64:65], v[194:195] op_sel_hi:[1,0]
    v_pk_mul_f32 v[66:67], v[66:67], v[194:195] op_sel_hi:[1,0]
    v_mfma_f32_16x16x32_bf16 v[88:91], v[240:243], v[184:187], v[88:91]
    v_cvt_pk_bf16_f32 v120, v52, v53
    v_cvt_pk_bf16_f32 v121, v54, v55
    v_cvt_pk_bf16_f32 v122, v64, v65
    v_cvt_pk_bf16_f32 v123, v66, v67
    buffer_store_dwordx4 v[120:123], v247, s[36:39], s47 offen offset:2048 sc1
    v_pk_mul_f32 v[56:57], v[56:57], v[196:197] op_sel_hi:[1,0]
    v_pk_mul_f32 v[58:59], v[58:59], v[196:197] op_sel_hi:[1,0]
    v_mfma_f32_16x16x32_bf16 v[92:95], v[240:243], v[188:191], v[92:95]
    v_pk_mul_f32 v[68:69], v[68:69], v[196:197] op_sel_hi:[1,0]
    v_pk_mul_f32 v[70:71], v[70:71], v[196:197] op_sel_hi:[1,0]
    v_cvt_pk_bf16_f32 v136, v56, v57
    v_cvt_pk_bf16_f32 v137, v58, v59
    v_cvt_pk_bf16_f32 v138, v68, v69
    v_cvt_pk_bf16_f32 v139, v70, v71
    buffer_store_dwordx4 v[136:139], v247, s[36:39], s48 offen offset:2048 sc1
    v_pk_mul_f32 v[72:73], v[72:73], v[192:193] op_sel_hi:[1,0]
    v_pk_mul_f32 v[74:75], v[74:75], v[192:193] op_sel_hi:[1,0]
    v_pk_mul_f32 v[84:85], v[84:85], v[192:193] op_sel_hi:[1,0]
    v_pk_mul_f32 v[86:87], v[86:87], v[192:193] op_sel_hi:[1,0]
    v_cvt_pk_bf16_f32 v108, v72, v73
    v_cvt_pk_bf16_f32 v109, v74, v75
    v_cvt_pk_bf16_f32 v110, v84, v85
    v_cvt_pk_bf16_f32 v111, v86, v87
    buffer_store_dwordx4 v[108:111], v247, s[36:39], s46 offen offset:3072 sc1
    v_pk_mul_f32 v[76:77], v[76:77], v[194:195] op_sel_hi:[1,0]
    v_pk_mul_f32 v[78:79], v[78:79], v[194:195] op_sel_hi:[1,0]
    v_pk_mul_f32 v[88:89], v[88:89], v[194:195] op_sel_hi:[1,0]
    v_pk_mul_f32 v[90:91], v[90:91], v[194:195] op_sel_hi:[1,0]
    v_cvt_pk_bf16_f32 v124, v76, v77
    v_cvt_pk_bf16_f32 v125, v78, v79
    v_cvt_pk_bf16_f32 v126, v88, v89
    v_cvt_pk_bf16_f32 v127, v90, v91
    buffer_store_dwordx4 v[124:127], v247, s[36:39], s47 offen offset:3072 sc1
    v_pk_mul_f32 v[80:81], v[80:81], v[196:197] op_sel_hi:[1,0]
    v_pk_mul_f32 v[82:83], v[82:83], v[196:197] op_sel_hi:[1,0]
    v_pk_mul_f32 v[92:93], v[92:93], v[196:197] op_sel_hi:[1,0]
    v_pk_mul_f32 v[94:95], v[94:95], v[196:197] op_sel_hi:[1,0]
    v_cvt_pk_bf16_f32 v140, v80, v81
    v_cvt_pk_bf16_f32 v141, v82, v83
    v_cvt_pk_bf16_f32 v142, v92, v93
    v_cvt_pk_bf16_f32 v143, v94, v95
    buffer_store_dwordx4 v[140:143], v247, s[36:39], s48 offen offset:3072 sc1
    s_barrier
    s_and_b32 s51, s50, 7
    s_lshr_b32 s54, s50, 3
    s_and_b32 s55, s44, 3
    s_mul_i32 s46, s45, 12
    s_mul_i32 s47, s55, 3
    s_add_u32 s46, s46, s47
    s_lshl_b32 s46, s46, 17
    s_lshl_b32 s47, s54, 15
    s_add_u32 s56, s46, s47
    s_lshl_b32 s46, s45, 3
    s_add_u32 s46, s46, s51
    s_lshl_b32 s46, s46, 5
    s_lshl_b32 s47, s55, 3
    s_add_u32 s46, s46, s47
    s_add_u32 s57, s46, 0
    v_lshlrev_b32 v244, 4, v255
    v_lshrrev_b32 v240, 2, v255
    v_lshlrev_b32 v240, 7, v240
    v_and_b32 v241, 3, v255
    v_lshl_add_u32 v240, v241, 3, v240
    v_bfe_u32 v242, v255, 3, 2
    v_xor_b32 v241, 0, v242
    v_lshl_add_u32 v236, v241, 5, v240
    v_add_u32 v232, 69632, v236
    v_xor_b32 v241, 1, v242
    v_lshl_add_u32 v237, v241, 5, v240
    v_add_u32 v233, 69632, v237
    v_xor_b32 v241, 2, v242
    v_lshl_add_u32 v238, v241, 5, v240
    v_add_u32 v234, 69632, v238
    v_xor_b32 v241, 3, v242
    v_lshl_add_u32 v239, v241, 5, v240
    v_add_u32 v235, 69632, v239
    v_add_u32 v250, s51, v255
    v_and_b32 v250, 7, v250
    v_lshlrev_b32 v250, 2, v250
    s_lshl_b32 s46, s45, 2
    s_add_u32 s46, s46, s55
    s_lshl_b32 s46, s46, 9
    s_lshl_b32 s47, s54, 7
    s_add_u32 s46, s46, s47
    s_add_u32 s23, s46, 16777216
    ds_read_b64_tr_b16 v[144:145], v232 offset:0
    ds_read_b64_tr_b16 v[146:147], v232 offset:2048
    ds_read_b64_tr_b16 v[160:161], v232 offset:4096
    ds_read_b64_tr_b16 v[162:163], v232 offset:6144
    ds_read_b64_tr_b16 v[148:149], v233 offset:0
    ds_read_b64_tr_b16 v[150:151], v233 offset:2048
    ds_read_b64_tr_b16 v[164:165], v233 offset:4096
    ds_read_b64_tr_b16 v[166:167], v233 offset:6144
    ds_read_b64_tr_b16 v[152:153], v234 offset:0
    ds_read_b64_tr_b16 v[154:155], v234 offset:2048
    ds_read_b64_tr_b16 v[168:169], v234 offset:4096
    ds_read_b64_tr_b16 v[170:171], v234 offset:6144
    ds_read_b64_tr_b16 v[156:157], v235 offset:0
    ds_read_b64_tr_b16 v[158:159], v235 offset:2048
    ds_read_b64_tr_b16 v[172:173], v235 offset:4096
    s_waitcnt lgkmcnt(11)
    ds_read_b64_tr_b16 v[174:175], v235 offset:6144
    s_lshl_b32 s46, s51, 2
    s_add_u32 s46, s46, s23
    v_mov_b32 v240, 0
    v_mov_b32 v241, 1
    s_waitcnt vmcnt(0)
    s_mov_b64 exec, 1
    buffer_store_dword v241, v240, s[36:39], s46 offen sc1
    s_mov_b64 exec, -1
    v_mfma_f32_16x16x32_bf16 v[0:3], v[144:147], v[96:99], 0
    v_mfma_f32_16x16x32_bf16 v[0:3], v[160:163], v[100:103], v[0:3]
    ds_read_b64_tr_b16 v[176:177], v232 offset:8192
    v_mfma_f32_16x16x32_bf16 v[4:7], v[144:147], v[112:115], 0
    ds_read_b64_tr_b16 v[178:179], v232 offset:10240
    v_mfma_f32_16x16x32_bf16 v[4:7], v[160:163], v[116:119], v[4:7]
    v_mfma_f32_16x16x32_bf16 v[8:11], v[144:147], v[128:131], 0
    ds_read_b64_tr_b16 v[192:193], v232 offset:12288
    v_mfma_f32_16x16x32_bf16 v[8:11], v[160:163], v[132:135], v[8:11]
    s_waitcnt lgkmcnt(11)
    ds_read_b64_tr_b16 v[194:195], v232 offset:14336
    v_mfma_f32_16x16x32_bf16 v[12:15], v[148:151], v[96:99], 0
    v_mfma_f32_16x16x32_bf16 v[12:15], v[164:167], v[100:103], v[12:15]
    ds_read_b64_tr_b16 v[180:181], v233 offset:8192
    v_mfma_f32_16x16x32_bf16 v[16:19], v[148:151], v[112:115], 0
    ds_read_b64_tr_b16 v[182:183], v233 offset:10240
    v_mfma_f32_16x16x32_bf16 v[16:19], v[164:167], v[116:119], v[16:19]
    v_mfma_f32_16x16x32_bf16 v[20:23], v[148:151], v[128:131], 0
    ds_read_b64_tr_b16 v[196:197], v233 offset:12288
    v_mfma_f32_16x16x32_bf16 v[20:23], v[164:167], v[132:135], v[20:23]
    s_waitcnt lgkmcnt(11)
    ds_read_b64_tr_b16 v[198:199], v233 offset:14336
    v_mfma_f32_16x16x32_bf16 v[24:27], v[152:155], v[96:99], 0
    v_mfma_f32_16x16x32_bf16 v[24:27], v[168:171], v[100:103], v[24:27]
    ds_read_b64_tr_b16 v[184:185], v234 offset:8192
    v_mfma_f32_16x16x32_bf16 v[28:31], v[152:155], v[112:115], 0
    ds_read_b64_tr_b16 v[186:187], v234 offset:10240
    v_mfma_f32_16x16x32_bf16 v[28:31], v[168:171], v[116:119], v[28:31]
    v_mfma_f32_16x16x32_bf16 v[32:35], v[152:155], v[128:131], 0
    ds_read_b64_tr_b16 v[200:201], v234 offset:12288
    v_mfma_f32_16x16x32_bf16 v[32:35], v[168:171], v[132:135], v[32:35]
    s_waitcnt lgkmcnt(11)
    ds_read_b64_tr_b16 v[202:203], v234 offset:14336
    v_mfma_f32_16x16x32_bf16 v[36:39], v[156:159], v[96:99], 0
    v_mfma_f32_16x16x32_bf16 v[36:39], v[172:175], v[100:103], v[36:39]
    ds_read_b64_tr_b16 v[188:189], v235 offset:8192
    v_mfma_f32_16x16x32_bf16 v[40:43], v[156:159], v[112:115], 0
    ds_read_b64_tr_b16 v[190:191], v235 offset:10240
    v_mfma_f32_16x16x32_bf16 v[40:43], v[172:175], v[116:119], v[40:43]
    v_mfma_f32_16x16x32_bf16 v[44:47], v[156:159], v[128:131], 0
    ds_read_b64_tr_b16 v[204:205], v235 offset:12288
    v_mfma_f32_16x16x32_bf16 v[44:47], v[172:175], v[132:135], v[44:47]
    s_waitcnt lgkmcnt(11)
    ds_read_b64_tr_b16 v[206:207], v235 offset:14336
    v_mfma_f32_16x16x32_bf16 v[0:3], v[176:179], v[104:107], v[0:3]
    v_mfma_f32_16x16x32_bf16 v[0:3], v[192:195], v[108:111], v[0:3]
    v_mfma_f32_16x16x32_bf16 v[4:7], v[176:179], v[120:123], v[4:7]
    v_mfma_f32_16x16x32_bf16 v[4:7], v[192:195], v[124:127], v[4:7]
    v_mfma_f32_16x16x32_bf16 v[8:11], v[176:179], v[136:139], v[8:11]
    v_mfma_f32_16x16x32_bf16 v[8:11], v[192:195], v[140:143], v[8:11]
    s_waitcnt lgkmcnt(8)
    v_mfma_f32_16x16x32_bf16 v[12:15], v[180:183], v[104:107], v[12:15]
    v_mfma_f32_16x16x32_bf16 v[12:15], v[196:199], v[108:111], v[12:15]
    v_mfma_f32_16x16x32_bf16 v[16:19], v[180:183], v[120:123], v[16:19]
    v_mfma_f32_16x16x32_bf16 v[16:19], v[196:199], v[124:127], v[16:19]
    v_mfma_f32_16x16x32_bf16 v[20:23], v[180:183], v[136:139], v[20:23]
    v_mfma_f32_16x16x32_bf16 v[20:23], v[196:199], v[140:143], v[20:23]
    s_waitcnt lgkmcnt(4)
    v_mfma_f32_16x16x32_bf16 v[24:27], v[184:187], v[104:107], v[24:27]
    v_mfma_f32_16x16x32_bf16 v[24:27], v[200:203], v[108:111], v[24:27]
    v_mfma_f32_16x16x32_bf16 v[28:31], v[184:187], v[120:123], v[28:31]
    v_mfma_f32_16x16x32_bf16 v[28:31], v[200:203], v[124:127], v[28:31]
    v_mfma_f32_16x16x32_bf16 v[32:35], v[184:187], v[136:139], v[32:35]
    v_mfma_f32_16x16x32_bf16 v[32:35], v[200:203], v[140:143], v[32:35]
    s_waitcnt lgkmcnt(0)
    v_mfma_f32_16x16x32_bf16 v[36:39], v[188:191], v[104:107], v[36:39]
    v_mfma_f32_16x16x32_bf16 v[36:39], v[204:207], v[108:111], v[36:39]
    v_mfma_f32_16x16x32_bf16 v[40:43], v[188:191], v[120:123], v[40:43]
    v_mfma_f32_16x16x32_bf16 v[40:43], v[204:207], v[124:127], v[40:43]
    v_mfma_f32_16x16x32_bf16 v[44:47], v[188:191], v[136:139], v[44:47]
    v_mfma_f32_16x16x32_bf16 v[44:47], v[204:207], v[140:143], v[44:47]
    s_barrier
    s_mov_b32 s3, 0
A_pw0:
    buffer_load_dword v251, v250, s[36:39], s23 offen sc1
    s_add_u32 s3, s3, 1
    s_waitcnt vmcnt(0)
A_pc0:
    v_cmp_ne_u32 vcc, 1, v251
    s_nop 0
    s_and_b32 s46, vcc_lo, 14
    s_cbranch_scc0 A_ab0
    s_sleep 1
    s_cmp_lt_u32 s3, 0x40000
    s_cbranch_scc1 A_pw0
A_ab0:
    s_add_u32 s48, s51, 1
    s_and_b32 s48, s48, 7
    s_lshl_b32 s48, s48, 12
    s_add_u32 s48, s48, s56
    s_add_u32 s49, s48, 131072
    s_add_u32 s47, s48, 262144
    buffer_load_dwordx4 v[208:211], v244, s[36:39], s48 offen offset:0 sc1
    buffer_load_dwordx4 v[212:215], v244, s[36:39], s49 offen offset:0 sc1
    buffer_load_dwordx4 v[216:219], v244, s[36:39], s47 offen offset:0 sc1
    buffer_load_dwordx4 v[220:223], v244, s[36:39], s48 offen offset:1024 sc1
    buffer_load_dwordx4 v[224:227], v244, s[36:39], s49 offen offset:1024 sc1
    buffer_load_dwordx4 v[228:231], v244, s[36:39], s47 offen offset:1024 sc1
    buffer_load_dwordx4 v[48:51], v244, s[36:39], s48 offen offset:2048 sc1
    buffer_load_dwordx4 v[52:55], v244, s[36:39], s49 offen offset:2048 sc1
    buffer_load_dwordx4 v[56:59], v244, s[36:39], s47 offen offset:2048 sc1
    buffer_load_dwordx4 v[60:63], v244, s[36:39], s48 offen offset:3072 sc1
    buffer_load_dwordx4 v[64:67], v244, s[36:39], s49 offen offset:3072 sc1
    buffer_load_dwordx4 v[68:71], v244, s[36:39], s47 offen offset:3072 sc1
    s_add_u32 s48, s51, 2
    s_and_b32 s48, s48, 7
    s_lshl_b32 s48, s48, 12
    s_add_u32 s48, s48, s56
    s_add_u32 s49, s48, 131072
    s_add_u32 s47, s48, 262144
    buffer_load_dwordx4 v[72:75], v244, s[36:39], s48 offen offset:0 sc1
    buffer_load_dwordx4 v[76:79], v244, s[36:39], s49 offen offset:0 sc1
    buffer_load_dwordx4 v[80:83], v244, s[36:39], s47 offen offset:0 sc1
    buffer_load_dwordx4 v[84:87], v244, s[36:39], s48 offen offset:1024 sc1
    buffer_load_dwordx4 v[88:91], v244, s[36:39], s49 offen offset:1024 sc1
    buffer_load_dwordx4 v[92:95], v244, s[36:39], s47 offen offset:1024 sc1
    ds_read_b64_tr_b16 v[144:145], v232 offset:16384
    ds_read_b64_tr_b16 v[146:147], v232 offset:18432
    ds_read_b64_tr_b16 v[160:161], v232 offset:20480
    ds_read_b64_tr_b16 v[162:163], v232 offset:22528
    ds_read_b64_tr_b16 v[148:149], v233 offset:16384
    ds_read_b64_tr_b16 v[150:151], v233 offset:18432
    ds_read_b64_tr_b16 v[164:165], v233 offset:20480
    ds_read_b64_tr_b16 v[166:167], v233 offset:22528
    ds_read_b64_tr_b16 v[152:153], v234 offset:16384
    ds_read_b64_tr_b16 v[154:155], v234 offset:18432
    ds_read_b64_tr_b16 v[168:169], v234 offset:20480
    ds_read_b64_tr_b16 v[170:171], v234 offset:22528
    ds_read_b64_tr_b16 v[156:157], v235 offset:16384
    ds_read_b64_tr_b16 v[158:159], v235 offset:18432
    ds_read_b64_tr_b16 v[172:173], v235 offset:20480
    s_waitcnt lgkmcnt(11)
    ds_read_b64_tr_b16 v[174:175], v235 offset:22528
    s_waitcnt vmcnt(12)
    v_mfma_f32_16x16x32_bf16 v[0:3], v[144:147], v[208:211], v[0:3]
    v_mfma_f32_16x16x32_bf16 v[0:3], v[160:163], v[220:223], v[0:3]
    buffer_load_dwordx4 v[96:99], v244, s[36:39], s48 offen offset:2048 sc1
    v_mfma_f32_16x16x32_bf16 v[4:7], v[144:147], v[212:215], v[4:7]
    ds_read_b64_tr_b16 v[176:177], v232 offset:24576
    v_mfma_f32_16x16x32_bf16 v[4:7], v[160:163], v[224:227], v[4:7]
    ds_read_b64_tr_b16 v[178:179], v232 offset:26624
    v_mfma_f32_16x16x32_bf16 v[8:11], v[144:147], v[216:219], v[8:11]
    buffer_load_dwordx4 v[100:103], v244, s[36:39], s49 offen offset:2048 sc1
    v_mfma_f32_16x16x32_bf16 v[8:11], v[160:163], v[228:231], v[8:11]
    ds_read_b64_tr_b16 v[192:193], v232 offset:28672
    s_waitcnt lgkmcnt(11)
    v_mfma_f32_16x16x32_bf16 v[12:15], v[148:151], v[208:211], v[12:15]
    ds_read_b64_tr_b16 v[194:195], v232 offset:30720
    v_mfma_f32_16x16x32_bf16 v[12:15], v[164:167], v[220:223], v[12:15]
    buffer_load_dwordx4 v[104:107], v244, s[36:39], s47 offen offset:2048 sc1
    v_mfma_f32_16x16x32_bf16 v[16:19], v[148:151], v[212:215], v[16:19]
    ds_read_b64_tr_b16 v[180:181], v233 offset:24576
    v_mfma_f32_16x16x32_bf16 v[16:19], v[164:167], v[224:227], v[16:19]
    ds_read_b64_tr_b16 v[182:183], v233 offset:26624
    v_mfma_f32_16x16x32_bf16 v[20:23], v[148:151], v[216:219], v[20:23]
    buffer_load_dwordx4 v[108:111], v244, s[36:39], s48 offen offset:3072 sc1
    v_mfma_f32_16x16x32_bf16 v[20:23], v[164:167], v[228:231], v[20:23]
    ds_read_b64_tr_b16 v[196:197], v233 offset:28672
    s_waitcnt lgkmcnt(11)
    v_mfma_f32_16x16x32_bf16 v[24:27], v[152:155], v[208:211], v[24:27]
    v_mfma_f32_16x16x32_bf16 v[24:27], v[168:171], v[220:223], v[24:27]
    ds_read_b64_tr_b16 v[198:199], v233 offset:30720
    v_mfma_f32_16x16x32_bf16 v[28:31], v[152:155], v[212:215], v[28:31]
    buffer_load_dwordx4 v[112:115], v244, s[36:39], s49 offen offset:3072 sc1
    v_mfma_f32_16x16x32_bf16 v[28:31], v[168:171], v[224:227], v[28:31]
    ds_read_b64_tr_b16 v[184:185], v234 offset:24576
    v_mfma_f32_16x16x32_bf16 v[32:35], v[152:155], v[216:219], v[32:35]
    ds_read_b64_tr_b16 v[186:187], v234 offset:26624
    v_mfma_f32_16x16x32_bf16 v[32:35], v[168:171], v[228:231], v[32:35]
    buffer_load_dwordx4 v[116:119], v244, s[36:39], s47 offen offset:3072 sc1
    s_waitcnt lgkmcnt(10)
    v_mfma_f32_16x16x32_bf16 v[36:39], v[156:159], v[208:211], v[36:39]
    ds_read_b64_tr_b16 v[200:201], v234 offset:28672
    v_mfma_f32_16x16x32_bf16 v[36:39], v[172:175], v[220:223], v[36:39]
    ds_read_b64_tr_b16 v[202:203], v234 offset:30720
    v_mfma_f32_16x16x32_bf16 v[40:43], v[156:159], v[212:215], v[40:43]
    ds_read_b64_tr_b16 v[188:189], v235 offset:24576
    v_mfma_f32_16x16x32_bf16 v[40:43], v[172:175], v[224:227], v[40:43]
    ds_read_b64_tr_b16 v[190:191], v235 offset:26624
    v_mfma_f32_16x16x32_bf16 v[44:47], v[156:159], v[216:219], v[44:47]
    ds_read_b64_tr_b16 v[204:205], v235 offset:28672
    v_mfma_f32_16x16x32_bf16 v[44:47], v[172:175], v[228:231], v[44:47]
    s_waitcnt lgkmcnt(11)
    ds_read_b64_tr_b16 v[206:207], v235 offset:30720
    s_add_u32 s48, s51, 3
    s_and_b32 s48, s48, 7
    s_lshl_b32 s48, s48, 12
    s_add_u32 s48, s48, s56
    s_add_u32 s49, s48, 131072
    s_add_u32 s47, s48, 262144
    s_waitcnt vmcnt(12)
    v_mfma_f32_16x16x32_bf16 v[0:3], v[176:179], v[48:51], v[0:3]
    v_mfma_f32_16x16x32_bf16 v[0:3], v[192:195], v[60:63], v[0:3]
    buffer_load_dwordx4 v[208:211], v244, s[36:39], s48 offen offset:0 sc1
    v_mfma_f32_16x16x32_bf16 v[4:7], v[176:179], v[52:55], v[4:7]
    ds_read_b64_tr_b16 v[144:145], v232 offset:32768
    v_mfma_f32_16x16x32_bf16 v[4:7], v[192:195], v[64:67], v[4:7]
    ds_read_b64_tr_b16 v[146:147], v232 offset:34816
    v_mfma_f32_16x16x32_bf16 v[8:11], v[176:179], v[56:59], v[8:11]
    buffer_load_dwordx4 v[212:215], v244, s[36:39], s49 offen offset:0 sc1
    v_mfma_f32_16x16x32_bf16 v[8:11], v[192:195], v[68:71], v[8:11]
    ds_read_b64_tr_b16 v[160:161], v232 offset:36864
    s_waitcnt lgkmcnt(11)
    v_mfma_f32_16x16x32_bf16 v[12:15], v[180:183], v[48:51], v[12:15]
    ds_read_b64_tr_b16 v[162:163], v232 offset:38912
    v_mfma_f32_16x16x32_bf16 v[12:15], v[196:199], v[60:63], v[12:15]
    buffer_load_dwordx4 v[216:219], v244, s[36:39], s47 offen offset:0 sc1
    v_mfma_f32_16x16x32_bf16 v[16:19], v[180:183], v[52:55], v[16:19]
    ds_read_b64_tr_b16 v[148:149], v233 offset:32768
    v_mfma_f32_16x16x32_bf16 v[16:19], v[196:199], v[64:67], v[16:19]
    ds_read_b64_tr_b16 v[150:151], v233 offset:34816
    v_mfma_f32_16x16x32_bf16 v[20:23], v[180:183], v[56:59], v[20:23]
    buffer_load_dwordx4 v[220:223], v244, s[36:39], s48 offen offset:1024 sc1
    v_mfma_f32_16x16x32_bf16 v[20:23], v[196:199], v[68:71], v[20:23]
    ds_read_b64_tr_b16 v[164:165], v233 offset:36864
    s_waitcnt lgkmcnt(11)
    v_mfma_f32_16x16x32_bf16 v[24:27], v[184:187], v[48:51], v[24:27]
    v_mfma_f32_16x16x32_bf16 v[24:27], v[200:203], v[60:63], v[24:27]
    ds_read_b64_tr_b16 v[166:167], v233 offset:38912
    v_mfma_f32_16x16x32_bf16 v[28:31], v[184:187], v[52:55], v[28:31]
    buffer_load_dwordx4 v[224:227], v244, s[36:39], s49 offen offset:1024 sc1
    v_mfma_f32_16x16x32_bf16 v[28:31], v[200:203], v[64:67], v[28:31]
    ds_read_b64_tr_b16 v[152:153], v234 offset:32768
    v_mfma_f32_16x16x32_bf16 v[32:35], v[184:187], v[56:59], v[32:35]
    ds_read_b64_tr_b16 v[154:155], v234 offset:34816
    v_mfma_f32_16x16x32_bf16 v[32:35], v[200:203], v[68:71], v[32:35]
    buffer_load_dwordx4 v[228:231], v244, s[36:39], s47 offen offset:1024 sc1
    s_waitcnt lgkmcnt(10)
    v_mfma_f32_16x16x32_bf16 v[36:39], v[188:191], v[48:51], v[36:39]
    ds_read_b64_tr_b16 v[168:169], v234 offset:36864
    v_mfma_f32_16x16x32_bf16 v[36:39], v[204:207], v[60:63], v[36:39]
    ds_read_b64_tr_b16 v[170:171], v234 offset:38912
    v_mfma_f32_16x16x32_bf16 v[40:43], v[188:191], v[52:55], v[40:43]
    ds_read_b64_tr_b16 v[156:157], v235 offset:32768
    v_mfma_f32_16x16x32_bf16 v[40:43], v[204:207], v[64:67], v[40:43]
    ds_read_b64_tr_b16 v[158:159], v235 offset:34816
    v_mfma_f32_16x16x32_bf16 v[44:47], v[188:191], v[56:59], v[44:47]
    ds_read_b64_tr_b16 v[172:173], v235 offset:36864
    v_mfma_f32_16x16x32_bf16 v[44:47], v[204:207], v[68:71], v[44:47]
    s_waitcnt lgkmcnt(11)
    ds_read_b64_tr_b16 v[174:175], v235 offset:38912
    buffer_load_dword v251, v250, s[36:39], s23 offen sc1
    s_waitcnt vmcnt(13)
    v_mfma_f32_16x16x32_bf16 v[0:3], v[144:147], v[72:75], v[0:3]
    v_mfma_f32_16x16x32_bf16 v[0:3], v[160:163], v[84:87], v[0:3]
    buffer_load_dwordx4 v[48:51], v244, s[36:39], s48 offen offset:2048 sc1
    v_mfma_f32_16x16x32_bf16 v[4:7], v[144:147], v[76:79], v[4:7]
    ds_read_b64_tr_b16 v[176:177], v232 offset:40960
    v_mfma_f32_16x16x32_bf16 v[4:7], v[160:163], v[88:91], v[4:7]
    ds_read_b64_tr_b16 v[178:179], v232 offset:43008
    v_mfma_f32_16x16x32_bf16 v[8:11], v[144:147], v[80:83], v[8:11]
    buffer_load_dwordx4 v[52:55], v244, s[36:39], s49 offen offset:2048 sc1
    v_mfma_f32_16x16x32_bf16 v[8:11], v[160:163], v[92:95], v[8:11]
    ds_read_b64_tr_b16 v[192:193], v232 offset:45056
    s_waitcnt lgkmcnt(11)
    v_mfma_f32_16x16x32_bf16 v[12:15], v[148:151], v[72:75], v[12:15]
    ds_read_b64_tr_b16 v[194:195], v232 offset:47104
    v_mfma_f32_16x16x32_bf16 v[12:15], v[164:167], v[84:87], v[12:15]
    buffer_load_dwordx4 v[56:59], v244, s[36:39], s47 offen offset:2048 sc1
    v_mfma_f32_16x16x32_bf16 v[16:19], v[148:151], v[76:79], v[16:19]
    ds_read_b64_tr_b16 v[180:181], v233 offset:40960
    v_mfma_f32_16x16x32_bf16 v[16:19], v[164:167], v[88:91], v[16:19]
    ds_read_b64_tr_b16 v[182:183], v233 offset:43008
    v_mfma_f32_16x16x32_bf16 v[20:23], v[148:151], v[80:83], v[20:23]
    buffer_load_dwordx4 v[60:63], v244, s[36:39], s48 offen offset:3072 sc1
    v_mfma_f32_16x16x32_bf16 v[20:23], v[164:167], v[92:95], v[20:23]
    ds_read_b64_tr_b16 v[196:197], v233 offset:45056
    s_waitcnt lgkmcnt(11)
    v_mfma_f32_16x16x32_bf16 v[24:27], v[152:155], v[72:75], v[24:27]
    v_mfma_f32_16x16x32_bf16 v[24:27], v[168:171], v[84:87], v[24:27]
    ds_read_b64_tr_b16 v[198:199], v233 offset:47104
    v_mfma_f32_16x16x32_bf16 v[28:31], v[152:155], v[76:79], v[28:31]
    buffer_load_dwordx4 v[64:67], v244, s[36:39], s49 offen offset:3072 sc1
    v_mfma_f32_16x16x32_bf16 v[28:31], v[168:171], v[88:91], v[28:31]
    ds_read_b64_tr_b16 v[184:185], v234 offset:40960
    v_mfma_f32_16x16x32_bf16 v[32:35], v[152:155], v[80:83], v[32:35]
    ds_read_b64_tr_b16 v[186:187], v234 offset:43008
    v_mfma_f32_16x16x32_bf16 v[32:35], v[168:171], v[92:95], v[32:35]
    buffer_load_dwordx4 v[68:71], v244, s[36:39], s47 offen offset:3072 sc1
    s_waitcnt lgkmcnt(10)
    v_mfma_f32_16x16x32_bf16 v[36:39], v[156:159], v[72:75], v[36:39]
    ds_read_b64_tr_b16 v[200:201], v234 offset:45056
    v_mfma_f32_16x16x32_bf16 v[36:39], v[172:175], v[84:87], v[36:39]
    ds_read_b64_tr_b16 v[202:203], v234 offset:47104
    v_mfma_f32_16x16x32_bf16 v[40:43], v[156:159], v[76:79], v[40:43]
    ds_read_b64_tr_b16 v[188:189], v235 offset:40960
    v_mfma_f32_16x16x32_bf16 v[40:43], v[172:175], v[88:91], v[40:43]
    ds_read_b64_tr_b16 v[190:191], v235 offset:43008
    v_mfma_f32_16x16x32_bf16 v[44:47], v[156:159], v[80:83], v[44:47]
    ds_read_b64_tr_b16 v[204:205], v235 offset:45056
    v_mfma_f32_16x16x32_bf16 v[44:47], v[172:175], v[92:95], v[44:47]
    s_waitcnt lgkmcnt(11)
    ds_read_b64_tr_b16 v[206:207], v235 offset:47104
    s_waitcnt vmcnt(6)
    s_mov_b32 s3, 0
A_qab0:
    v_cmp_ne_u32 vcc, 1, v251
    s_nop 0
    s_and_b32 s46, vcc_lo, 240
    s_cbranch_scc0 A_rab0
    s_sleep 1
    buffer_load_dword v251, v250, s[36:39], s23 offen sc1
    s_add_u32 s3, s3, 1
    s_waitcnt vmcnt(0)
    s_cmp_lt_u32 s3, 0x40000
    s_cbranch_scc1 A_qab0
A_rab0:
    s_add_u32 s48, s51, 4
    s_and_b32 s48, s48, 7
    s_lshl_b32 s48, s48, 12
    s_add_u32 s48, s48, s56
    s_add_u32 s49, s48, 131072
    s_add_u32 s47, s48, 262144
    s_waitcnt vmcnt(6)
    v_mfma_f32_16x16x32_bf16 v[0:3], v[176:179], v[96:99], v[0:3]
    v_mfma_f32_16x16x32_bf16 v[0:3], v[192:195], v[108:111], v[0:3]
    buffer_load_dwordx4 v[72:75], v244, s[36:39], s48 offen offset:0 sc1
    v_mfma_f32_16x16x32_bf16 v[4:7], v[176:179], v[100:103], v[4:7]
    ds_read_b64_tr_b16 v[144:145], v232 offset:49152
    v_mfma_f32_16x16x32_bf16 v[4:7], v[192:195], v[112:115], v[4:7]
    ds_read_b64_tr_b16 v[146:147], v232 offset:51200
    v_mfma_f32_16x16x32_bf16 v[8:11], v[176:179], v[104:107], v[8:11]
    buffer_load_dwordx4 v[76:79], v244, s[36:39], s49 offen offset:0 sc1
    v_mfma_f32_16x16x32_bf16 v[8:11], v[192:195], v[116:119], v[8:11]
    ds_read_b64_tr_b16 v[160:161], v232 offset:53248
    s_waitcnt lgkmcnt(11)
    v_mfma_f32_16x16x32_bf16 v[12:15], v[180:183], v[96:99], v[12:15]
    ds_read_b64_tr_b16 v[162:163], v232 offset:55296
    v_mfma_f32_16x16x32_bf16 v[12:15], v[196:199], v[108:111], v[12:15]
    buffer_load_dwordx4 v[80:83], v244, s[36:39], s47 offen offset:0 sc1
    v_mfma_f32_16x16x32_bf16 v[16:19], v[180:183], v[100:103], v[16:19]
    ds_read_b64_tr_b16 v[148:149], v233 offset:49152
    v_mfma_f32_16x16x32_bf16 v[16:19], v[196:199], v[112:115], v[16:19]
    ds_read_b64_tr_b16 v[150:151], v233 offset:51200
    v_mfma_f32_16x16x32_bf16 v[20:23], v[180:183], v[104:107], v[20:23]
    buffer_load_dwordx4 v[84:87], v244, s[36:39], s48 offen offset:1024 sc1
    v_mfma_f32_16x16x32_bf16 v[20:23], v[196:199], v[116:119], v[20:23]
    ds_read_b64_tr_b16 v[164:165], v233 offset:53248
    s_waitcnt lgkmcnt(11)
    v_mfma_f32_16x16x32_bf16 v[24:27], v[184:187], v[96:99], v[24:27]
    v_mfma_f32_16x16x32_bf16 v[24:27], v[200:203], v[108:111], v[24:27]
    ds_read_b64_tr_b16 v[166:167], v233 offset:55296
    v_mfma_f32_16x16x32_bf16 v[28:31], v[184:187], v[100:103], v[28:31]
    buffer_load_dwordx4 v[88:91], v244, s[36:39], s49 offen offset:1024 sc1
    v_mfma_f32_16x16x32_bf16 v[28:31], v[200:203], v[112:115], v[28:31]
    ds_read_b64_tr_b16 v[152:153], v234 offset:49152
    v_mfma_f32_16x16x32_bf16 v[32:35], v[184:187], v[104:107], v[32:35]
    ds_read_b64_tr_b16 v[154:155], v234 offset:51200
    v_mfma_f32_16x16x32_bf16 v[32:35], v[200:203], v[116:119], v[32:35]
    buffer_load_dwordx4 v[92:95], v244, s[36:39], s47 offen offset:1024 sc1
    s_waitcnt lgkmcnt(10)
    v_mfma_f32_16x16x32_bf16 v[36:39], v[188:191], v[96:99], v[36:39]
    ds_read_b64_tr_b16 v[168:169], v234 offset:53248
    v_mfma_f32_16x16x32_bf16 v[36:39], v[204:207], v[108:111], v[36:39]
    ds_read_b64_tr_b16 v[170:171], v234 offset:55296
    v_mfma_f32_16x16x32_bf16 v[40:43], v[188:191], v[100:103], v[40:43]
    ds_read_b64_tr_b16 v[156:157], v235 offset:49152
    v_mfma_f32_16x16x32_bf16 v[40:43], v[204:207], v[112:115], v[40:43]
    ds_read_b64_tr_b16 v[158:159], v235 offset:51200
    v_mfma_f32_16x16x32_bf16 v[44:47], v[188:191], v[104:107], v[44:47]
    ds_read_b64_tr_b16 v[172:173], v235 offset:53248
    v_mfma_f32_16x16x32_bf16 v[44:47], v[204:207], v[116:119], v[44:47]
    s_waitcnt lgkmcnt(11)
    ds_read_b64_tr_b16 v[174:175], v235 offset:55296
    s_waitcnt vmcnt(12)
    v_mfma_f32_16x16x32_bf16 v[0:3], v[144:147], v[208:211], v[0:3]
    v_mfma_f32_16x16x32_bf16 v[0:3], v[160:163], v[220:223], v[0:3]
    buffer_load_dwordx4 v[96:99], v244, s[36:39], s48 offen offset:2048 sc1
    v_mfma_f32_16x16x32_bf16 v[4:7], v[144:147], v[212:215], v[4:7]
    ds_read_b64_tr_b16 v[176:177], v232 offset:57344
    v_mfma_f32_16x16x32_bf16 v[4:7], v[160:163], v[224:227], v[4:7]
    ds_read_b64_tr_b16 v[178:179], v232 offset:59392
    v_mfma_f32_16x16x32_bf16 v[8:11], v[144:147], v[216:219], v[8:11]
    buffer_load_dwordx4 v[100:103], v244, s[36:39], s49 offen offset:2048 sc1
    v_mfma_f32_16x16x32_bf16 v[8:11], v[160:163], v[228:231], v[8:11]
    ds_read_b64_tr_b16 v[192:193], v232 offset:61440
    s_waitcnt lgkmcnt(11)
    v_mfma_f32_16x16x32_bf16 v[12:15], v[148:151], v[208:211], v[12:15]
    ds_read_b64_tr_b16 v[194:195], v232 offset:63488
    v_mfma_f32_16x16x32_bf16 v[12:15], v[164:167], v[220:223], v[12:15]
    buffer_load_dwordx4 v[104:107], v244, s[36:39], s47 offen offset:2048 sc1
    v_mfma_f32_16x16x32_bf16 v[16:19], v[148:151], v[212:215], v[16:19]
    ds_read_b64_tr_b16 v[180:181], v233 offset:57344
    v_mfma_f32_16x16x32_bf16 v[16:19], v[164:167], v[224:227], v[16:19]
    ds_read_b64_tr_b16 v[182:183], v233 offset:59392
    v_mfma_f32_16x16x32_bf16 v[20:23], v[148:151], v[216:219], v[20:23]
    buffer_load_dwordx4 v[108:111], v244, s[36:39], s48 offen offset:3072 sc1
    v_mfma_f32_16x16x32_bf16 v[20:23], v[164:167], v[228:231], v[20:23]
    ds_read_b64_tr_b16 v[196:197], v233 offset:61440
    s_waitcnt lgkmcnt(11)
    v_mfma_f32_16x16x32_bf16 v[24:27], v[152:155], v[208:211], v[24:27]
    v_mfma_f32_16x16x32_bf16 v[24:27], v[168:171], v[220:223], v[24:27]
    ds_read_b64_tr_b16 v[198:199], v233 offset:63488
    v_mfma_f32_16x16x32_bf16 v[28:31], v[152:155], v[212:215], v[28:31]
    buffer_load_dwordx4 v[112:115], v244, s[36:39], s49 offen offset:3072 sc1
    v_mfma_f32_16x16x32_bf16 v[28:31], v[168:171], v[224:227], v[28:31]
    ds_read_b64_tr_b16 v[184:185], v234 offset:57344
    v_mfma_f32_16x16x32_bf16 v[32:35], v[152:155], v[216:219], v[32:35]
    ds_read_b64_tr_b16 v[186:187], v234 offset:59392
    v_mfma_f32_16x16x32_bf16 v[32:35], v[168:171], v[228:231], v[32:35]
    buffer_load_dwordx4 v[116:119], v244, s[36:39], s47 offen offset:3072 sc1
    s_waitcnt lgkmcnt(10)
    v_mfma_f32_16x16x32_bf16 v[36:39], v[156:159], v[208:211], v[36:39]
    ds_read_b64_tr_b16 v[200:201], v234 offset:61440
    v_mfma_f32_16x16x32_bf16 v[36:39], v[172:175], v[220:223], v[36:39]
    ds_read_b64_tr_b16 v[202:203], v234 offset:63488
    v_mfma_f32_16x16x32_bf16 v[40:43], v[156:159], v[212:215], v[40:43]
    ds_read_b64_tr_b16 v[188:189], v235 offset:57344
    v_mfma_f32_16x16x32_bf16 v[40:43], v[172:175], v[224:227], v[40:43]
    ds_read_b64_tr_b16 v[190:191], v235 offset:59392
    v_mfma_f32_16x16x32_bf16 v[44:47], v[156:159], v[216:219], v[44:47]
    ds_read_b64_tr_b16 v[204:205], v235 offset:61440
    v_mfma_f32_16x16x32_bf16 v[44:47], v[172:175], v[228:231], v[44:47]
    s_waitcnt lgkmcnt(11)
    ds_read_b64_tr_b16 v[206:207], v235 offset:63488
    s_add_u32 s48, s51, 5
    s_and_b32 s48, s48, 7
    s_lshl_b32 s48, s48, 12
    s_add_u32 s48, s48, s56
    s_add_u32 s49, s48, 131072
    s_add_u32 s47, s48, 262144
    s_waitcnt vmcnt(12)
    v_mfma_f32_16x16x32_bf16 v[0:3], v[176:179], v[48:51], v[0:3]
    v_mfma_f32_16x16x32_bf16 v[0:3], v[192:195], v[60:63], v[0:3]
    buffer_load_dwordx4 v[208:211], v244, s[36:39], s48 offen offset:0 sc1
    v_mfma_f32_16x16x32_bf16 v[4:7], v[176:179], v[52:55], v[4:7]
    ds_read_b64_tr_b16 v[144:145], v236 offset:0
    v_mfma_f32_16x16x32_bf16 v[4:7], v[192:195], v[64:67], v[4:7]
    ds_read_b64_tr_b16 v[146:147], v236 offset:2048
    v_mfma_f32_16x16x32_bf16 v[8:11], v[176:179], v[56:59], v[8:11]
    buffer_load_dwordx4 v[212:215], v244, s[36:39], s49 offen offset:0 sc1
    v_mfma_f32_16x16x32_bf16 v[8:11], v[192:195], v[68:71], v[8:11]
    ds_read_b64_tr_b16 v[160:161], v236 offset:4096
    s_waitcnt lgkmcnt(11)
    v_mfma_f32_16x16x32_bf16 v[12:15], v[180:183], v[48:51], v[12:15]
    ds_read_b64_tr_b16 v[162:163], v236 offset:6144
    v_mfma_f32_16x16x32_bf16 v[12:15], v[196:199], v[60:63], v[12:15]
    buffer_load_dwordx4 v[216:219], v244, s[36:39], s47 offen offset:0 sc1
    v_mfma_f32_16x16x32_bf16 v[16:19], v[180:183], v[52:55], v[16:19]
    ds_read_b64_tr_b16 v[148:149], v237 offset:0
    v_mfma_f32_16x16x32_bf16 v[16:19], v[196:199], v[64:67], v[16:19]
    ds_read_b64_tr_b16 v[150:151], v237 offset:2048
    v_mfma_f32_16x16x32_bf16 v[20:23], v[180:183], v[56:59], v[20:23]
    buffer_load_dwordx4 v[220:223], v244, s[36:39], s48 offen offset:1024 sc1
    v_mfma_f32_16x16x32_bf16 v[20:23], v[196:199], v[68:71], v[20:23]
    ds_read_b64_tr_b16 v[164:165], v237 offset:4096
    s_waitcnt lgkmcnt(11)
    v_mfma_f32_16x16x32_bf16 v[24:27], v[184:187], v[48:51], v[24:27]
    v_mfma_f32_16x16x32_bf16 v[24:27], v[200:203], v[60:63], v[24:27]
    ds_read_b64_tr_b16 v[166:167], v237 offset:6144
    v_mfma_f32_16x16x32_bf16 v[28:31], v[184:187], v[52:55], v[28:31]
    buffer_load_dwordx4 v[224:227], v244, s[36:39], s49 offen offset:1024 sc1
    v_mfma_f32_16x16x32_bf16 v[28:31], v[200:203], v[64:67], v[28:31]
    ds_read_b64_tr_b16 v[152:153], v238 offset:0
    v_mfma_f32_16x16x32_bf16 v[32:35], v[184:187], v[56:59], v[32:35]
    ds_read_b64_tr_b16 v[154:155], v238 offset:2048
    v_mfma_f32_16x16x32_bf16 v[32:35], v[200:203], v[68:71], v[32:35]
    buffer_load_dwordx4 v[228:231], v244, s[36:39], s47 offen offset:1024 sc1
    s_waitcnt lgkmcnt(10)
    v_mfma_f32_16x16x32_bf16 v[36:39], v[188:191], v[48:51], v[36:39]
    ds_read_b64_tr_b16 v[168:169], v238 offset:4096
    v_mfma_f32_16x16x32_bf16 v[36:39], v[204:207], v[60:63], v[36:39]
    ds_read_b64_tr_b16 v[170:171], v238 offset:6144
    v_mfma_f32_16x16x32_bf16 v[40:43], v[188:191], v[52:55], v[40:43]
    ds_read_b64_tr_b16 v[156:157], v239 offset:0
    v_mfma_f32_16x16x32_bf16 v[40:43], v[204:207], v[64:67], v[40:43]
    ds_read_b64_tr_b16 v[158:159], v239 offset:2048
    v_mfma_f32_16x16x32_bf16 v[44:47], v[188:191], v[56:59], v[44:47]
    ds_read_b64_tr_b16 v[172:173], v239 offset:4096
    v_mfma_f32_16x16x32_bf16 v[44:47], v[204:207], v[68:71], v[44:47]
    s_waitcnt lgkmcnt(11)
    ds_read_b64_tr_b16 v[174:175], v239 offset:6144
    s_waitcnt vmcnt(12)
    v_mfma_f32_16x16x32_bf16 v[0:3], v[144:147], v[72:75], v[0:3]
    v_mfma_f32_16x16x32_bf16 v[0:3], v[160:163], v[84:87], v[0:3]
    buffer_load_dwordx4 v[48:51], v244, s[36:39], s48 offen offset:2048 sc1
    v_mfma_f32_16x16x32_bf16 v[4:7], v[144:147], v[76:79], v[4:7]
    ds_read_b64_tr_b16 v[176:177], v236 offset:8192
    v_mfma_f32_16x16x32_bf16 v[4:7], v[160:163], v[88:91], v[4:7]
    ds_read_b64_tr_b16 v[178:179], v236 offset:10240
    v_mfma_f32_16x16x32_bf16 v[8:11], v[144:147], v[80:83], v[8:11]
    buffer_load_dwordx4 v[52:55], v244, s[36:39], s49 offen offset:2048 sc1
    v_mfma_f32_16x16x32_bf16 v[8:11], v[160:163], v[92:95], v[8:11]
    ds_read_b64_tr_b16 v[192:193], v236 offset:12288
    s_waitcnt lgkmcnt(11)
    v_mfma_f32_16x16x32_bf16 v[12:15], v[148:151], v[72:75], v[12:15]
    ds_read_b64_tr_b16 v[194:195], v236 offset:14336
    v_mfma_f32_16x16x32_bf16 v[12:15], v[164:167], v[84:87], v[12:15]
    buffer_load_dwordx4 v[56:59], v244, s[36:39], s47 offen offset:2048 sc1
    v_mfma_f32_16x16x32_bf16 v[16:19], v[148:151], v[76:79], v[16:19]
    ds_read_b64_tr_b16 v[180:181], v237 offset:8192
    v_mfma_f32_16x16x32_bf16 v[16:19], v[164:167], v[88:91], v[16:19]
    ds_read_b64_tr_b16 v[182:183], v237 offset:10240
    v_mfma_f32_16x16x32_bf16 v[20:23], v[148:151], v[80:83], v[20:23]
    buffer_load_dwordx4 v[60:63], v244, s[36:39], s48 offen offset:3072 sc1
    v_mfma_f32_16x16x32_bf16 v[20:23], v[164:167], v[92:95], v[20:23]
    ds_read_b64_tr_b16 v[196:197], v237 offset:12288
    s_waitcnt lgkmcnt(11)
    v_mfma_f32_16x16x32_bf16 v[24:27], v[152:155], v[72:75], v[24:27]
    v_mfma_f32_16x16x32_bf16 v[24:27], v[168:171], v[84:87], v[24:27]
    ds_read_b64_tr_b16 v[198:199], v237 offset:14336
    v_mfma_f32_16x16x32_bf16 v[28:31], v[152:155], v[76:79], v[28:31]
    buffer_load_dwordx4 v[64:67], v244, s[36:39], s49 offen offset:3072 sc1
    v_mfma_f32_16x16x32_bf16 v[28:31], v[168:171], v[88:91], v[28:31]
    ds_read_b64_tr_b16 v[184:185], v238 offset:8192
    v_mfma_f32_16x16x32_bf16 v[32:35], v[152:155], v[80:83], v[32:35]
    ds_read_b64_tr_b16 v[186:187], v238 offset:10240
    v_mfma_f32_16x16x32_bf16 v[32:35], v[168:171], v[92:95], v[32:35]
    buffer_load_dwordx4 v[68:71], v244, s[36:39], s47 offen offset:3072 sc1
    s_waitcnt lgkmcnt(10)
    v_mfma_f32_16x16x32_bf16 v[36:39], v[156:159], v[72:75], v[36:39]
    ds_read_b64_tr_b16 v[200:201], v238 offset:12288
    v_mfma_f32_16x16x32_bf16 v[36:39], v[172:175], v[84:87], v[36:39]
    ds_read_b64_tr_b16 v[202:203], v238 offset:14336
    v_mfma_f32_16x16x32_bf16 v[40:43], v[156:159], v[76:79], v[40:43]
    ds_read_b64_tr_b16 v[188:189], v239 offset:8192
    v_mfma_f32_16x16x32_bf16 v[40:43], v[172:175], v[88:91], v[40:43]
    ds_read_b64_tr_b16 v[190:191], v239 offset:10240
    v_mfma_f32_16x16x32_bf16 v[44:47], v[156:159], v[80:83], v[44:47]
    ds_read_b64_tr_b16 v[204:205], v239 offset:12288
    v_mfma_f32_16x16x32_bf16 v[44:47], v[172:175], v[92:95], v[44:47]
    s_waitcnt lgkmcnt(11)
    ds_read_b64_tr_b16 v[206:207], v239 offset:14336
    s_add_u32 s48, s51, 6
    s_and_b32 s48, s48, 7
    s_lshl_b32 s48, s48, 12
    s_add_u32 s48, s48, s56
    s_add_u32 s49, s48, 131072
    s_add_u32 s47, s48, 262144
    s_waitcnt vmcnt(12)
    v_mfma_f32_16x16x32_bf16 v[0:3], v[176:179], v[96:99], v[0:3]
    v_mfma_f32_16x16x32_bf16 v[0:3], v[192:195], v[108:111], v[0:3]
    buffer_load_dwordx4 v[72:75], v244, s[36:39], s48 offen offset:0 sc1
    v_mfma_f32_16x16x32_bf16 v[4:7], v[176:179], v[100:103], v[4:7]
    ds_read_b64_tr_b16 v[144:145], v236 offset:16384
    v_mfma_f32_16x16x32_bf16 v[4:7], v[192:195], v[112:115], v[4:7]
    ds_read_b64_tr_b16 v[146:147], v236 offset:18432
    v_mfma_f32_16x16x32_bf16 v[8:11], v[176:179], v[104:107], v[8:11]
    buffer_load_dwordx4 v[76:79], v244, s[36:39], s49 offen offset:0 sc1
    v_mfma_f32_16x16x32_bf16 v[8:11], v[192:195], v[116:119], v[8:11]
    ds_read_b64_tr_b16 v[160:161], v236 offset:20480
    s_waitcnt lgkmcnt(11)
    v_mfma_f32_16x16x32_bf16 v[12:15], v[180:183], v[96:99], v[12:15]
    ds_read_b64_tr_b16 v[162:163], v236 offset:22528
    v_mfma_f32_16x16x32_bf16 v[12:15], v[196:199], v[108:111], v[12:15]
    buffer_load_dwordx4 v[80:83], v244, s[36:39], s47 offen offset:0 sc1
    v_mfma_f32_16x16x32_bf16 v[16:19], v[180:183], v[100:103], v[16:19]
    ds_read_b64_tr_b16 v[148:149], v237 offset:16384
    v_mfma_f32_16x16x32_bf16 v[16:19], v[196:199], v[112:115], v[16:19]
    ds_read_b64_tr_b16 v[150:151], v237 offset:18432
    v_mfma_f32_16x16x32_bf16 v[20:23], v[180:183], v[104:107], v[20:23]
    buffer_load_dwordx4 v[84:87], v244, s[36:39], s48 offen offset:1024 sc1
    v_mfma_f32_16x16x32_bf16 v[20:23], v[196:199], v[116:119], v[20:23]
    ds_read_b64_tr_b16 v[164:165], v237 offset:20480
    s_waitcnt lgkmcnt(11)
    v_mfma_f32_16x16x32_bf16 v[24:27], v[184:187], v[96:99], v[24:27]
    v_mfma_f32_16x16x32_bf16 v[24:27], v[200:203], v[108:111], v[24:27]
    ds_read_b64_tr_b16 v[166:167], v237 offset:22528
    v_mfma_f32_16x16x32_bf16 v[28:31], v[184:187], v[100:103], v[28:31]
    buffer_load_dwordx4 v[88:91], v244, s[36:39], s49 offen offset:1024 sc1
    v_mfma_f32_16x16x32_bf16 v[28:31], v[200:203], v[112:115], v[28:31]
    ds_read_b64_tr_b16 v[152:153], v238 offset:16384
    v_mfma_f32_16x16x32_bf16 v[32:35], v[184:187], v[104:107], v[32:35]
    ds_read_b64_tr_b16 v[154:155], v238 offset:18432
    v_mfma_f32_16x16x32_bf16 v[32:35], v[200:203], v[116:119], v[32:35]
    buffer_load_dwordx4 v[92:95], v244, s[36:39], s47 offen offset:1024 sc1
    s_waitcnt lgkmcnt(10)
    v_mfma_f32_16x16x32_bf16 v[36:39], v[188:191], v[96:99], v[36:39]
    ds_read_b64_tr_b16 v[168:169], v238 offset:20480
    v_mfma_f32_16x16x32_bf16 v[36:39], v[204:207], v[108:111], v[36:39]
    ds_read_b64_tr_b16 v[170:171], v238 offset:22528
    v_mfma_f32_16x16x32_bf16 v[40:43], v[188:191], v[100:103], v[40:43]
    ds_read_b64_tr_b16 v[156:157], v239 offset:16384
    v_mfma_f32_16x16x32_bf16 v[40:43], v[204:207], v[112:115], v[40:43]
    ds_read_b64_tr_b16 v[158:159], v239 offset:18432
    v_mfma_f32_16x16x32_bf16 v[44:47], v[188:191], v[104:107], v[44:47]
    ds_read_b64_tr_b16 v[172:173], v239 offset:20480
    v_mfma_f32_16x16x32_bf16 v[44:47], v[204:207], v[116:119], v[44:47]
    s_waitcnt lgkmcnt(11)
    ds_read_b64_tr_b16 v[174:175], v239 offset:22528
    s_waitcnt vmcnt(12)
    v_mfma_f32_16x16x32_bf16 v[0:3], v[144:147], v[208:211], v[0:3]
    v_mfma_f32_16x16x32_bf16 v[0:3], v[160:163], v[220:223], v[0:3]
    buffer_load_dwordx4 v[96:99], v244, s[36:39], s48 offen offset:2048 sc1
    v_mfma_f32_16x16x32_bf16 v[4:7], v[144:147], v[212:215], v[4:7]
    ds_read_b64_tr_b16 v[176:177], v236 offset:24576
    v_mfma_f32_16x16x32_bf16 v[4:7], v[160:163], v[224:227], v[4:7]
    ds_read_b64_tr_b16 v[178:179], v236 offset:26624
    v_mfma_f32_16x16x32_bf16 v[8:11], v[144:147], v[216:219], v[8:11]
    buffer_load_dwordx4 v[100:103], v244, s[36:39], s49 offen offset:2048 sc1
    v_mfma_f32_16x16x32_bf16 v[8:11], v[160:163], v[228:231], v[8:11]
    ds_read_b64_tr_b16 v[192:193], v236 offset:28672
    s_waitcnt lgkmcnt(11)
    v_mfma_f32_16x16x32_bf16 v[12:15], v[148:151], v[208:211], v[12:15]
    ds_read_b64_tr_b16 v[194:195], v236 offset:30720
    v_mfma_f32_16x16x32_bf16 v[12:15], v[164:167], v[220:223], v[12:15]
    buffer_load_dwordx4 v[104:107], v244, s[36:39], s47 offen offset:2048 sc1
    v_mfma_f32_16x16x32_bf16 v[16:19], v[148:151], v[212:215], v[16:19]
    ds_read_b64_tr_b16 v[180:181], v237 offset:24576
    v_mfma_f32_16x16x32_bf16 v[16:19], v[164:167], v[224:227], v[16:19]
    ds_read_b64_tr_b16 v[182:183], v237 offset:26624
    v_mfma_f32_16x16x32_bf16 v[20:23], v[148:151], v[216:219], v[20:23]
    buffer_load_dwordx4 v[108:111], v244, s[36:39], s48 offen offset:3072 sc1
    v_mfma_f32_16x16x32_bf16 v[20:23], v[164:167], v[228:231], v[20:23]
    ds_read_b64_tr_b16 v[196:197], v237 offset:28672
    s_waitcnt lgkmcnt(11)
    v_mfma_f32_16x16x32_bf16 v[24:27], v[152:155], v[208:211], v[24:27]
    v_mfma_f32_16x16x32_bf16 v[24:27], v[168:171], v[220:223], v[24:27]
    ds_read_b64_tr_b16 v[198:199], v237 offset:30720
    v_mfma_f32_16x16x32_bf16 v[28:31], v[152:155], v[212:215], v[28:31]
    buffer_load_dwordx4 v[112:115], v244, s[36:39], s49 offen offset:3072 sc1
    v_mfma_f32_16x16x32_bf16 v[28:31], v[168:171], v[224:227], v[28:31]
    ds_read_b64_tr_b16 v[184:185], v238 offset:24576
    v_mfma_f32_16x16x32_bf16 v[32:35], v[152:155], v[216:219], v[32:35]
    ds_read_b64_tr_b16 v[186:187], v238 offset:26624
    v_mfma_f32_16x16x32_bf16 v[32:35], v[168:171], v[228:231], v[32:35]
    buffer_load_dwordx4 v[116:119], v244, s[36:39], s47 offen offset:3072 sc1
    s_waitcnt lgkmcnt(10)
    v_mfma_f32_16x16x32_bf16 v[36:39], v[156:159], v[208:211], v[36:39]
    ds_read_b64_tr_b16 v[200:201], v238 offset:28672
    v_mfma_f32_16x16x32_bf16 v[36:39], v[172:175], v[220:223], v[36:39]
    ds_read_b64_tr_b16 v[202:203], v238 offset:30720
    v_mfma_f32_16x16x32_bf16 v[40:43], v[156:159], v[212:215], v[40:43]
    ds_read_b64_tr_b16 v[188:189], v239 offset:24576
    v_mfma_f32_16x16x32_bf16 v[40:43], v[172:175], v[224:227], v[40:43]
    ds_read_b64_tr_b16 v[190:191], v239 offset:26624
    v_mfma_f32_16x16x32_bf16 v[44:47], v[156:159], v[216:219], v[44:47]
    ds_read_b64_tr_b16 v[204:205], v239 offset:28672
    v_mfma_f32_16x16x32_bf16 v[44:47], v[172:175], v[228:231], v[44:47]
    s_waitcnt lgkmcnt(11)
    ds_read_b64_tr_b16 v[206:207], v239 offset:30720
    s_add_u32 s48, s51, 7
    s_and_b32 s48, s48, 7
    s_lshl_b32 s48, s48, 12
    s_add_u32 s48, s48, s56
    s_add_u32 s49, s48, 131072
    s_add_u32 s47, s48, 262144
    s_waitcnt vmcnt(12)
    v_mfma_f32_16x16x32_bf16 v[0:3], v[176:179], v[48:51], v[0:3]
    v_mfma_f32_16x16x32_bf16 v[0:3], v[192:195], v[60:63], v[0:3]
    buffer_load_dwordx4 v[208:211], v244, s[36:39], s48 offen offset:0 sc1
    v_mfma_f32_16x16x32_bf16 v[4:7], v[176:179], v[52:55], v[4:7]
    ds_read_b64_tr_b16 v[144:145], v236 offset:32768
    v_mfma_f32_16x16x32_bf16 v[4:7], v[192:195], v[64:67], v[4:7]
    ds_read_b64_tr_b16 v[146:147], v236 offset:34816
    v_mfma_f32_16x16x32_bf16 v[8:11], v[176:179], v[56:59], v[8:11]
    buffer_load_dwordx4 v[212:215], v244, s[36:39], s49 offen offset:0 sc1
    v_mfma_f32_16x16x32_bf16 v[8:11], v[192:195], v[68:71], v[8:11]
    ds_read_b64_tr_b16 v[160:161], v236 offset:36864
    s_waitcnt lgkmcnt(11)
    v_mfma_f32_16x16x32_bf16 v[12:15], v[180:183], v[48:51], v[12:15]
    ds_read_b64_tr_b16 v[162:163], v236 offset:38912
    v_mfma_f32_16x16x32_bf16 v[12:15], v[196:199], v[60:63], v[12:15]
    buffer_load_dwordx4 v[216:219], v244, s[36:39], s47 offen offset:0 sc1
    v_mfma_f32_16x16x32_bf16 v[16:19], v[180:183], v[52:55], v[16:19]
    ds_read_b64_tr_b16 v[148:149], v237 offset:32768
    v_mfma_f32_16x16x32_bf16 v[16:19], v[196:199], v[64:67], v[16:19]
    ds_read_b64_tr_b16 v[150:151], v237 offset:34816
    v_mfma_f32_16x16x32_bf16 v[20:23], v[180:183], v[56:59], v[20:23]
    buffer_load_dwordx4 v[220:223], v244, s[36:39], s48 offen offset:1024 sc1
    v_mfma_f32_16x16x32_bf16 v[20:23], v[196:199], v[68:71], v[20:23]
    ds_read_b64_tr_b16 v[164:165], v237 offset:36864
    s_waitcnt lgkmcnt(11)
    v_mfma_f32_16x16x32_bf16 v[24:27], v[184:187], v[48:51], v[24:27]
    v_mfma_f32_16x16x32_bf16 v[24:27], v[200:203], v[60:63], v[24:27]
    ds_read_b64_tr_b16 v[166:167], v237 offset:38912
    v_mfma_f32_16x16x32_bf16 v[28:31], v[184:187], v[52:55], v[28:31]
    buffer_load_dwordx4 v[224:227], v244, s[36:39], s49 offen offset:1024 sc1
    v_mfma_f32_16x16x32_bf16 v[28:31], v[200:203], v[64:67], v[28:31]
    ds_read_b64_tr_b16 v[152:153], v238 offset:32768
    v_mfma_f32_16x16x32_bf16 v[32:35], v[184:187], v[56:59], v[32:35]
    ds_read_b64_tr_b16 v[154:155], v238 offset:34816
    v_mfma_f32_16x16x32_bf16 v[32:35], v[200:203], v[68:71], v[32:35]
    buffer_load_dwordx4 v[228:231], v244, s[36:39], s47 offen offset:1024 sc1
    s_waitcnt lgkmcnt(10)
    v_mfma_f32_16x16x32_bf16 v[36:39], v[188:191], v[48:51], v[36:39]
    ds_read_b64_tr_b16 v[168:169], v238 offset:36864
    v_mfma_f32_16x16x32_bf16 v[36:39], v[204:207], v[60:63], v[36:39]
    ds_read_b64_tr_b16 v[170:171], v238 offset:38912
    v_mfma_f32_16x16x32_bf16 v[40:43], v[188:191], v[52:55], v[40:43]
    ds_read_b64_tr_b16 v[156:157], v239 offset:32768
    v_mfma_f32_16x16x32_bf16 v[40:43], v[204:207], v[64:67], v[40:43]
    ds_read_b64_tr_b16 v[158:159], v239 offset:34816
    v_mfma_f32_16x16x32_bf16 v[44:47], v[188:191], v[56:59], v[44:47]
    ds_read_b64_tr_b16 v[172:173], v239 offset:36864
    v_mfma_f32_16x16x32_bf16 v[44:47], v[204:207], v[68:71], v[44:47]
    s_waitcnt lgkmcnt(11)
    ds_read_b64_tr_b16 v[174:175], v239 offset:38912
    s_waitcnt vmcnt(12)
    v_mfma_f32_16x16x32_bf16 v[0:3], v[144:147], v[72:75], v[0:3]
    v_mfma_f32_16x16x32_bf16 v[0:3], v[160:163], v[84:87], v[0:3]
    buffer_load_dwordx4 v[48:51], v244, s[36:39], s48 offen offset:2048 sc1
    v_mfma_f32_16x16x32_bf16 v[4:7], v[144:147], v[76:79], v[4:7]
    ds_read_b64_tr_b16 v[176:177], v236 offset:40960
    v_mfma_f32_16x16x32_bf16 v[4:7], v[160:163], v[88:91], v[4:7]
    ds_read_b64_tr_b16 v[178:179], v236 offset:43008
    v_mfma_f32_16x16x32_bf16 v[8:11], v[144:147], v[80:83], v[8:11]
    buffer_load_dwordx4 v[52:55], v244, s[36:39], s49 offen offset:2048 sc1
    v_mfma_f32_16x16x32_bf16 v[8:11], v[160:163], v[92:95], v[8:11]
    ds_read_b64_tr_b16 v[192:193], v236 offset:45056
    s_waitcnt lgkmcnt(11)
    v_mfma_f32_16x16x32_bf16 v[12:15], v[148:151], v[72:75], v[12:15]
    ds_read_b64_tr_b16 v[194:195], v236 offset:47104
    v_mfma_f32_16x16x32_bf16 v[12:15], v[164:167], v[84:87], v[12:15]
    buffer_load_dwordx4 v[56:59], v244, s[36:39], s47 offen offset:2048 sc1
    v_mfma_f32_16x16x32_bf16 v[16:19], v[148:151], v[76:79], v[16:19]
    ds_read_b64_tr_b16 v[180:181], v237 offset:40960
    v_mfma_f32_16x16x32_bf16 v[16:19], v[164:167], v[88:91], v[16:19]
    ds_read_b64_tr_b16 v[182:183], v237 offset:43008
    v_mfma_f32_16x16x32_bf16 v[20:23], v[148:151], v[80:83], v[20:23]
    buffer_load_dwordx4 v[60:63], v244, s[36:39], s48 offen offset:3072 sc1
    v_mfma_f32_16x16x32_bf16 v[20:23], v[164:167], v[92:95], v[20:23]
    ds_read_b64_tr_b16 v[196:197], v237 offset:45056
    s_waitcnt lgkmcnt(11)
    v_mfma_f32_16x16x32_bf16 v[24:27], v[152:155], v[72:75], v[24:27]
    v_mfma_f32_16x16x32_bf16 v[24:27], v[168:171], v[84:87], v[24:27]
    ds_read_b64_tr_b16 v[198:199], v237 offset:47104
    v_mfma_f32_16x16x32_bf16 v[28:31], v[152:155], v[76:79], v[28:31]
    buffer_load_dwordx4 v[64:67], v244, s[36:39], s49 offen offset:3072 sc1
    v_mfma_f32_16x16x32_bf16 v[28:31], v[168:171], v[88:91], v[28:31]
    ds_read_b64_tr_b16 v[184:185], v238 offset:40960
    v_mfma_f32_16x16x32_bf16 v[32:35], v[152:155], v[80:83], v[32:35]
    ds_read_b64_tr_b16 v[186:187], v238 offset:43008
    v_mfma_f32_16x16x32_bf16 v[32:35], v[168:171], v[92:95], v[32:35]
    buffer_load_dwordx4 v[68:71], v244, s[36:39], s47 offen offset:3072 sc1
    s_waitcnt lgkmcnt(10)
    v_mfma_f32_16x16x32_bf16 v[36:39], v[156:159], v[72:75], v[36:39]
    ds_read_b64_tr_b16 v[200:201], v238 offset:45056
    v_mfma_f32_16x16x32_bf16 v[36:39], v[172:175], v[84:87], v[36:39]
    ds_read_b64_tr_b16 v[202:203], v238 offset:47104
    v_mfma_f32_16x16x32_bf16 v[40:43], v[156:159], v[76:79], v[40:43]
    ds_read_b64_tr_b16 v[188:189], v239 offset:40960
    v_mfma_f32_16x16x32_bf16 v[40:43], v[172:175], v[88:91], v[40:43]
    ds_read_b64_tr_b16 v[190:191], v239 offset:43008
    v_mfma_f32_16x16x32_bf16 v[44:47], v[156:159], v[80:83], v[44:47]
    ds_read_b64_tr_b16 v[204:205], v239 offset:45056
    v_mfma_f32_16x16x32_bf16 v[44:47], v[172:175], v[92:95], v[44:47]
    s_waitcnt lgkmcnt(11)
    ds_read_b64_tr_b16 v[206:207], v239 offset:47104
    s_waitcnt vmcnt(12)
    v_mfma_f32_16x16x32_bf16 v[0:3], v[176:179], v[96:99], v[0:3]
    v_mfma_f32_16x16x32_bf16 v[0:3], v[192:195], v[108:111], v[0:3]
    ds_read_b64_tr_b16 v[144:145], v236 offset:49152
    v_mfma_f32_16x16x32_bf16 v[4:7], v[176:179], v[100:103], v[4:7]
    ds_read_b64_tr_b16 v[146:147], v236 offset:51200
    v_mfma_f32_16x16x32_bf16 v[4:7], v[192:195], v[112:115], v[4:7]
    v_mfma_f32_16x16x32_bf16 v[8:11], v[176:179], v[104:107], v[8:11]
    ds_read_b64_tr_b16 v[160:161], v236 offset:53248
    v_mfma_f32_16x16x32_bf16 v[8:11], v[192:195], v[116:119], v[8:11]
    s_waitcnt lgkmcnt(11)
    ds_read_b64_tr_b16 v[162:163], v236 offset:55296
    v_mfma_f32_16x16x32_bf16 v[12:15], v[180:183], v[96:99], v[12:15]
    v_mfma_f32_16x16x32_bf16 v[12:15], v[196:199], v[108:111], v[12:15]
    ds_read_b64_tr_b16 v[148:149], v237 offset:49152
    v_mfma_f32_16x16x32_bf16 v[16:19], v[180:183], v[100:103], v[16:19]
    ds_read_b64_tr_b16 v[150:151], v237 offset:51200
    v_mfma_f32_16x16x32_bf16 v[16:19], v[196:199], v[112:115], v[16:19]
    v_mfma_f32_16x16x32_bf16 v[20:23], v[180:183], v[104:107], v[20:23]
    ds_read_b64_tr_b16 v[164:165], v237 offset:53248
    v_mfma_f32_16x16x32_bf16 v[20:23], v[196:199], v[116:119], v[20:23]
    s_waitcnt lgkmcnt(11)
    ds_read_b64_tr_b16 v[166:167], v237 offset:55296
    v_mfma_f32_16x16x32_bf16 v[24:27], v[184:187], v[96:99], v[24:27]
    v_mfma_f32_16x16x32_bf16 v[24:27], v[200:203], v[108:111], v[24:27]
    ds_read_b64_tr_b16 v[152:153], v238 offset:49152
    v_mfma_f32_16x16x32_bf16 v[28:31], v[184:187], v[100:103], v[28:31]
    ds_read_b64_tr_b16 v[154:155], v238 offset:51200
    v_mfma_f32_16x16x32_bf16 v[28:31], v[200:203], v[112:115], v[28:31]
    v_mfma_f32_16x16x32_bf16 v[32:35], v[184:187], v[104:107], v[32:35]
    ds_read_b64_tr_b16 v[168:169], v238 offset:53248
    v_mfma_f32_16x16x32_bf16 v[32:35], v[200:203], v[116:119], v[32:35]
    s_waitcnt lgkmcnt(11)
    ds_read_b64_tr_b16 v[170:171], v238 offset:55296
    v_mfma_f32_16x16x32_bf16 v[36:39], v[188:191], v[96:99], v[36:39]
    v_mfma_f32_16x16x32_bf16 v[36:39], v[204:207], v[108:111], v[36:39]
    ds_read_b64_tr_b16 v[156:157], v239 offset:49152
    v_mfma_f32_16x16x32_bf16 v[40:43], v[188:191], v[100:103], v[40:43]
    ds_read_b64_tr_b16 v[158:159], v239 offset:51200
    v_mfma_f32_16x16x32_bf16 v[40:43], v[204:207], v[112:115], v[40:43]
    v_mfma_f32_16x16x32_bf16 v[44:47], v[188:191], v[104:107], v[44:47]
    ds_read_b64_tr_b16 v[172:173], v239 offset:53248
    v_mfma_f32_16x16x32_bf16 v[44:47], v[204:207], v[116:119], v[44:47]
    s_waitcnt lgkmcnt(11)
    ds_read_b64_tr_b16 v[174:175], v239 offset:55296
    s_waitcnt vmcnt(6)
    v_mfma_f32_16x16x32_bf16 v[0:3], v[144:147], v[208:211], v[0:3]
    v_mfma_f32_16x16x32_bf16 v[0:3], v[160:163], v[220:223], v[0:3]
    ds_read_b64_tr_b16 v[176:177], v236 offset:57344
    v_mfma_f32_16x16x32_bf16 v[4:7], v[144:147], v[212:215], v[4:7]
    ds_read_b64_tr_b16 v[178:179], v236 offset:59392
    v_mfma_f32_16x16x32_bf16 v[4:7], v[160:163], v[224:227], v[4:7]
    v_mfma_f32_16x16x32_bf16 v[8:11], v[144:147], v[216:219], v[8:11]
    ds_read_b64_tr_b16 v[192:193], v236 offset:61440
    v_mfma_f32_16x16x32_bf16 v[8:11], v[160:163], v[228:231], v[8:11]
    s_waitcnt lgkmcnt(11)
    ds_read_b64_tr_b16 v[194:195], v236 offset:63488
    v_mfma_f32_16x16x32_bf16 v[12:15], v[148:151], v[208:211], v[12:15]
    v_mfma_f32_16x16x32_bf16 v[12:15], v[164:167], v[220:223], v[12:15]
    ds_read_b64_tr_b16 v[180:181], v237 offset:57344
    v_mfma_f32_16x16x32_bf16 v[16:19], v[148:151], v[212:215], v[16:19]
    ds_read_b64_tr_b16 v[182:183], v237 offset:59392
    v_mfma_f32_16x16x32_bf16 v[16:19], v[164:167], v[224:227], v[16:19]
    v_mfma_f32_16x16x32_bf16 v[20:23], v[148:151], v[216:219], v[20:23]
    ds_read_b64_tr_b16 v[196:197], v237 offset:61440
    v_mfma_f32_16x16x32_bf16 v[20:23], v[164:167], v[228:231], v[20:23]
    s_waitcnt lgkmcnt(11)
    ds_read_b64_tr_b16 v[198:199], v237 offset:63488
    v_mfma_f32_16x16x32_bf16 v[24:27], v[152:155], v[208:211], v[24:27]
    v_mfma_f32_16x16x32_bf16 v[24:27], v[168:171], v[220:223], v[24:27]
    ds_read_b64_tr_b16 v[184:185], v238 offset:57344
    v_mfma_f32_16x16x32_bf16 v[28:31], v[152:155], v[212:215], v[28:31]
    ds_read_b64_tr_b16 v[186:187], v238 offset:59392
    v_mfma_f32_16x16x32_bf16 v[28:31], v[168:171], v[224:227], v[28:31]
    v_mfma_f32_16x16x32_bf16 v[32:35], v[152:155], v[216:219], v[32:35]
    ds_read_b64_tr_b16 v[200:201], v238 offset:61440
    v_mfma_f32_16x16x32_bf16 v[32:35], v[168:171], v[228:231], v[32:35]
    s_waitcnt lgkmcnt(11)
    ds_read_b64_tr_b16 v[202:203], v238 offset:63488
    v_mfma_f32_16x16x32_bf16 v[36:39], v[156:159], v[208:211], v[36:39]
    v_mfma_f32_16x16x32_bf16 v[36:39], v[172:175], v[220:223], v[36:39]
    ds_read_b64_tr_b16 v[188:189], v239 offset:57344
    v_mfma_f32_16x16x32_bf16 v[40:43], v[156:159], v[212:215], v[40:43]
    ds_read_b64_tr_b16 v[190:191], v239 offset:59392
    v_mfma_f32_16x16x32_bf16 v[40:43], v[172:175], v[224:227], v[40:43]
    v_mfma_f32_16x16x32_bf16 v[44:47], v[156:159], v[216:219], v[44:47]
    ds_read_b64_tr_b16 v[204:205], v239 offset:61440
    v_mfma_f32_16x16x32_bf16 v[44:47], v[172:175], v[228:231], v[44:47]
    s_waitcnt lgkmcnt(11)
    ds_read_b64_tr_b16 v[206:207], v239 offset:63488
    s_waitcnt vmcnt(0)
    v_mfma_f32_16x16x32_bf16 v[0:3], v[176:179], v[48:51], v[0:3]
    v_mfma_f32_16x16x32_bf16 v[0:3], v[192:195], v[60:63], v[0:3]
    v_mfma_f32_16x16x32_bf16 v[4:7], v[176:179], v[52:55], v[4:7]
    v_mfma_f32_16x16x32_bf16 v[4:7], v[192:195], v[64:67], v[4:7]
    v_mfma_f32_16x16x32_bf16 v[8:11], v[176:179], v[56:59], v[8:11]
    v_mfma_f32_16x16x32_bf16 v[8:11], v[192:195], v[68:71], v[8:11]
    s_waitcnt lgkmcnt(8)
    v_mfma_f32_16x16x32_bf16 v[12:15], v[180:183], v[48:51], v[12:15]
    v_mfma_f32_16x16x32_bf16 v[12:15], v[196:199], v[60:63], v[12:15]
    v_mfma_f32_16x16x32_bf16 v[16:19], v[180:183], v[52:55], v[16:19]
    v_mfma_f32_16x16x32_bf16 v[16:19], v[196:199], v[64:67], v[16:19]
    v_max3_f32 v130, abs(v0), abs(v1), abs(v2)
    v_max3_f32 v130, v130, abs(v3), abs(v4)
    v_max3_f32 v130, v130, abs(v5), abs(v6)
    v_mfma_f32_16x16x32_bf16 v[20:23], v[180:183], v[56:59], v[20:23]
    v_max3_f32 v130, v130, abs(v7), abs(v8)
    v_max3_f32 v130, v130, abs(v9), abs(v10)
    v_max3_f32 v130, v130, abs(v11), abs(v11)
    v_mfma_f32_16x16x32_bf16 v[20:23], v[196:199], v[68:71], v[20:23]
    v_frexp_exp_i32_f32 v130, v130
    v_max_i32 v130, 0xffffff9c, v130
    v_sub_u32 v131, 15, v130
    v_ldexp_f32 v132, 1.0, v131
    s_waitcnt lgkmcnt(4)
    v_mfma_f32_16x16x32_bf16 v[24:27], v[184:187], v[48:51], v[24:27]
    v_subrev_u32 v130, 15, v130
    v_ldexp_f32 v124, 1.0, v130
    v_pk_mul_f32 v[134:135], v[0:1], v[132:133] op_sel_hi:[1,0]
    v_mfma_f32_16x16x32_bf16 v[24:27], v[200:203], v[60:63], v[24:27]
    v_cvt_pk_f16_f32 v100, v134, v135
    v_pk_mul_f32 v[136:137], v[2:3], v[132:133] op_sel_hi:[1,0]
    v_cvt_pk_f16_f32 v101, v136, v137
    v_pk_mul_f32 v[138:139], v[4:5], v[132:133] op_sel_hi:[1,0]
    v_mfma_f32_16x16x32_bf16 v[28:31], v[184:187], v[52:55], v[28:31]
    v_cvt_pk_f16_f32 v102, v138, v139
    v_pk_mul_f32 v[134:135], v[6:7], v[132:133] op_sel_hi:[1,0]
    v_cvt_pk_f16_f32 v103, v134, v135
    v_mfma_f32_16x16x32_bf16 v[28:31], v[200:203], v[64:67], v[28:31]
    v_pk_mul_f32 v[136:137], v[8:9], v[132:133] op_sel_hi:[1,0]
    v_cvt_pk_f16_f32 v104, v136, v137
    v_pk_mul_f32 v[138:139], v[10:11], v[132:133] op_sel_hi:[1,0]
    v_cvt_pk_f16_f32 v105, v138, v139
    v_mfma_f32_16x16x32_bf16 v[32:35], v[184:187], v[56:59], v[32:35]
    v_max3_f32 v130, abs(v12), abs(v13), abs(v14)
    v_max3_f32 v130, v130, abs(v15), abs(v16)
    v_max3_f32 v130, v130, abs(v17), abs(v18)
    v_mfma_f32_16x16x32_bf16 v[32:35], v[200:203], v[68:71], v[32:35]
    v_max3_f32 v130, v130, abs(v19), abs(v20)
    v_max3_f32 v130, v130, abs(v21), abs(v22)
    v_max3_f32 v130, v130, abs(v23), abs(v23)
    s_waitcnt lgkmcnt(0)
    v_mfma_f32_16x16x32_bf16 v[36:39], v[188:191], v[48:51], v[36:39]
    v_frexp_exp_i32_f32 v130, v130
    v_max_i32 v130, 0xffffff9c, v130
    v_sub_u32 v131, 15, v130
    v_mfma_f32_16x16x32_bf16 v[36:39], v[204:207], v[60:63], v[36:39]
    v_ldexp_f32 v132, 1.0, v131
    v_subrev_u32 v130, 15, v130
    v_ldexp_f32 v125, 1.0, v130
    v_mfma_f32_16x16x32_bf16 v[40:43], v[188:191], v[52:55], v[40:43]
    v_pk_mul_f32 v[134:135], v[12:13], v[132:133] op_sel_hi:[1,0]
    v_cvt_pk_f16_f32 v106, v134, v135
    v_pk_mul_f32 v[136:137], v[14:15], v[132:133] op_sel_hi:[1,0]
    v_mfma_f32_16x16x32_bf16 v[40:43], v[204:207], v[64:67], v[40:43]
    v_cvt_pk_f16_f32 v107, v136, v137
    v_pk_mul_f32 v[138:139], v[16:17], v[132:133] op_sel_hi:[1,0]
    v_cvt_pk_f16_f32 v108, v138, v139
    v_mfma_f32_16x16x32_bf16 v[44:47], v[188:191], v[56:59], v[44:47]
    v_pk_mul_f32 v[134:135], v[18:19], v[132:133] op_sel_hi:[1,0]
    v_cvt_pk_f16_f32 v109, v134, v135
    v_pk_mul_f32 v[136:137], v[20:21], v[132:133] op_sel_hi:[1,0]
    v_mfma_f32_16x16x32_bf16 v[44:47], v[204:207], v[68:71], v[44:47]
    v_cvt_pk_f16_f32 v110, v136, v137
    v_pk_mul_f32 v[138:139], v[22:23], v[132:133] op_sel_hi:[1,0]
    v_cvt_pk_f16_f32 v111, v138, v139
A_pe0:
    s_add_u32 s46, s57, s54
    s_lshl_b32 s47, s46, 13
    s_add_u32 s47, s47, 20971520
    s_add_u32 s48, s47, 4096
    s_cmp_eq_u32 s55, s54
    s_cbranch_scc1 A_own0
    buffer_store_dwordx4 v[100:103], v244, s[36:39], s47 offen offset:0 sc1
    buffer_store_dwordx4 v[104:107], v244, s[36:39], s47 offen offset:1024 sc1
    buffer_store_dwordx4 v[108:111], v244, s[36:39], s47 offen offset:2048 sc1
    v_max3_f32 v130, abs(v24), abs(v25), abs(v26)
    v_max3_f32 v130, v130, abs(v27), abs(v28)
    v_max3_f32 v130, v130, abs(v29), abs(v30)
    v_max3_f32 v130, v130, abs(v31), abs(v32)
    v_max3_f32 v130, v130, abs(v33), abs(v34)
    v_max3_f32 v130, v130, abs(v35), abs(v35)
    v_frexp_exp_i32_f32 v130, v130
    v_max_i32 v130, 0xffffff9c, v130
    v_sub_u32 v131, 15, v130
    v_ldexp_f32 v132, 1.0, v131
    v_subrev_u32 v130, 15, v130
    v_ldexp_f32 v126, 1.0, v130
    v_pk_mul_f32 v[134:135], v[24:25], v[132:133] op_sel_hi:[1,0]
    v_cvt_pk_f16_f32 v112, v134, v135
    v_pk_mul_f32 v[136:137], v[26:27], v[132:133] op_sel_hi:[1,0]
    v_cvt_pk_f16_f32 v113, v136, v137
    v_pk_mul_f32 v[138:139], v[28:29], v[132:133] op_sel_hi:[1,0]
    v_cvt_pk_f16_f32 v114, v138, v139
    v_pk_mul_f32 v[134:135], v[30:31], v[132:133] op_sel_hi:[1,0]
    v_cvt_pk_f16_f32 v115, v134, v135
    v_pk_mul_f32 v[136:137], v[32:33], v[132:133] op_sel_hi:[1,0]
    v_cvt_pk_f16_f32 v116, v136, v137
    v_pk_mul_f32 v[138:139], v[34:35], v[132:133] op_sel_hi:[1,0]
    v_cvt_pk_f16_f32 v117, v138, v139
    buffer_store_dwordx4 v[112:115], v244, s[36:39], s47 offen offset:3072 sc1
    v_max3_f32 v130, abs(v36), abs(v37), abs(v38)
    v_max3_f32 v130, v130, abs(v39), abs(v40)
    v_max3_f32 v130, v130, abs(v41), abs(v42)
    v_max3_f32 v130, v130, abs(v43), abs(v44)
    v_max3_f32 v130, v130, abs(v45), abs(v46)
    v_max3_f32 v130, v130, abs(v47), abs(v47)
    v_frexp_exp_i32_f32 v130, v130
    v_max_i32 v130, 0xffffff9c, v130
    v_sub_u32 v131, 15, v130
    v_ldexp_f32 v132, 1.0, v131
    v_subrev_u32 v130, 15, v130
    v_ldexp_f32 v127, 1.0, v130
    v_pk_mul_f32 v[134:135], v[36:37], v[132:133] op_sel_hi:[1,0]
    v_cvt_pk_f16_f32 v118, v134, v135
    v_pk_mul_f32 v[136:137], v[38:39], v[132:133] op_sel_hi:[1,0]
    v_cvt_pk_f16_f32 v119, v136, v137
    v_pk_mul_f32 v[138:139], v[40:41], v[132:133] op_sel_hi:[1,0]
    v_cvt_pk_f16_f32 v120, v138, v139
    v_pk_mul_f32 v[134:135], v[42:43], v[132:133] op_sel_hi:[1,0]
    v_cvt_pk_f16_f32 v121, v134, v135
    v_pk_mul_f32 v[136:137], v[44:45], v[132:133] op_sel_hi:[1,0]
    v_cvt_pk_f16_f32 v122, v136, v137
    v_pk_mul_f32 v[138:139], v[46:47], v[132:133] op_sel_hi:[1,0]
    v_cvt_pk_f16_f32 v123, v138, v139
    buffer_store_dwordx4 v[116:119], v244, s[36:39], s48 offen offset:0 sc1
    buffer_store_dwordx4 v[120:123], v244, s[36:39], s48 offen offset:1024 sc1
    buffer_store_dwordx4 v[124:127], v244, s[36:39], s48 offen offset:2048 sc1
    s_lshr_b32 s47, s46, 3
    s_lshl_b32 s47, s47, 7
    s_and_b32 s46, s46, 7
    s_lshl_b32 s46, s46, 2
    s_add_u32 s46, s46, s47
    s_add_u32 s46, s46, 16793600
    v_mov_b32 v200, 0
    v_mov_b32 v201, 1
    s_waitcnt vmcnt(0)
    s_mov_b64 exec, 1
    buffer_store_dword v201, v200, s[36:39], s46 offen sc1
    s_mov_b64 exec, -1
    s_endpgm
A_own0:
    v_and_b32 v250, 3, v255
    v_cmp_ne_u32 s[48:49], s54, v250
    v_lshlrev_b32 v250, 2, v250
    s_lshr_b32 s47, s57, 3
    s_lshl_b32 s47, s47, 7
    s_and_b32 s46, s57, 7
    s_lshl_b32 s46, s46, 2
    s_add_u32 s46, s46, s47
    s_add_u32 s46, s46, 16793600
    s_mov_b32 s20, s14
    s_and_b32 s21, s15, 0xffff
    s_mov_b32 s22, 1572864
    s_mov_b32 s23, 0x00020000
    v_and_b32 v200, 1, v254
    v_lshrrev_b32 v201, 1, v254
    v_lshl_or_b32 v200, v200, 1, v201
    v_lshlrev_b32 v200, 4, v200
    v_lshl_add_u32 v200, v253, 10, v200
    s_mov_b32 s3, 0
A_ow0:
    buffer_load_dword v251, v250, s[36:39], s46 offen sc1
    s_add_u32 s3, s3, 1
    s_waitcnt vmcnt(0)
    v_cmp_ne_u32 vcc, 1, v251
    s_nop 0
    s_and_b64 vcc, vcc, s[48:49]
    s_cbranch_vccz A_og0
    s_sleep 1
    s_cmp_lt_u32 s3, 0x40000
    s_cbranch_scc1 A_ow0
A_og0:
    s_add_u32 s46, s54, 1
    s_and_b32 s46, s46, 3
    s_add_u32 s46, s46, s57
    s_lshl_b32 s46, s46, 13
    s_add_u32 s46, s46, 20971520
    s_add_u32 s47, s46, 4096
    buffer_load_dwordx4 v[72:75], v244, s[36:39], s47 offen offset:2048 sc1
    buffer_load_dwordx4 v[48:51], v244, s[36:39], s46 offen offset:0 sc1
    buffer_load_dwordx4 v[52:55], v244, s[36:39], s46 offen offset:1024 sc1
    buffer_load_dwordx4 v[56:59], v244, s[36:39], s46 offen offset:2048 sc1
    buffer_load_dwordx4 v[60:63], v244, s[36:39], s46 offen offset:3072 sc1
    buffer_load_dwordx4 v[64:67], v244, s[36:39], s47 offen offset:0 sc1
    buffer_load_dwordx4 v[68:71], v244, s[36:39], s47 offen offset:1024 sc1
    s_add_u32 s46, s54, 2
    s_and_b32 s46, s46, 3
    s_add_u32 s46, s46, s57
    s_lshl_b32 s46, s46, 13
    s_add_u32 s46, s46, 20971520
    s_add_u32 s47, s46, 4096
    buffer_load_dwordx4 v[100:103], v244, s[36:39], s47 offen offset:2048 sc1
    buffer_load_dwordx4 v[76:79], v244, s[36:39], s46 offen offset:0 sc1
    buffer_load_dwordx4 v[80:83], v244, s[36:39], s46 offen offset:1024 sc1
    buffer_load_dwordx4 v[84:87], v244, s[36:39], s46 offen offset:2048 sc1
    buffer_load_dwordx4 v[88:91], v244, s[36:39], s46 offen offset:3072 sc1
    buffer_load_dwordx4 v[92:95], v244, s[36:39], s47 offen offset:0 sc1
    buffer_load_dwordx4 v[96:99], v244, s[36:39], s47 offen offset:1024 sc1
    s_add_u32 s46, s54, 3
    s_and_b32 s46, s46, 3
    s_add_u32 s46, s46, s57
    s_lshl_b32 s46, s46, 13
    s_add_u32 s46, s46, 20971520
    s_add_u32 s47, s46, 4096
    buffer_load_dwordx4 v[128:131], v244, s[36:39], s47 offen offset:2048 sc1
    buffer_load_dwordx4 v[104:107], v244, s[36:39], s46 offen offset:0 sc1
    buffer_load_dwordx4 v[108:111], v244, s[36:39], s46 offen offset:1024 sc1
    buffer_load_dwordx4 v[112:115], v244, s[36:39], s46 offen offset:2048 sc1
    buffer_load_dwordx4 v[116:119], v244, s[36:39], s46 offen offset:3072 sc1
    buffer_load_dwordx4 v[120:123], v244, s[36:39], s47 offen offset:0 sc1
    buffer_load_dwordx4 v[124:127], v244, s[36:39], s47 offen offset:1024 sc1
    s_lshl_b32 s46, s45, 2
    s_add_u32 s46, s46, s55
    s_mul_i32 s46, s46, 49152
    s_lshl_b32 s47, s51, 7
    s_add_u32 s46, s46, s47
    s_waitcnt vmcnt(19)
    v_fma_mix_f32 v0, v48, v72, v0 op_sel_hi:[1,0,0]
    v_fma_mix_f32 v1, v48, v72, v1 op_sel:[1,0,0] op_sel_hi:[1,0,0]
    v_fma_mix_f32 v2, v49, v72, v2 op_sel_hi:[1,0,0]
    v_fma_mix_f32 v3, v49, v72, v3 op_sel:[1,0,0] op_sel_hi:[1,0,0]
    v_fma_mix_f32 v4, v50, v72, v4 op_sel_hi:[1,0,0]
    v_fma_mix_f32 v5, v50, v72, v5 op_sel:[1,0,0] op_sel_hi:[1,0,0]
    v_fma_mix_f32 v6, v51, v72, v6 op_sel_hi:[1,0,0]
    v_fma_mix_f32 v7, v51, v72, v7 op_sel:[1,0,0] op_sel_hi:[1,0,0]
    s_waitcnt vmcnt(18)
    v_fma_mix_f32 v8, v52, v72, v8 op_sel_hi:[1,0,0]
    v_fma_mix_f32 v9, v52, v72, v9 op_sel:[1,0,0] op_sel_hi:[1,0,0]
    v_fma_mix_f32 v10, v53, v72, v10 op_sel_hi:[1,0,0]
    v_fma_mix_f32 v11, v53, v72, v11 op_sel:[1,0,0] op_sel_hi:[1,0,0]
    v_fma_mix_f32 v12, v54, v73, v12 op_sel_hi:[1,0,0]
    v_fma_mix_f32 v13, v54, v73, v13 op_sel:[1,0,0] op_sel_hi:[1,0,0]
    v_fma_mix_f32 v14, v55, v73, v14 op_sel_hi:[1,0,0]
    v_fma_mix_f32 v15, v55, v73, v15 op_sel:[1,0,0] op_sel_hi:[1,0,0]
    s_waitcnt vmcnt(17)
    v_fma_mix_f32 v16, v56, v73, v16 op_sel_hi:[1,0,0]
    v_fma_mix_f32 v17, v56, v73, v17 op_sel:[1,0,0] op_sel_hi:[1,0,0]
    v_fma_mix_f32 v18, v57, v73, v18 op_sel_hi:[1,0,0]
    v_fma_mix_f32 v19, v57, v73, v19 op_sel:[1,0,0] op_sel_hi:[1,0,0]
    v_fma_mix_f32 v20, v58, v73, v20 op_sel_hi:[1,0,0]
    v_fma_mix_f32 v21, v58, v73, v21 op_sel:[1,0,0] op_sel_hi:[1,0,0]
    v_fma_mix_f32 v22, v59, v73, v22 op_sel_hi:[1,0,0]
    v_fma_mix_f32 v23, v59, v73, v23 op_sel:[1,0,0] op_sel_hi:[1,0,0]
    s_waitcnt vmcnt(16)
    v_fma_mix_f32 v24, v60, v74, v24 op_sel_hi:[1,0,0]
    v_fma_mix_f32 v25, v60, v74, v25 op_sel:[1,0,0] op_sel_hi:[1,0,0]
    v_fma_mix_f32 v26, v61, v74, v26 op_sel_hi:[1,0,0]
    v_fma_mix_f32 v27, v61, v74, v27 op_sel:[1,0,0] op_sel_hi:[1,0,0]
    v_fma_mix_f32 v28, v62, v74, v28 op_sel_hi:[1,0,0]
    v_fma_mix_f32 v29, v62, v74, v29 op_sel:[1,0,0] op_sel_hi:[1,0,0]
    v_fma_mix_f32 v30, v63, v74, v30 op_sel_hi:[1,0,0]
    v_fma_mix_f32 v31, v63, v74, v31 op_sel:[1,0,0] op_sel_hi:[1,0,0]
    s_waitcnt vmcnt(15)
    v_fma_mix_f32 v32, v64, v74, v32 op_sel_hi:[1,0,0]
    v_fma_mix_f32 v33, v64, v74, v33 op_sel:[1,0,0] op_sel_hi:[1,0,0]
    v_fma_mix_f32 v34, v65, v74, v34 op_sel_hi:[1,0,0]
    v_fma_mix_f32 v35, v65, v74, v35 op_sel:[1,0,0] op_sel_hi:[1,0,0]
    v_fma_mix_f32 v36, v66, v75, v36 op_sel_hi:[1,0,0]
    v_fma_mix_f32 v37, v66, v75, v37 op_sel:[1,0,0] op_sel_hi:[1,0,0]
    v_fma_mix_f32 v38, v67, v75, v38 op_sel_hi:[1,0,0]
    v_fma_mix_f32 v39, v67, v75, v39 op_sel:[1,0,0] op_sel_hi:[1,0,0]
    s_waitcnt vmcnt(14)
    v_fma_mix_f32 v40, v68, v75, v40 op_sel_hi:[1,0,0]
    v_fma_mix_f32 v41, v68, v75, v41 op_sel:[1,0,0] op_sel_hi:[1,0,0]
    v_fma_mix_f32 v42, v69, v75, v42 op_sel_hi:[1,0,0]
    v_fma_mix_f32 v43, v69, v75, v43 op_sel:[1,0,0] op_sel_hi:[1,0,0]
    v_fma_mix_f32 v44, v70, v75, v44 op_sel_hi:[1,0,0]
    v_fma_mix_f32 v45, v70, v75, v45 op_sel:[1,0,0] op_sel_hi:[1,0,0]
    v_fma_mix_f32 v46, v71, v75, v46 op_sel_hi:[1,0,0]
    v_fma_mix_f32 v47, v71, v75, v47 op_sel:[1,0,0] op_sel_hi:[1,0,0]
    s_waitcnt vmcnt(12)
    v_fma_mix_f32 v0, v76, v100, v0 op_sel_hi:[1,0,0]
    v_fma_mix_f32 v1, v76, v100, v1 op_sel:[1,0,0] op_sel_hi:[1,0,0]
    v_fma_mix_f32 v2, v77, v100, v2 op_sel_hi:[1,0,0]
    v_fma_mix_f32 v3, v77, v100, v3 op_sel:[1,0,0] op_sel_hi:[1,0,0]
    v_fma_mix_f32 v4, v78, v100, v4 op_sel_hi:[1,0,0]
    v_fma_mix_f32 v5, v78, v100, v5 op_sel:[1,0,0] op_sel_hi:[1,0,0]
    v_fma_mix_f32 v6, v79, v100, v6 op_sel_hi:[1,0,0]
    v_fma_mix_f32 v7, v79, v100, v7 op_sel:[1,0,0] op_sel_hi:[1,0,0]
    s_waitcnt vmcnt(11)
    v_fma_mix_f32 v8, v80, v100, v8 op_sel_hi:[1,0,0]
    v_fma_mix_f32 v9, v80, v100, v9 op_sel:[1,0,0] op_sel_hi:[1,0,0]
    v_fma_mix_f32 v10, v81, v100, v10 op_sel_hi:[1,0,0]
    v_fma_mix_f32 v11, v81, v100, v11 op_sel:[1,0,0] op_sel_hi:[1,0,0]
    v_fma_mix_f32 v12, v82, v101, v12 op_sel_hi:[1,0,0]
    v_fma_mix_f32 v13, v82, v101, v13 op_sel:[1,0,0] op_sel_hi:[1,0,0]
    v_fma_mix_f32 v14, v83, v101, v14 op_sel_hi:[1,0,0]
    v_fma_mix_f32 v15, v83, v101, v15 op_sel:[1,0,0] op_sel_hi:[1,0,0]
    s_waitcnt vmcnt(10)
    v_fma_mix_f32 v16, v84, v101, v16 op_sel_hi:[1,0,0]
    v_fma_mix_f32 v17, v84, v101, v17 op_sel:[1,0,0] op_sel_hi:[1,0,0]
    v_fma_mix_f32 v18, v85, v101, v18 op_sel_hi:[1,0,0]
    v_fma_mix_f32 v19, v85, v101, v19 op_sel:[1,0,0] op_sel_hi:[1,0,0]
    v_fma_mix_f32 v20, v86, v101, v20 op_sel_hi:[1,0,0]
    v_fma_mix_f32 v21, v86, v101, v21 op_sel:[1,0,0] op_sel_hi:[1,0,0]
    v_fma_mix_f32 v22, v87, v101, v22 op_sel_hi:[1,0,0]
    v_fma_mix_f32 v23, v87, v101, v23 op_sel:[1,0,0] op_sel_hi:[1,0,0]
    s_waitcnt vmcnt(9)
    v_fma_mix_f32 v24, v88, v102, v24 op_sel_hi:[1,0,0]
    v_fma_mix_f32 v25, v88, v102, v25 op_sel:[1,0,0] op_sel_hi:[1,0,0]
    v_fma_mix_f32 v26, v89, v102, v26 op_sel_hi:[1,0,0]
    v_fma_mix_f32 v27, v89, v102, v27 op_sel:[1,0,0] op_sel_hi:[1,0,0]
    v_fma_mix_f32 v28, v90, v102, v28 op_sel_hi:[1,0,0]
    v_fma_mix_f32 v29, v90, v102, v29 op_sel:[1,0,0] op_sel_hi:[1,0,0]
    v_fma_mix_f32 v30, v91, v102, v30 op_sel_hi:[1,0,0]
    v_fma_mix_f32 v31, v91, v102, v31 op_sel:[1,0,0] op_sel_hi:[1,0,0]
    s_waitcnt vmcnt(8)
    v_fma_mix_f32 v32, v92, v102, v32 op_sel_hi:[1,0,0]
    v_fma_mix_f32 v33, v92, v102, v33 op_sel:[1,0,0] op_sel_hi:[1,0,0]
    v_fma_mix_f32 v34, v93, v102, v34 op_sel_hi:[1,0,0]
    v_fma_mix_f32 v35, v93, v102, v35 op_sel:[1,0,0] op_sel_hi:[1,0,0]
    v_fma_mix_f32 v36, v94, v103, v36 op_sel_hi:[1,0,0]
    v_fma_mix_f32 v37, v94, v103, v37 op_sel:[1,0,0] op_sel_hi:[1,0,0]
    v_fma_mix_f32 v38, v95, v103, v38 op_sel_hi:[1,0,0]
    v_fma_mix_f32 v39, v95, v103, v39 op_sel:[1,0,0] op_sel_hi:[1,0,0]
    s_waitcnt vmcnt(7)
    v_fma_mix_f32 v40, v96, v103, v40 op_sel_hi:[1,0,0]
    v_fma_mix_f32 v41, v96, v103, v41 op_sel:[1,0,0] op_sel_hi:[1,0,0]
    v_fma_mix_f32 v42, v97, v103, v42 op_sel_hi:[1,0,0]
    v_fma_mix_f32 v43, v97, v103, v43 op_sel:[1,0,0] op_sel_hi:[1,0,0]
    v_fma_mix_f32 v44, v98, v103, v44 op_sel_hi:[1,0,0]
    v_fma_mix_f32 v45, v98, v103, v45 op_sel:[1,0,0] op_sel_hi:[1,0,0]
    v_fma_mix_f32 v46, v99, v103, v46 op_sel_hi:[1,0,0]
    v_fma_mix_f32 v47, v99, v103, v47 op_sel:[1,0,0] op_sel_hi:[1,0,0]
    s_waitcnt vmcnt(5)
    v_fma_mix_f32 v0, v104, v128, v0 op_sel_hi:[1,0,0]
    v_fma_mix_f32 v1, v104, v128, v1 op_sel:[1,0,0] op_sel_hi:[1,0,0]
    v_fma_mix_f32 v2, v105, v128, v2 op_sel_hi:[1,0,0]
    v_fma_mix_f32 v3, v105, v128, v3 op_sel:[1,0,0] op_sel_hi:[1,0,0]
    v_fma_mix_f32 v4, v106, v128, v4 op_sel_hi:[1,0,0]
    v_fma_mix_f32 v5, v106, v128, v5 op_sel:[1,0,0] op_sel_hi:[1,0,0]
    v_fma_mix_f32 v6, v107, v128, v6 op_sel_hi:[1,0,0]
    v_fma_mix_f32 v7, v107, v128, v7 op_sel:[1,0,0] op_sel_hi:[1,0,0]
    s_waitcnt vmcnt(4)
    v_fma_mix_f32 v8, v108, v128, v8 op_sel_hi:[1,0,0]
    v_fma_mix_f32 v9, v108, v128, v9 op_sel:[1,0,0] op_sel_hi:[1,0,0]
    v_fma_mix_f32 v10, v109, v128, v10 op_sel_hi:[1,0,0]
    v_fma_mix_f32 v11, v109, v128, v11 op_sel:[1,0,0] op_sel_hi:[1,0,0]
    v_fma_mix_f32 v12, v110, v129, v12 op_sel_hi:[1,0,0]
    v_fma_mix_f32 v13, v110, v129, v13 op_sel:[1,0,0] op_sel_hi:[1,0,0]
    v_fma_mix_f32 v14, v111, v129, v14 op_sel_hi:[1,0,0]
    v_fma_mix_f32 v15, v111, v129, v15 op_sel:[1,0,0] op_sel_hi:[1,0,0]
    s_waitcnt vmcnt(3)
    v_fma_mix_f32 v16, v112, v129, v16 op_sel_hi:[1,0,0]
    v_fma_mix_f32 v17, v112, v129, v17 op_sel:[1,0,0] op_sel_hi:[1,0,0]
    v_fma_mix_f32 v18, v113, v129, v18 op_sel_hi:[1,0,0]
    v_fma_mix_f32 v19, v113, v129, v19 op_sel:[1,0,0] op_sel_hi:[1,0,0]
    v_fma_mix_f32 v20, v114, v129, v20 op_sel_hi:[1,0,0]
    v_fma_mix_f32 v21, v114, v129, v21 op_sel:[1,0,0] op_sel_hi:[1,0,0]
    v_fma_mix_f32 v22, v115, v129, v22 op_sel_hi:[1,0,0]
    v_fma_mix_f32 v23, v115, v129, v23 op_sel:[1,0,0] op_sel_hi:[1,0,0]
    s_waitcnt vmcnt(2)
    v_fma_mix_f32 v24, v116, v130, v24 op_sel_hi:[1,0,0]
    v_fma_mix_f32 v25, v116, v130, v25 op_sel:[1,0,0] op_sel_hi:[1,0,0]
    v_fma_mix_f32 v26, v117, v130, v26 op_sel_hi:[1,0,0]
    v_fma_mix_f32 v27, v117, v130, v27 op_sel:[1,0,0] op_sel_hi:[1,0,0]
    v_fma_mix_f32 v28, v118, v130, v28 op_sel_hi:[1,0,0]
    v_fma_mix_f32 v29, v118, v130, v29 op_sel:[1,0,0] op_sel_hi:[1,0,0]
    v_fma_mix_f32 v30, v119, v130, v30 op_sel_hi:[1,0,0]
    v_fma_mix_f32 v31, v119, v130, v31 op_sel:[1,0,0] op_sel_hi:[1,0,0]
    s_waitcnt vmcnt(1)
    v_fma_mix_f32 v32, v120, v130, v32 op_sel_hi:[1,0,0]
    v_fma_mix_f32 v33, v120, v130, v33 op_sel:[1,0,0] op_sel_hi:[1,0,0]
    v_fma_mix_f32 v34, v121, v130, v34 op_sel_hi:[1,0,0]
    v_fma_mix_f32 v35, v121, v130, v35 op_sel:[1,0,0] op_sel_hi:[1,0,0]
    v_fma_mix_f32 v36, v122, v131, v36 op_sel_hi:[1,0,0]
    v_fma_mix_f32 v37, v122, v131, v37 op_sel:[1,0,0] op_sel_hi:[1,0,0]
    v_fma_mix_f32 v38, v123, v131, v38 op_sel_hi:[1,0,0]
    v_fma_mix_f32 v39, v123, v131, v39 op_sel:[1,0,0] op_sel_hi:[1,0,0]
    s_waitcnt vmcnt(0)
    v_fma_mix_f32 v40, v124, v131, v40 op_sel_hi:[1,0,0]
    v_fma_mix_f32 v41, v124, v131, v41 op_sel:[1,0,0] op_sel_hi:[1,0,0]
    v_fma_mix_f32 v42, v125, v131, v42 op_sel_hi:[1,0,0]
    v_fma_mix_f32 v43, v125, v131, v43 op_sel:[1,0,0] op_sel_hi:[1,0,0]
    v_fma_mix_f32 v44, v126, v131, v44 op_sel_hi:[1,0,0]
    v_fma_mix_f32 v45, v126, v131, v45 op_sel:[1,0,0] op_sel_hi:[1,0,0]
    v_fma_mix_f32 v46, v127, v131, v46 op_sel_hi:[1,0,0]
    v_fma_mix_f32 v47, v127, v131, v47 op_sel:[1,0,0] op_sel_hi:[1,0,0]
    v_cvt_pk_bf16_f32 v204, v0, v1
    v_cvt_pk_bf16_f32 v205, v2, v3
    v_cvt_pk_bf16_f32 v206, v12, v13
    v_cvt_pk_bf16_f32 v207, v14, v15
    v_cvt_pk_bf16_f32 v208, v24, v25
    v_cvt_pk_bf16_f32 v209, v26, v27
    v_cvt_pk_bf16_f32 v210, v36, v37
    v_cvt_pk_bf16_f32 v211, v38, v39
    v_cvt_pk_bf16_f32 v212, v4, v5
    v_cvt_pk_bf16_f32 v213, v6, v7
    v_cvt_pk_bf16_f32 v214, v16, v17
    v_cvt_pk_bf16_f32 v215, v18, v19
    v_cvt_pk_bf16_f32 v216, v28, v29
    v_cvt_pk_bf16_f32 v217, v30, v31
    v_cvt_pk_bf16_f32 v218, v40, v41
    v_cvt_pk_bf16_f32 v219, v42, v43
    v_cvt_pk_bf16_f32 v220, v8, v9
    v_cvt_pk_bf16_f32 v221, v10, v11
    v_cvt_pk_bf16_f32 v222, v20, v21
    v_cvt_pk_bf16_f32 v223, v22, v23
    v_cvt_pk_bf16_f32 v224, v32, v33
    v_cvt_pk_bf16_f32 v225, v34, v35
    v_cvt_pk_bf16_f32 v226, v44, v45
    v_cvt_pk_bf16_f32 v227, v46, v47
    v_permlane16_swap_b32 v204, v206
    v_permlane16_swap_b32 v205, v207
    v_permlane16_swap_b32 v208, v210
    v_permlane16_swap_b32 v209, v211
    v_permlane16_swap_b32 v212, v214
    v_permlane16_swap_b32 v213, v215
    v_permlane16_swap_b32 v216, v218
    v_permlane16_swap_b32 v217, v219
    v_permlane16_swap_b32 v220, v222
    v_permlane16_swap_b32 v221, v223
    v_permlane16_swap_b32 v224, v226
    v_permlane16_swap_b32 v225, v227
    buffer_store_dwordx4 v[204:207], v200, s[20:23], s46 offen offset:0
    buffer_store_dwordx4 v[208:211], v200, s[20:23], s46 offen offset:64
    s_add_u32 s46, s46, 16384
    buffer_store_dwordx4 v[212:215], v200, s[20:23], s46 offen offset:0
    buffer_store_dwordx4 v[216:219], v200, s[20:23], s46 offen offset:64
    s_add_u32 s46, s46, 16384
    buffer_store_dwordx4 v[220:223], v200, s[20:23], s46 offen offset:0
    buffer_store_dwordx4 v[224:227], v200, s[20:23], s46 offen offset:64
    s_endpgm
A_loader:
    s_sub_u32 s3, s44, 4
    s_lshl_b32 s54, s3, 10
    s_mul_i32 s56, s3, 1056
    s_and_b32 s46, s3, 1
    s_lshl_b32 s46, s46, 2
    v_add_u32 v1, s46, v254
    v_and_b32 v2, 7, v255
    v_xor_b32 v1, v1, v2
    v_lshlrev_b32 v1, 4, v1
    v_lshrrev_b32 v2, 3, v255
    v_lshl_add_u32 v1, v2, 10, v1
    s_lshl_b32 s46, s3, 13
    v_add_u32 v10, s46, v1
    v_lshrrev_b32 v1, 1, v254
    v_and_b32 v2, 1, v254
    v_lshlrev_b32 v1, 17, v1
    v_lshl_add_u32 v1, v2, 15, v1
    v_lshl_add_u32 v1, v253, 4, v1
    v_add_u32 v11, s46, v1
    s_waitcnt lgkmcnt(0)
    s_mul_i32 s46, s45, 196608
    s_add_u32 s20, s4, s46
    s_addc_u32 s21, s5, 0
    s_and_b32 s21, s21, 0xffff
    s_mov_b32 s22, 196608
    s_mov_b32 s23, 0x00020000
    s_lshl_b32 s46, s50, 8
    s_sub_u32 s47, 4194304, s46
    s_add_u32 s24, s10, s46
    s_addc_u32 s25, s11, 0
    s_and_b32 s25, s25, 0xffff
    s_mov_b32 s26, s47
    s_mov_b32 s27, 0x00020000
    s_add_u32 s46, s51, 0
    s_and_b32 s46, s46, 7
    s_lshl_b32 s57, s46, 7
    s_lshl_b32 s48, s46, 19
    s_add_u32 m0, s56, 128000
    s_add_u32 s49, s48, 0
    buffer_load_dwordx4 v11, s[24:27], s49 offen lds
    s_add_u32 m0, s54, 45056
    s_add_u32 s49, s57, 0
    buffer_load_dwordx4 v10, s[20:23], s49 offen lds
    s_add_u32 m0, s54, 49152
    s_add_u32 s49, s57, 32768
    buffer_load_dwordx4 v10, s[20:23], s49 offen lds
    s_add_u32 m0, s56, 132224
    s_add_u32 s49, s48, 65536
    buffer_load_dwordx4 v11, s[24:27], s49 offen lds
    s_add_u32 m0, s54, 53248
    s_add_u32 s49, s57, 65536
    buffer_load_dwordx4 v10, s[20:23], s49 offen lds
    s_add_u32 m0, s56, 136448
    s_add_u32 s49, s48, 262144
    buffer_load_dwordx4 v11, s[24:27], s49 offen lds
    s_add_u32 m0, s54, 57344
    s_add_u32 s49, s57, 98304
    buffer_load_dwordx4 v10, s[20:23], s49 offen lds
    s_add_u32 m0, s54, 61440
    s_add_u32 s49, s57, 131072
    buffer_load_dwordx4 v10, s[20:23], s49 offen lds
    s_add_u32 m0, s56, 140672
    s_add_u32 s49, s48, 327680
    buffer_load_dwordx4 v11, s[24:27], s49 offen lds
    s_add_u32 m0, s54, 65536
    s_add_u32 s49, s57, 163840
    buffer_load_dwordx4 v10, s[20:23], s49 offen lds
    s_lshl_b32 s46, s45, 5
    s_add_u32 s46, s46, s50
    s_lshl_b32 s46, s46, 18
    s_add_u32 s28, s6, s46
    s_addc_u32 s29, s7, 0
    s_and_b32 s29, s29, 0xffff
    s_mov_b32 s30, 262144
    s_mov_b32 s31, 0x00020000
    s_add_u32 s32, s8, s46
    s_addc_u32 s33, s9, 0
    s_and_b32 s33, s33, 0xffff
    s_mov_b32 s34, 262144
    s_mov_b32 s35, 0x00020000
    s_mul_i32 s55, s3, 1088
    v_xor_b32 v1, v253, v254
    v_lshlrev_b32 v1, 4, v1
    v_lshl_add_u32 v1, v254, 8, v1
    s_lshl_b32 s46, s3, 15
    v_add_u32 v12, s46, v1
    v_lshlrev_b32 v1, 4, v253
    v_and_b32 v2, 1, v254
    v_lshl_add_u32 v1, v2, 16, v1
    v_lshrrev_b32 v2, 1, v254
    v_lshl_add_u32 v1, v2, 10, v1
    s_lshl_b32 s46, s3, 8
    v_add_u32 v13, s46, v1
    v_lshlrev_b32 v1, 4, v255
    v_add_u32 v8, s55, v1
    s_add_u32 s46, s56, 94208
    v_add_u32 v9, s46, v1
    s_add_u32 s46, s51, 1
    s_and_b32 s46, s46, 7
    s_lshl_b32 s57, s46, 7
    s_lshl_b32 s48, s46, 19
    s_add_u32 m0, s56, 144896
    s_add_u32 s49, s48, 0
    buffer_load_dwordx4 v11, s[24:27], s49 offen lds
    s_add_u32 m0, s54, 69632
    s_add_u32 s49, s57, 0
    buffer_load_dwordx4 v10, s[20:23], s49 offen lds
    s_waitcnt vmcnt(11)
    s_add_u32 m0, s54, 73728
    s_add_u32 s49, s57, 32768
    buffer_load_dwordx4 v10, s[20:23], s49 offen lds
    s_waitcnt vmcnt(11)
    s_add_u32 m0, s56, 149120
    s_add_u32 s49, s48, 65536
    buffer_load_dwordx4 v11, s[24:27], s49 offen lds
    s_waitcnt vmcnt(11)
    s_add_u32 m0, s54, 77824
    s_add_u32 s49, s57, 65536
    buffer_load_dwordx4 v10, s[20:23], s49 offen lds
    s_waitcnt vmcnt(11)
    s_add_u32 m0, s56, 153344
    s_add_u32 s49, s48, 262144
    buffer_load_dwordx4 v11, s[24:27], s49 offen lds
    s_waitcnt vmcnt(11)
    s_add_u32 m0, s54, 81920
    s_add_u32 s49, s57, 98304
    buffer_load_dwordx4 v10, s[20:23], s49 offen lds
    s_waitcnt vmcnt(11)
    s_add_u32 m0, s54, 86016
    s_add_u32 s49, s57, 131072
    buffer_load_dwordx4 v10, s[20:23], s49 offen lds
    s_waitcnt vmcnt(11)
    s_add_u32 m0, s56, 157568
    s_add_u32 s49, s48, 327680
    buffer_load_dwordx4 v11, s[24:27], s49 offen lds
    s_waitcnt vmcnt(11)
    s_add_u32 m0, s54, 90112
    s_add_u32 s49, s57, 163840
    buffer_load_dwordx4 v10, s[20:23], s49 offen lds
    s_waitcnt vmcnt(10)
    s_barrier
    s_add_u32 s46, s51, 2
    s_and_b32 s46, s46, 7
    s_lshl_b32 s57, s46, 7
    s_lshl_b32 s48, s46, 19
    s_add_u32 m0, s56, 111104
    s_add_u32 s49, s48, 0
    buffer_load_dwordx4 v11, s[24:27], s49 offen lds
    s_add_u32 m0, s54, 17408
    s_add_u32 s49, s57, 0
    buffer_load_dwordx4 v10, s[20:23], s49 offen lds
    s_waitcnt vmcnt(11)
    s_add_u32 m0, s54, 21504
    s_add_u32 s49, s57, 32768
    buffer_load_dwordx4 v10, s[20:23], s49 offen lds
    s_waitcnt vmcnt(11)
    s_add_u32 m0, s56, 115328
    s_add_u32 s49, s48, 65536
    buffer_load_dwordx4 v11, s[24:27], s49 offen lds
    s_waitcnt vmcnt(11)
    s_add_u32 m0, s54, 25600
    s_add_u32 s49, s57, 65536
    buffer_load_dwordx4 v10, s[20:23], s49 offen lds
    s_waitcnt vmcnt(11)
    s_add_u32 m0, s56, 119552
    s_add_u32 s49, s48, 262144
    buffer_load_dwordx4 v11, s[24:27], s49 offen lds
    s_waitcnt vmcnt(11)
    s_add_u32 m0, s54, 29696
    s_add_u32 s49, s57, 98304
    buffer_load_dwordx4 v10, s[20:23], s49 offen lds
    s_waitcnt vmcnt(11)
    s_add_u32 m0, s54, 33792
    s_add_u32 s49, s57, 131072
    buffer_load_dwordx4 v10, s[20:23], s49 offen lds
    s_waitcnt vmcnt(11)
    s_add_u32 m0, s56, 123776
    s_add_u32 s49, s48, 327680
    buffer_load_dwordx4 v11, s[24:27], s49 offen lds
    s_waitcnt vmcnt(11)
    s_add_u32 m0, s54, 37888
    s_add_u32 s49, s57, 163840
    buffer_load_dwordx4 v10, s[20:23], s49 offen lds
    s_waitcnt vmcnt(11)
    s_lshr_b32 s53, s52, 4
    s_mul_i32 s53, s53, 0
    s_add_u32 s53, s53, s52
    s_and_b32 s53, s53, 15
    s_lshr_b32 s49, s53, 3
    s_lshl_b32 s49, s49, 17
    s_and_b32 s53, s53, 7
    s_lshl_b32 s53, s53, 11
    s_add_u32 s53, s53, s49
    s_add_u32 m0, s55, 0
    s_add_u32 s49, s53, 0
    buffer_load_dwordx4 v12, s[28:31], s49 offen nt lds
    s_waitcnt vmcnt(11)
    s_barrier
    s_add_u32 m0, s55, 4352
    s_add_u32 s49, s53, 1024
    buffer_load_dwordx4 v12, s[28:31], s49 offen nt lds
    s_waitcnt vmcnt(11)
    s_add_u32 m0, s55, 8704
    s_add_u32 s49, s53, 16384
    buffer_load_dwordx4 v12, s[28:31], s49 offen nt lds
    s_waitcnt vmcnt(11)
    s_add_u32 m0, s55, 13056
    s_add_u32 s49, s53, 17408
    buffer_load_dwordx4 v12, s[28:31], s49 offen nt lds
    s_waitcnt vmcnt(11)
    s_lshr_b32 s53, s52, 4
    s_mul_i32 s53, s53, 1
    s_add_u32 s53, s53, s52
    s_and_b32 s53, s53, 15
    s_lshr_b32 s49, s53, 3
    s_lshl_b32 s49, s49, 17
    s_and_b32 s53, s53, 7
    s_lshl_b32 s53, s53, 11
    s_add_u32 s53, s53, s49
    s_add_u32 s49, s53, 0
    buffer_load_dwordx4 v[16:19], v12, s[28:31], s49 offen nt
    s_waitcnt vmcnt(11)
    s_add_u32 s46, s51, 3
    s_and_b32 s46, s46, 7
    s_lshl_b32 s57, s46, 7
    s_lshl_b32 s48, s46, 19
    s_add_u32 m0, s56, 128000
    s_add_u32 s49, s48, 0
    buffer_load_dwordx4 v11, s[24:27], s49 offen lds
    s_waitcnt vmcnt(11)
    s_add_u32 m0, s54, 45056
    s_add_u32 s49, s57, 0
    buffer_load_dwordx4 v10, s[20:23], s49 offen lds
    s_waitcnt vmcnt(11)
    s_add_u32 m0, s54, 49152
    s_add_u32 s49, s57, 32768
    buffer_load_dwordx4 v10, s[20:23], s49 offen lds
    s_waitcnt vmcnt(11)
    s_add_u32 m0, s56, 132224
    s_add_u32 s49, s48, 65536
    buffer_load_dwordx4 v11, s[24:27], s49 offen lds
    s_waitcnt vmcnt(11)
    s_add_u32 m0, s54, 53248
    s_add_u32 s49, s57, 65536
    buffer_load_dwordx4 v10, s[20:23], s49 offen lds
    s_waitcnt vmcnt(11)
    s_add_u32 m0, s56, 136448
    s_add_u32 s49, s48, 262144
    buffer_load_dwordx4 v11, s[24:27], s49 offen lds
    s_waitcnt vmcnt(11)
    s_add_u32 m0, s54, 57344
    s_add_u32 s49, s57, 98304
    buffer_load_dwordx4 v10, s[20:23], s49 offen lds
    s_waitcnt vmcnt(11)
    s_add_u32 m0, s54, 61440
    s_add_u32 s49, s57, 131072
    buffer_load_dwordx4 v10, s[20:23], s49 offen lds
    s_waitcnt vmcnt(11)
    s_add_u32 m0, s56, 140672
    s_add_u32 s49, s48, 327680
    buffer_load_dwordx4 v11, s[24:27], s49 offen lds
    s_waitcnt vmcnt(11)
    s_add_u32 m0, s54, 65536
    s_add_u32 s49, s57, 163840
    buffer_load_dwordx4 v10, s[20:23], s49 offen lds
    s_waitcnt vmcnt(11)
    s_add_u32 s49, s53, 1024
    buffer_load_dwordx4 v[20:23], v12, s[28:31], s49 offen nt
    s_waitcnt vmcnt(11)
    s_add_u32 s49, s53, 16384
    buffer_load_dwordx4 v[24:27], v12, s[28:31], s49 offen nt
    s_waitcnt vmcnt(11)
    s_add_u32 s49, s53, 17408
    buffer_load_dwordx4 v[28:31], v12, s[28:31], s49 offen nt
    s_waitcnt vmcnt(11)
    s_lshr_b32 s53, s52, 4
    s_mul_i32 s53, s53, 0
    s_add_u32 s53, s53, s52
    s_and_b32 s53, s53, 15
    s_lshr_b32 s49, s53, 3
    s_lshl_b32 s49, s49, 17
    s_and_b32 s53, s53, 7
    s_lshl_b32 s53, s53, 11
    s_add_u32 s53, s53, s49
    s_add_u32 m0, s56, 94208
    s_add_u32 s49, s53, 0
    buffer_load_dwordx4 v13, s[32:35], s49 offen nt lds
    s_waitcnt vmcnt(11)
    s_add_u32 m0, s56, 98432
    s_add_u32 s49, s53, 32768
    buffer_load_dwordx4 v13, s[32:35], s49 offen nt lds
    s_barrier
    s_waitcnt vmcnt(11)
    s_add_u32 s46, s51, 4
    s_and_b32 s46, s46, 7
    s_lshl_b32 s57, s46, 7
    s_lshl_b32 s48, s46, 19
    s_add_u32 m0, s56, 144896
    s_add_u32 s49, s48, 0
    buffer_load_dwordx4 v11, s[24:27], s49 offen lds
    s_waitcnt vmcnt(11)
    s_add_u32 m0, s54, 69632
    s_add_u32 s49, s57, 0
    buffer_load_dwordx4 v10, s[20:23], s49 offen lds
    s_waitcnt vmcnt(11)
    s_add_u32 m0, s54, 73728
    s_add_u32 s49, s57, 32768
    buffer_load_dwordx4 v10, s[20:23], s49 offen lds
    s_waitcnt vmcnt(11)
    s_add_u32 m0, s56, 149120
    s_add_u32 s49, s48, 65536
    buffer_load_dwordx4 v11, s[24:27], s49 offen lds
    s_waitcnt vmcnt(11)
    s_add_u32 m0, s54, 77824
    s_add_u32 s49, s57, 65536
    buffer_load_dwordx4 v10, s[20:23], s49 offen lds
    s_waitcnt vmcnt(11)
    s_add_u32 m0, s56, 153344
    s_add_u32 s49, s48, 262144
    buffer_load_dwordx4 v11, s[24:27], s49 offen lds
    s_waitcnt vmcnt(11)
    s_add_u32 m0, s54, 81920
    s_add_u32 s49, s57, 98304
    buffer_load_dwordx4 v10, s[20:23], s49 offen lds
    s_waitcnt vmcnt(11)
    s_add_u32 m0, s54, 86016
    s_add_u32 s49, s57, 131072
    buffer_load_dwordx4 v10, s[20:23], s49 offen lds
    s_waitcnt vmcnt(11)
    s_add_u32 m0, s56, 157568
    s_add_u32 s49, s48, 327680
    buffer_load_dwordx4 v11, s[24:27], s49 offen lds
    s_waitcnt vmcnt(11)
    s_add_u32 m0, s54, 90112
    s_add_u32 s49, s57, 163840
    buffer_load_dwordx4 v10, s[20:23], s49 offen lds
    s_waitcnt vmcnt(11)
    s_add_u32 m0, s56, 102656
    s_add_u32 s49, s53, 16384
    buffer_load_dwordx4 v13, s[32:35], s49 offen nt lds
    s_waitcnt vmcnt(11)
    s_add_u32 m0, s56, 106880
    s_add_u32 s49, s53, 49152
    buffer_load_dwordx4 v13, s[32:35], s49 offen nt lds
    s_waitcnt vmcnt(11)
    s_lshr_b32 s53, s52, 4
    s_mul_i32 s53, s53, 2
    s_add_u32 s53, s53, s52
    s_and_b32 s53, s53, 15
    s_lshr_b32 s49, s53, 3
    s_lshl_b32 s49, s49, 17
    s_and_b32 s53, s53, 7
    s_lshl_b32 s53, s53, 11
    s_add_u32 s53, s53, s49
    s_add_u32 s49, s53, 0
    buffer_load_dwordx4 v[32:35], v12, s[28:31], s49 offen nt
    s_waitcnt vmcnt(11)
    s_add_u32 s49, s53, 1024
    buffer_load_dwordx4 v[36:39], v12, s[28:31], s49 offen nt
    s_waitcnt vmcnt(11)
    s_add_u32 s49, s53, 16384
    buffer_load_dwordx4 v[40:43], v12, s[28:31], s49 offen nt
    s_barrier
    s_waitcnt vmcnt(11)
    s_add_u32 s46, s51, 5
    s_and_b32 s46, s46, 7
    s_lshl_b32 s57, s46, 7
    s_lshl_b32 s48, s46, 19
    s_add_u32 m0, s56, 111104
    s_add_u32 s49, s48, 0
    buffer_load_dwordx4 v11, s[24:27], s49 offen lds
    s_waitcnt vmcnt(11)
    s_add_u32 m0, s54, 17408
    s_add_u32 s49, s57, 0
    buffer_load_dwordx4 v10, s[20:23], s49 offen lds
    s_waitcnt vmcnt(11)
    s_add_u32 m0, s54, 21504
    s_add_u32 s49, s57, 32768
    buffer_load_dwordx4 v10, s[20:23], s49 offen lds
    s_waitcnt vmcnt(11)
    s_add_u32 m0, s56, 115328
    s_add_u32 s49, s48, 65536
    buffer_load_dwordx4 v11, s[24:27], s49 offen lds
    s_waitcnt vmcnt(11)
    s_add_u32 m0, s54, 25600
    s_add_u32 s49, s57, 65536
    buffer_load_dwordx4 v10, s[20:23], s49 offen lds
    s_waitcnt vmcnt(11)
    s_add_u32 m0, s56, 119552
    s_add_u32 s49, s48, 262144
    buffer_load_dwordx4 v11, s[24:27], s49 offen lds
    s_waitcnt vmcnt(11)
    s_add_u32 m0, s54, 29696
    s_add_u32 s49, s57, 98304
    buffer_load_dwordx4 v10, s[20:23], s49 offen lds
    s_waitcnt vmcnt(11)
    s_add_u32 m0, s54, 33792
    s_add_u32 s49, s57, 131072
    buffer_load_dwordx4 v10, s[20:23], s49 offen lds
    s_waitcnt vmcnt(11)
    s_add_u32 m0, s56, 123776
    s_add_u32 s49, s48, 327680
    buffer_load_dwordx4 v11, s[24:27], s49 offen lds
    s_waitcnt vmcnt(11)
    s_add_u32 m0, s54, 37888
    s_add_u32 s49, s57, 163840
    buffer_load_dwordx4 v10, s[20:23], s49 offen lds
    s_waitcnt vmcnt(11)
    s_add_u32 s49, s53, 17408
    buffer_load_dwordx4 v[44:47], v12, s[28:31], s49 offen nt
    s_waitcnt vmcnt(11)
    s_lshr_b32 s53, s52, 4
    s_mul_i32 s53, s53, 1
    s_add_u32 s53, s53, s52
    s_and_b32 s53, s53, 15
    s_lshr_b32 s49, s53, 3
    s_lshl_b32 s49, s49, 17
    s_and_b32 s53, s53, 7
    s_lshl_b32 s53, s53, 11
    s_add_u32 s53, s53, s49
    s_add_u32 s49, s53, 0
    buffer_load_dwordx4 v[48:51], v13, s[32:35], s49 offen nt
    s_waitcnt vmcnt(11)
    s_add_u32 s49, s53, 32768
    buffer_load_dwordx4 v[52:55], v13, s[32:35], s49 offen nt
    s_waitcnt vmcnt(11)
    s_add_u32 s49, s53, 16384
    buffer_load_dwordx4 v[56:59], v13, s[32:35], s49 offen nt
    s_waitcnt vmcnt(11)
    s_add_u32 s49, s53, 49152
    buffer_load_dwordx4 v[60:63], v13, s[32:35], s49 offen nt
    s_barrier
    s_waitcnt vmcnt(11)
    s_add_u32 s46, s51, 6
    s_and_b32 s46, s46, 7
    s_lshl_b32 s57, s46, 7
    s_lshl_b32 s48, s46, 19
    s_add_u32 m0, s56, 128000
    s_add_u32 s49, s48, 0
    buffer_load_dwordx4 v11, s[24:27], s49 offen lds
    s_waitcnt vmcnt(11)
    s_add_u32 m0, s54, 45056
    s_add_u32 s49, s57, 0
    buffer_load_dwordx4 v10, s[20:23], s49 offen lds
    s_waitcnt vmcnt(11)
    s_add_u32 m0, s54, 49152
    s_add_u32 s49, s57, 32768
    buffer_load_dwordx4 v10, s[20:23], s49 offen lds
    s_waitcnt vmcnt(11)
    s_add_u32 m0, s56, 132224
    s_add_u32 s49, s48, 65536
    buffer_load_dwordx4 v11, s[24:27], s49 offen lds
    s_waitcnt vmcnt(11)
    s_add_u32 m0, s54, 53248
    s_add_u32 s49, s57, 65536
    buffer_load_dwordx4 v10, s[20:23], s49 offen lds
    s_waitcnt vmcnt(11)
    s_add_u32 m0, s56, 136448
    s_add_u32 s49, s48, 262144
    buffer_load_dwordx4 v11, s[24:27], s49 offen lds
    s_waitcnt vmcnt(11)
    s_add_u32 m0, s54, 57344
    s_add_u32 s49, s57, 98304
    buffer_load_dwordx4 v10, s[20:23], s49 offen lds
    s_waitcnt vmcnt(11)
    s_add_u32 m0, s54, 61440
    s_add_u32 s49, s57, 131072
    buffer_load_dwordx4 v10, s[20:23], s49 offen lds
    s_waitcnt vmcnt(11)
    s_add_u32 m0, s56, 140672
    s_add_u32 s49, s48, 327680
    buffer_load_dwordx4 v11, s[24:27], s49 offen lds
    s_waitcnt vmcnt(11)
    s_add_u32 m0, s54, 65536
    s_add_u32 s49, s57, 163840
    buffer_load_dwordx4 v10, s[20:23], s49 offen lds
    s_waitcnt vmcnt(11)
    s_lshr_b32 s53, s52, 4
    s_mul_i32 s53, s53, 3
    s_add_u32 s53, s53, s52
    s_and_b32 s53, s53, 15
    s_lshr_b32 s49, s53, 3
    s_lshl_b32 s49, s49, 17
    s_and_b32 s53, s53, 7
    s_lshl_b32 s53, s53, 11
    s_add_u32 s53, s53, s49
    s_add_u32 s49, s53, 0
    buffer_load_dwordx4 v[64:67], v12, s[28:31], s49 offen nt
    s_waitcnt vmcnt(11)
    s_add_u32 s49, s53, 1024
    buffer_load_dwordx4 v[68:71], v12, s[28:31], s49 offen nt
    s_waitcnt vmcnt(11)
    s_add_u32 s49, s53, 16384
    buffer_load_dwordx4 v[72:75], v12, s[28:31], s49 offen nt
    s_waitcnt vmcnt(11)
    s_add_u32 s49, s53, 17408
    buffer_load_dwordx4 v[76:79], v12, s[28:31], s49 offen nt
    s_waitcnt vmcnt(11)
    s_lshr_b32 s53, s52, 4
    s_mul_i32 s53, s53, 2
    s_add_u32 s53, s53, s52
    s_and_b32 s53, s53, 15
    s_lshr_b32 s49, s53, 3
    s_lshl_b32 s49, s49, 17
    s_and_b32 s53, s53, 7
    s_lshl_b32 s53, s53, 11
    s_add_u32 s53, s53, s49
    s_add_u32 s49, s53, 0
    buffer_load_dwordx4 v[80:83], v13, s[32:35], s49 offen nt
    s_barrier
    s_waitcnt vmcnt(11)
    s_add_u32 s46, s51, 7
    s_and_b32 s46, s46, 7
    s_lshl_b32 s57, s46, 7
    s_lshl_b32 s48, s46, 19
    s_add_u32 m0, s56, 144896
    s_add_u32 s49, s48, 0
    buffer_load_dwordx4 v11, s[24:27], s49 offen lds
    s_waitcnt vmcnt(11)
    s_add_u32 m0, s54, 69632
    s_add_u32 s49, s57, 0
    buffer_load_dwordx4 v10, s[20:23], s49 offen lds
    s_waitcnt vmcnt(11)
    s_add_u32 m0, s54, 73728
    s_add_u32 s49, s57, 32768
    buffer_load_dwordx4 v10, s[20:23], s49 offen lds
    s_waitcnt vmcnt(11)
    s_add_u32 m0, s56, 149120
    s_add_u32 s49, s48, 65536
    buffer_load_dwordx4 v11, s[24:27], s49 offen lds
    s_waitcnt vmcnt(11)
    s_add_u32 m0, s54, 77824
    s_add_u32 s49, s57, 65536
    buffer_load_dwordx4 v10, s[20:23], s49 offen lds
    s_waitcnt vmcnt(11)
    s_add_u32 m0, s56, 153344
    s_add_u32 s49, s48, 262144
    buffer_load_dwordx4 v11, s[24:27], s49 offen lds
    s_waitcnt vmcnt(11)
    s_add_u32 m0, s54, 81920
    s_add_u32 s49, s57, 98304
    buffer_load_dwordx4 v10, s[20:23], s49 offen lds
    s_waitcnt vmcnt(11)
    s_add_u32 m0, s54, 86016
    s_add_u32 s49, s57, 131072
    buffer_load_dwordx4 v10, s[20:23], s49 offen lds
    s_waitcnt vmcnt(11)
    s_add_u32 m0, s56, 157568
    s_add_u32 s49, s48, 327680
    buffer_load_dwordx4 v11, s[24:27], s49 offen lds
    s_waitcnt vmcnt(11)
    s_add_u32 m0, s54, 90112
    s_add_u32 s49, s57, 163840
    buffer_load_dwordx4 v10, s[20:23], s49 offen lds
    s_waitcnt vmcnt(11)
    s_barrier
    s_add_u32 s49, s53, 32768
    buffer_load_dwordx4 v[84:87], v13, s[32:35], s49 offen nt
    s_waitcnt vmcnt(11)
    s_add_u32 s49, s53, 16384
    buffer_load_dwordx4 v[88:91], v13, s[32:35], s49 offen nt
    s_waitcnt vmcnt(11)
    s_add_u32 s49, s53, 49152
    buffer_load_dwordx4 v[92:95], v13, s[32:35], s49 offen nt
    s_waitcnt vmcnt(11)
    s_lshr_b32 s53, s52, 4
    s_mul_i32 s53, s53, 4
    s_add_u32 s53, s53, s52
    s_and_b32 s53, s53, 15
    s_lshr_b32 s49, s53, 3
    s_lshl_b32 s49, s49, 17
    s_and_b32 s53, s53, 7
    s_lshl_b32 s53, s53, 11
    s_add_u32 s53, s53, s49
    s_add_u32 s49, s53, 0
    buffer_load_dwordx4 v[96:99], v12, s[28:31], s49 offen nt
    s_waitcnt vmcnt(11)
    s_add_u32 s49, s53, 1024
    buffer_load_dwordx4 v[100:103], v12, s[28:31], s49 offen nt
    s_waitcnt vmcnt(11)
    s_add_u32 s49, s53, 16384
    buffer_load_dwordx4 v[104:107], v12, s[28:31], s49 offen nt
    s_waitcnt vmcnt(6)
    s_barrier
    s_add_u32 s49, s53, 17408
    buffer_load_dwordx4 v[108:111], v12, s[28:31], s49 offen nt
    s_lshr_b32 s53, s52, 4
    s_mul_i32 s53, s53, 3
    s_add_u32 s53, s53, s52
    s_and_b32 s53, s53, 15
    s_lshr_b32 s49, s53, 3
    s_lshl_b32 s49, s49, 17
    s_and_b32 s53, s53, 7
    s_lshl_b32 s53, s53, 11
    s_add_u32 s53, s53, s49
    s_add_u32 s49, s53, 0
    buffer_load_dwordx4 v[112:115], v13, s[32:35], s49 offen nt
    s_add_u32 s49, s53, 32768
    buffer_load_dwordx4 v[116:119], v13, s[32:35], s49 offen nt
    s_add_u32 s49, s53, 16384
    buffer_load_dwordx4 v[120:123], v13, s[32:35], s49 offen nt
    s_add_u32 s49, s53, 49152
    buffer_load_dwordx4 v[124:127], v13, s[32:35], s49 offen nt
    s_barrier
    s_mov_b32 s36, s18
    s_and_b32 s37, s19, 0xffff
    s_mov_b32 s38, 37748736
    s_mov_b32 s39, 0x00020000
    s_mov_b32 s20, s55
    s_mov_b32 s21, s56
    s_mov_b32 s24, s54
    s_mov_b32 s40, s12
    s_and_b32 s41, s13, 0xffff
    s_mov_b32 s42, 4194304
    s_mov_b32 s43, 0x00020000
    s_and_b32 s51, s50, 7
    s_lshr_b32 s54, s50, 3
    s_and_b32 s55, s44, 3
    s_mul_i32 s46, s45, 12
    s_mul_i32 s47, s55, 3
    s_add_u32 s46, s46, s47
    s_add_u32 s46, s46, 2
    s_lshl_b32 s46, s46, 17
    s_lshl_b32 s47, s54, 15
    s_add_u32 s56, s46, s47
    s_lshl_b32 s46, s45, 3
    s_add_u32 s46, s46, s51
    s_lshl_b32 s46, s46, 5
    s_lshl_b32 s47, s55, 3
    s_add_u32 s46, s46, s47
    s_add_u32 s57, s46, 4
    v_lshlrev_b32 v244, 4, v255
    v_lshrrev_b32 v240, 2, v255
    v_lshlrev_b32 v240, 7, v240
    v_and_b32 v241, 3, v255
    v_lshl_add_u32 v240, v241, 3, v240
    v_bfe_u32 v242, v255, 3, 2
    v_xor_b32 v241, 0, v242
    v_lshl_add_u32 v236, v241, 5, v240
    v_add_u32 v232, 69632, v236
    v_xor_b32 v241, 1, v242
    v_lshl_add_u32 v237, v241, 5, v240
    v_add_u32 v233, 69632, v237
    v_xor_b32 v241, 2, v242
    v_lshl_add_u32 v238, v241, 5, v240
    v_add_u32 v234, 69632, v238
    v_xor_b32 v241, 3, v242
    v_lshl_add_u32 v239, v241, 5, v240
    v_add_u32 v235, 69632, v239
    v_add_u32 v250, s51, v255
    v_and_b32 v250, 7, v250
    v_lshlrev_b32 v250, 2, v250
    s_lshl_b32 s46, s45, 2
    s_add_u32 s46, s46, s55
    s_lshl_b32 s46, s46, 9
    s_lshl_b32 s47, s54, 7
    s_add_u32 s46, s46, s47
    s_add_u32 s23, s46, 16777216
    v_lshlrev_b32 v1, 1, v254
    v_and_b32 v2, 7, v255
    v_xor_b32 v1, v1, v2
    v_lshlrev_b32 v1, 4, v1
    v_lshrrev_b32 v2, 3, v255
    v_lshl_add_u32 v245, v2, 10, v1
    s_lshl_b32 s22, s54, 20
    s_lshl_b32 s46, s55, 13
    s_add_u32 s22, s22, s46
    s_lshl_b32 s46, s51, 7
    s_add_u32 s22, s22, s46
    v_add_u32 v14, s24, v244
    v_add_u32 v15, 69632, v14
    v_and_b32 v1, 3, v255
    v_lshlrev_b32 v1, 6, v1
    s_lshr_b32 s53, s52, 4
    s_mul_i32 s53, s53, 5
    s_add_u32 s53, s53, s52
    s_and_b32 s53, s53, 15
    s_lshr_b32 s49, s53, 3
    s_lshl_b32 s49, s49, 17
    s_and_b32 s53, s53, 7
    s_lshl_b32 s53, s53, 11
    s_add_u32 s53, s53, s49
    s_add_u32 s49, s53, 0
    buffer_load_dwordx4 v[128:131], v12, s[28:31], s49 offen nt
    s_add_u32 s49, s53, 1024
    buffer_load_dwordx4 v[132:135], v12, s[28:31], s49 offen nt
    s_add_u32 s49, s53, 16384
    buffer_load_dwordx4 v[136:139], v12, s[28:31], s49 offen nt
    s_add_u32 s49, s53, 17408
    buffer_load_dwordx4 v[140:143], v12, s[28:31], s49 offen nt
    ds_write_b128 v8, v[16:19] offset:17408
    ds_write_b128 v8, v[20:23] offset:21760
    ds_write_b128 v8, v[24:27] offset:26112
    ds_write_b128 v8, v[28:31] offset:30464
    ds_write_b128 v9, v[48:51] offset:16896
    ds_write_b128 v9, v[52:55] offset:21120
    ds_write_b128 v9, v[56:59] offset:25344
    ds_write_b128 v9, v[60:63] offset:29568
    s_waitcnt lgkmcnt(0)
    s_lshr_b32 s53, s52, 4
    s_mul_i32 s53, s53, 4
    s_add_u32 s53, s53, s52
    s_and_b32 s53, s53, 15
    s_lshr_b32 s49, s53, 3
    s_lshl_b32 s49, s49, 17
    s_and_b32 s53, s53, 7
    s_lshl_b32 s53, s53, 11
    s_add_u32 s53, s53, s49
    s_add_u32 s49, s53, 0
    buffer_load_dwordx4 v[16:19], v13, s[32:35], s49 offen nt
    s_add_u32 s49, s53, 32768
    buffer_load_dwordx4 v[20:23], v13, s[32:35], s49 offen nt
    s_add_u32 s49, s53, 16384
    buffer_load_dwordx4 v[24:27], v13, s[32:35], s49 offen nt
    s_add_u32 s49, s53, 49152
    buffer_load_dwordx4 v[28:31], v13, s[32:35], s49 offen nt
    s_barrier
    s_lshr_b32 s53, s52, 4
    s_mul_i32 s53, s53, 6
    s_add_u32 s53, s53, s52
    s_and_b32 s53, s53, 15
    s_lshr_b32 s49, s53, 3
    s_lshl_b32 s49, s49, 17
    s_and_b32 s53, s53, 7
    s_lshl_b32 s53, s53, 11
    s_add_u32 s53, s53, s49
    s_add_u32 s49, s53, 0
    buffer_load_dwordx4 v[48:51], v12, s[28:31], s49 offen nt
    s_add_u32 s49, s53, 1024
    buffer_load_dwordx4 v[52:55], v12, s[28:31], s49 offen nt
    s_add_u32 s49, s53, 16384
    buffer_load_dwordx4 v[56:59], v12, s[28:31], s49 offen nt
    s_add_u32 s49, s53, 17408
    buffer_load_dwordx4 v[60:63], v12, s[28:31], s49 offen nt
    s_waitcnt vmcnt(20)
    ds_write_b128 v8, v[32:35] offset:34816
    ds_write_b128 v8, v[36:39] offset:39168
    ds_write_b128 v8, v[40:43] offset:43520
    ds_write_b128 v8, v[44:47] offset:47872
    ds_write_b128 v9, v[80:83] offset:33792
    ds_write_b128 v9, v[84:87] offset:38016
    ds_write_b128 v9, v[88:91] offset:42240
    ds_write_b128 v9, v[92:95] offset:46464
    s_waitcnt lgkmcnt(0)
    s_lshr_b32 s53, s52, 4
    s_mul_i32 s53, s53, 5
    s_add_u32 s53, s53, s52
    s_and_b32 s53, s53, 15
    s_lshr_b32 s49, s53, 3
    s_lshl_b32 s49, s49, 17
    s_and_b32 s53, s53, 7
    s_lshl_b32 s53, s53, 11
    s_add_u32 s53, s53, s49
    s_add_u32 s49, s53, 0
    buffer_load_dwordx4 v[32:35], v13, s[32:35], s49 offen nt
    s_add_u32 s49, s53, 32768
    buffer_load_dwordx4 v[36:39], v13, s[32:35], s49 offen nt
    s_add_u32 s49, s53, 16384
    buffer_load_dwordx4 v[40:43], v13, s[32:35], s49 offen nt
    s_barrier
    s_add_u32 s49, s53, 49152
    buffer_load_dwordx4 v[44:47], v13, s[32:35], s49 offen nt
    s_lshr_b32 s53, s52, 4
    s_mul_i32 s53, s53, 7
    s_add_u32 s53, s53, s52
    s_and_b32 s53, s53, 15
    s_lshr_b32 s49, s53, 3
    s_lshl_b32 s49, s49, 17
    s_and_b32 s53, s53, 7
    s_lshl_b32 s53, s53, 11
    s_add_u32 s53, s53, s49
    s_add_u32 s49, s53, 0
    buffer_load_dwordx4 v[80:83], v12, s[28:31], s49 offen nt
    s_add_u32 s49, s53, 1024
    buffer_load_dwordx4 v[84:87], v12, s[28:31], s49 offen nt
    s_add_u32 s49, s53, 16384
    buffer_load_dwordx4 v[88:91], v12, s[28:31], s49 offen nt
    s_waitcnt vmcnt(19)
    ds_write_b128 v8, v[64:67] offset:52224
    ds_write_b128 v8, v[68:71] offset:56576
    ds_write_b128 v8, v[72:75] offset:60928
    ds_write_b128 v8, v[76:79] offset:65280
    ds_write_b128 v9, v[112:115] offset:50688
    ds_write_b128 v9, v[116:119] offset:54912
    ds_write_b128 v9, v[120:123] offset:59136
    ds_write_b128 v9, v[124:127] offset:63360
    s_waitcnt lgkmcnt(0)
    s_add_u32 s49, s53, 17408
    buffer_load_dwordx4 v[64:67], v12, s[28:31], s49 offen nt
    s_lshr_b32 s53, s52, 4
    s_mul_i32 s53, s53, 6
    s_add_u32 s53, s53, s52
    s_and_b32 s53, s53, 15
    s_lshr_b32 s49, s53, 3
    s_lshl_b32 s49, s49, 17
    s_and_b32 s53, s53, 7
    s_lshl_b32 s53, s53, 11
    s_add_u32 s53, s53, s49
    s_add_u32 s49, s53, 0
    buffer_load_dwordx4 v[68:71], v13, s[32:35], s49 offen nt
    s_add_u32 s49, s53, 32768
    buffer_load_dwordx4 v[72:75], v13, s[32:35], s49 offen nt
    s_barrier
    s_add_u32 s49, s53, 16384
    buffer_load_dwordx4 v[76:79], v13, s[32:35], s49 offen nt
    s_add_u32 s49, s53, 49152
    buffer_load_dwordx4 v[92:95], v13, s[32:35], s49 offen nt
    s_lshr_b32 s53, s52, 4
    s_mul_i32 s53, s53, 8
    s_add_u32 s53, s53, s52
    s_and_b32 s53, s53, 15
    s_lshr_b32 s49, s53, 3
    s_lshl_b32 s49, s49, 17
    s_and_b32 s53, s53, 7
    s_lshl_b32 s53, s53, 11
    s_add_u32 s53, s53, s49
    s_add_u32 s49, s53, 0
    buffer_load_dwordx4 v[112:115], v12, s[28:31], s49 offen nt
    s_add_u32 s49, s53, 1024
    buffer_load_dwordx4 v[116:119], v12, s[28:31], s49 offen nt
    s_waitcnt vmcnt(18)
    ds_write_b128 v8, v[96:99] offset:0
    ds_write_b128 v8, v[100:103] offset:4352
    ds_write_b128 v8, v[104:107] offset:8704
    ds_write_b128 v8, v[108:111] offset:13056
    ds_write_b128 v9, v[16:19] offset:0
    ds_write_b128 v9, v[20:23] offset:4224
    ds_write_b128 v9, v[24:27] offset:8448
    ds_write_b128 v9, v[28:31] offset:12672
    s_waitcnt lgkmcnt(0)
    s_add_u32 s49, s53, 16384
    buffer_load_dwordx4 v[16:19], v12, s[28:31], s49 offen nt
    s_add_u32 s49, s53, 17408
    buffer_load_dwordx4 v[20:23], v12, s[28:31], s49 offen nt
    s_lshr_b32 s53, s52, 4
    s_mul_i32 s53, s53, 7
    s_add_u32 s53, s53, s52
    s_and_b32 s53, s53, 15
    s_lshr_b32 s49, s53, 3
    s_lshl_b32 s49, s49, 17
    s_and_b32 s53, s53, 7
    s_lshl_b32 s53, s53, 11
    s_add_u32 s53, s53, s49
    s_add_u32 s49, s53, 0
    buffer_load_dwordx4 v[24:27], v13, s[32:35], s49 offen nt
    s_barrier
    s_add_u32 s49, s53, 32768
    buffer_load_dwordx4 v[28:31], v13, s[32:35], s49 offen nt
    s_add_u32 s49, s53, 16384
    buffer_load_dwordx4 v[96:99], v13, s[32:35], s49 offen nt
    s_add_u32 s49, s53, 49152
    buffer_load_dwordx4 v[100:103], v13, s[32:35], s49 offen nt
    s_lshr_b32 s53, s52, 4
    s_mul_i32 s53, s53, 9
    s_add_u32 s53, s53, s52
    s_and_b32 s53, s53, 15
    s_lshr_b32 s49, s53, 3
    s_lshl_b32 s49, s49, 17
    s_and_b32 s53, s53, 7
    s_lshl_b32 s53, s53, 11
    s_add_u32 s53, s53, s49
    s_add_u32 s49, s53, 0
    buffer_load_dwordx4 v[104:107], v12, s[28:31], s49 offen nt
    s_waitcnt vmcnt(17)
    ds_write_b128 v8, v[128:131] offset:17408
    ds_write_b128 v8, v[132:135] offset:21760
    ds_write_b128 v8, v[136:139] offset:26112
    ds_write_b128 v8, v[140:143] offset:30464
    ds_write_b128 v9, v[32:35] offset:16896
    ds_write_b128 v9, v[36:39] offset:21120
    ds_write_b128 v9, v[40:43] offset:25344
    ds_write_b128 v9, v[44:47] offset:29568
    s_waitcnt lgkmcnt(0)
    s_add_u32 s49, s53, 1024
    buffer_load_dwordx4 v[32:35], v12, s[28:31], s49 offen nt
    s_add_u32 s49, s53, 16384
    buffer_load_dwordx4 v[36:39], v12, s[28:31], s49 offen nt
    s_add_u32 s49, s53, 17408
    buffer_load_dwordx4 v[40:43], v12, s[28:31], s49 offen nt
    s_barrier
    s_lshr_b32 s53, s52, 4
    s_mul_i32 s53, s53, 8
    s_add_u32 s53, s53, s52
    s_and_b32 s53, s53, 15
    s_lshr_b32 s49, s53, 3
    s_lshl_b32 s49, s49, 17
    s_and_b32 s53, s53, 7
    s_lshl_b32 s53, s53, 11
    s_add_u32 s53, s53, s49
    s_add_u32 s49, s53, 0
    buffer_load_dwordx4 v[44:47], v13, s[32:35], s49 offen nt
    s_add_u32 s49, s53, 32768
    buffer_load_dwordx4 v[108:111], v13, s[32:35], s49 offen nt
    s_add_u32 s49, s53, 16384
    buffer_load_dwordx4 v[120:123], v13, s[32:35], s49 offen nt
    s_add_u32 s49, s53, 49152
    buffer_load_dwordx4 v[124:127], v13, s[32:35], s49 offen nt
    s_waitcnt vmcnt(16)
    ds_write_b128 v8, v[48:51] offset:34816
    ds_write_b128 v8, v[52:55] offset:39168
    ds_write_b128 v8, v[56:59] offset:43520
    ds_write_b128 v8, v[60:63] offset:47872
    ds_write_b128 v9, v[68:71] offset:33792
    ds_write_b128 v9, v[72:75] offset:38016
    ds_write_b128 v9, v[76:79] offset:42240
    ds_write_b128 v9, v[92:95] offset:46464
    s_waitcnt lgkmcnt(0)
    s_lshr_b32 s53, s52, 4
    s_mul_i32 s53, s53, 10
    s_add_u32 s53, s53, s52
    s_and_b32 s53, s53, 15
    s_lshr_b32 s49, s53, 3
    s_lshl_b32 s49, s49, 17
    s_and_b32 s53, s53, 7
    s_lshl_b32 s53, s53, 11
    s_add_u32 s53, s53, s49
    s_add_u32 s49, s53, 0
    buffer_load_dwordx4 v[48:51], v12, s[28:31], s49 offen nt
    s_add_u32 s49, s53, 1024
    buffer_load_dwordx4 v[52:55], v12, s[28:31], s49 offen nt
    s_add_u32 s49, s53, 16384
    buffer_load_dwordx4 v[56:59], v12, s[28:31], s49 offen nt
    s_barrier
    s_add_u32 s49, s53, 17408
    buffer_load_dwordx4 v[60:63], v12, s[28:31], s49 offen nt
    s_lshr_b32 s53, s52, 4
    s_mul_i32 s53, s53, 9
    s_add_u32 s53, s53, s52
    s_and_b32 s53, s53, 15
    s_lshr_b32 s49, s53, 3
    s_lshl_b32 s49, s49, 17
    s_and_b32 s53, s53, 7
    s_lshl_b32 s53, s53, 11
    s_add_u32 s53, s53, s49
    s_add_u32 s49, s53, 0
    buffer_load_dwordx4 v[68:71], v13, s[32:35], s49 offen nt
    s_add_u32 s49, s53, 32768
    buffer_load_dwordx4 v[72:75], v13, s[32:35], s49 offen nt
    s_add_u32 s49, s53, 16384
    buffer_load_dwordx4 v[76:79], v13, s[32:35], s49 offen nt
    s_waitcnt vmcnt(15)
    ds_write_b128 v8, v[80:83] offset:52224
    ds_write_b128 v8, v[84:87] offset:56576
    ds_write_b128 v8, v[88:91] offset:60928
    ds_write_b128 v8, v[64:67] offset:65280
    ds_write_b128 v9, v[24:27] offset:50688
    ds_write_b128 v9, v[28:31] offset:54912
    ds_write_b128 v9, v[96:99] offset:59136
    ds_write_b128 v9, v[100:103] offset:63360
    s_waitcnt lgkmcnt(0)
    s_add_u32 s49, s53, 49152
    buffer_load_dwordx4 v[24:27], v13, s[32:35], s49 offen nt
    s_lshr_b32 s53, s52, 4
    s_mul_i32 s53, s53, 11
    s_add_u32 s53, s53, s52
    s_and_b32 s53, s53, 15
    s_lshr_b32 s49, s53, 3
    s_lshl_b32 s49, s49, 17
    s_and_b32 s53, s53, 7
    s_lshl_b32 s53, s53, 11
    s_add_u32 s53, s53, s49
    s_add_u32 s49, s53, 0
    buffer_load_dwordx4 v[28:31], v12, s[28:31], s49 offen nt
    s_add_u32 s49, s53, 1024
    buffer_load_dwordx4 v[64:67], v12, s[28:31], s49 offen nt
    s_barrier
    s_add_u32 s49, s53, 16384
    buffer_load_dwordx4 v[80:83], v12, s[28:31], s49 offen nt
    s_add_u32 s49, s53, 17408
    buffer_load_dwordx4 v[84:87], v12, s[28:31], s49 offen nt
    s_lshr_b32 s53, s52, 4
    s_mul_i32 s53, s53, 10
    s_add_u32 s53, s53, s52
    s_and_b32 s53, s53, 15
    s_lshr_b32 s49, s53, 3
    s_lshl_b32 s49, s49, 17
    s_and_b32 s53, s53, 7
    s_lshl_b32 s53, s53, 11
    s_add_u32 s53, s53, s49
    s_add_u32 s49, s53, 0
    buffer_load_dwordx4 v[88:91], v13, s[32:35], s49 offen nt
    s_add_u32 s49, s53, 32768
    buffer_load_dwordx4 v[92:95], v13, s[32:35], s49 offen nt
    s_waitcnt vmcnt(14)
    ds_write_b128 v8, v[112:115] offset:0
    ds_write_b128 v8, v[116:119] offset:4352
    ds_write_b128 v8, v[16:19] offset:8704
    ds_write_b128 v8, v[20:23] offset:13056
    ds_write_b128 v9, v[44:47] offset:0
    ds_write_b128 v9, v[108:111] offset:4224
    ds_write_b128 v9, v[120:123] offset:8448
    ds_write_b128 v9, v[124:127] offset:12672
    s_waitcnt lgkmcnt(0)
    s_add_u32 s49, s53, 16384
    buffer_load_dwordx4 v[16:19], v13, s[32:35], s49 offen nt
    s_add_u32 s49, s53, 49152
    buffer_load_dwordx4 v[20:23], v13, s[32:35], s49 offen nt
    s_lshr_b32 s53, s52, 4
    s_mul_i32 s53, s53, 12
    s_add_u32 s53, s53, s52
    s_and_b32 s53, s53, 15
    s_lshr_b32 s49, s53, 3
    s_lshl_b32 s49, s49, 17
    s_and_b32 s53, s53, 7
    s_lshl_b32 s53, s53, 11
    s_add_u32 s53, s53, s49
    s_add_u32 s49, s53, 0
    buffer_load_dwordx4 v[44:47], v12, s[28:31], s49 offen nt
    s_barrier
    s_add_u32 s49, s53, 1024
    buffer_load_dwordx4 v[96:99], v12, s[28:31], s49 offen nt
    s_add_u32 s49, s53, 16384
    buffer_load_dwordx4 v[100:103], v12, s[28:31], s49 offen nt
    s_add_u32 s49, s53, 17408
    buffer_load_dwordx4 v[108:111], v12, s[28:31], s49 offen nt
    s_lshr_b32 s53, s52, 4
    s_mul_i32 s53, s53, 11
    s_add_u32 s53, s53, s52
    s_and_b32 s53, s53, 15
    s_lshr_b32 s49, s53, 3
    s_lshl_b32 s49, s49, 17
    s_and_b32 s53, s53, 7
    s_lshl_b32 s53, s53, 11
    s_add_u32 s53, s53, s49
    s_add_u32 s49, s53, 0
    buffer_load_dwordx4 v[112:115], v13, s[32:35], s49 offen nt
    s_waitcnt vmcnt(13)
    ds_write_b128 v8, v[104:107] offset:17408
    ds_write_b128 v8, v[32:35] offset:21760
    ds_write_b128 v8, v[36:39] offset:26112
    ds_write_b128 v8, v[40:43] offset:30464
    ds_write_b128 v9, v[68:71] offset:16896
    ds_write_b128 v9, v[72:75] offset:21120
    ds_write_b128 v9, v[76:79] offset:25344
    ds_write_b128 v9, v[24:27] offset:29568
    s_waitcnt lgkmcnt(0)
    s_add_u32 s49, s53, 32768
    buffer_load_dwordx4 v[24:27], v13, s[32:35], s49 offen nt
    s_add_u32 s49, s53, 16384
    buffer_load_dwordx4 v[32:35], v13, s[32:35], s49 offen nt
    s_add_u32 s49, s53, 49152
    buffer_load_dwordx4 v[36:39], v13, s[32:35], s49 offen nt
    s_barrier
    s_lshr_b32 s53, s52, 4
    s_mul_i32 s53, s53, 13
    s_add_u32 s53, s53, s52
    s_and_b32 s53, s53, 15
    s_lshr_b32 s49, s53, 3
    s_lshl_b32 s49, s49, 17
    s_and_b32 s53, s53, 7
    s_lshl_b32 s53, s53, 11
    s_add_u32 s53, s53, s49
    s_add_u32 s49, s53, 0
    buffer_load_dwordx4 v[40:43], v12, s[28:31], s49 offen nt
    s_add_u32 s49, s53, 1024
    buffer_load_dwordx4 v[68:71], v12, s[28:31], s49 offen nt
    s_add_u32 s49, s53, 16384
    buffer_load_dwordx4 v[72:75], v12, s[28:31], s49 offen nt
    s_add_u32 s49, s53, 17408
    buffer_load_dwordx4 v[76:79], v12, s[28:31], s49 offen nt
    s_waitcnt vmcnt(12)
    ds_write_b128 v8, v[48:51] offset:34816
    ds_write_b128 v8, v[52:55] offset:39168
    ds_write_b128 v8, v[56:59] offset:43520
    ds_write_b128 v8, v[60:63] offset:47872
    ds_write_b128 v9, v[88:91] offset:33792
    ds_write_b128 v9, v[92:95] offset:38016
    ds_write_b128 v9, v[16:19] offset:42240
    ds_write_b128 v9, v[20:23] offset:46464
    s_waitcnt lgkmcnt(0)
    s_lshr_b32 s53, s52, 4
    s_mul_i32 s53, s53, 12
    s_add_u32 s53, s53, s52
    s_and_b32 s53, s53, 15
    s_lshr_b32 s49, s53, 3
    s_lshl_b32 s49, s49, 17
    s_and_b32 s53, s53, 7
    s_lshl_b32 s53, s53, 11
    s_add_u32 s53, s53, s49
    s_add_u32 s49, s53, 0
    buffer_load_dwordx4 v[16:19], v13, s[32:35], s49 offen nt
    s_add_u32 s49, s53, 32768
    buffer_load_dwordx4 v[20:23], v13, s[32:35], s49 offen nt
    s_add_u32 s49, s53, 16384
    buffer_load_dwordx4 v[48:51], v13, s[32:35], s49 offen nt
    s_barrier
    s_add_u32 m0, s21, 106880
    s_add_u32 s49, s53, 49152
    buffer_load_dwordx4 v13, s[32:35], s49 offen nt lds
    s_lshr_b32 s53, s52, 4
    s_mul_i32 s53, s53, 14
    s_add_u32 s53, s53, s52
    s_and_b32 s53, s53, 15
    s_lshr_b32 s49, s53, 3
    s_lshl_b32 s49, s49, 17
    s_and_b32 s53, s53, 7
    s_lshl_b32 s53, s53, 11
    s_add_u32 s53, s53, s49
    s_add_u32 s49, s53, 0
    buffer_load_dwordx4 v[52:55], v12, s[28:31], s49 offen nt
    s_add_u32 s49, s53, 1024
    buffer_load_dwordx4 v[56:59], v12, s[28:31], s49 offen nt
    s_add_u32 s49, s53, 16384
    buffer_load_dwordx4 v[60:63], v12, s[28:31], s49 offen nt
    s_waitcnt vmcnt(11)
    ds_write_b128 v8, v[28:31] offset:52224
    ds_write_b128 v8, v[64:67] offset:56576
    ds_write_b128 v8, v[80:83] offset:60928
    ds_write_b128 v8, v[84:87] offset:65280
    ds_write_b128 v9, v[112:115] offset:50688
    ds_write_b128 v9, v[24:27] offset:54912
    ds_write_b128 v9, v[32:35] offset:59136
    ds_write_b128 v9, v[36:39] offset:63360
    s_waitcnt lgkmcnt(0)
    s_add_u32 s49, s53, 17408
    buffer_load_dwordx4 v[24:27], v12, s[28:31], s49 offen nt
    s_lshr_b32 s53, s52, 4
    s_mul_i32 s53, s53, 13
    s_add_u32 s53, s53, s52
    s_and_b32 s53, s53, 15
    s_lshr_b32 s49, s53, 3
    s_lshl_b32 s49, s49, 17
    s_and_b32 s53, s53, 7
    s_lshl_b32 s53, s53, 11
    s_add_u32 s53, s53, s49
    s_add_u32 s49, s53, 0
    buffer_load_dwordx4 v[28:31], v13, s[32:35], s49 offen nt
    s_add_u32 s49, s53, 32768
    buffer_load_dwordx4 v[32:35], v13, s[32:35], s49 offen nt
    s_barrier
    s_add_u32 m0, s21, 119552
    s_add_u32 s49, s53, 16384
    buffer_load_dwordx4 v13, s[32:35], s49 offen nt lds
    s_add_u32 m0, s21, 123776
    s_add_u32 s49, s53, 49152
    buffer_load_dwordx4 v13, s[32:35], s49 offen nt lds
    s_lshr_b32 s53, s52, 4
    s_mul_i32 s53, s53, 15
    s_add_u32 s53, s53, s52
    s_and_b32 s53, s53, 15
    s_lshr_b32 s49, s53, 3
    s_lshl_b32 s49, s49, 17
    s_and_b32 s53, s53, 7
    s_lshl_b32 s53, s53, 11
    s_add_u32 s53, s53, s49
    s_add_u32 s49, s53, 0
    buffer_load_dwordx4 v[36:39], v12, s[28:31], s49 offen nt
    s_add_u32 s49, s53, 1024
    buffer_load_dwordx4 v[64:67], v12, s[28:31], s49 offen nt
    s_waitcnt vmcnt(10)
    ds_write_b128 v8, v[44:47] offset:0
    ds_write_b128 v8, v[96:99] offset:4352
    ds_write_b128 v8, v[100:103] offset:8704
    ds_write_b128 v8, v[108:111] offset:13056
    ds_write_b128 v9, v[16:19] offset:0
    ds_write_b128 v9, v[20:23] offset:4224
    ds_write_b128 v9, v[48:51] offset:8448
    s_waitcnt lgkmcnt(0)
    s_add_u32 s49, s53, 16384
    buffer_load_dwordx4 v[16:19], v12, s[28:31], s49 offen nt
    s_add_u32 s49, s53, 17408
    buffer_load_dwordx4 v[20:23], v12, s[28:31], s49 offen nt
    s_lshr_b32 s53, s52, 4
    s_mul_i32 s53, s53, 14
    s_add_u32 s53, s53, s52
    s_and_b32 s53, s53, 15
    s_lshr_b32 s49, s53, 3
    s_lshl_b32 s49, s49, 17
    s_and_b32 s53, s53, 7
    s_lshl_b32 s53, s53, 11
    s_add_u32 s53, s53, s49
    s_add_u32 s49, s53, 0
    buffer_load_dwordx4 v[44:47], v13, s[32:35], s49 offen nt
    s_barrier
    global_load_dword v2, v1, s[16:17] sc1
    s_add_u32 m0, s21, 132224
    s_add_u32 s49, s53, 32768
    buffer_load_dwordx4 v13, s[32:35], s49 offen nt lds
    s_add_u32 m0, s21, 136448
    s_add_u32 s49, s53, 16384
    buffer_load_dwordx4 v13, s[32:35], s49 offen nt lds
    s_add_u32 m0, s21, 140672
    s_add_u32 s49, s53, 49152
    buffer_load_dwordx4 v13, s[32:35], s49 offen nt lds
    s_lshr_b32 s53, s52, 4
    s_mul_i32 s53, s53, 15
    s_add_u32 s53, s53, s52
    s_and_b32 s53, s53, 15
    s_lshr_b32 s49, s53, 3
    s_lshl_b32 s49, s49, 17
    s_and_b32 s53, s53, 7
    s_lshl_b32 s53, s53, 11
    s_add_u32 s53, s53, s49
    s_add_u32 s49, s53, 0
    buffer_load_dwordx4 v[48:51], v13, s[32:35], s49 offen nt
    s_waitcnt vmcnt(10)
    ds_write_b128 v8, v[40:43] offset:17408
    ds_write_b128 v8, v[68:71] offset:21760
    ds_write_b128 v8, v[72:75] offset:26112
    ds_write_b128 v8, v[76:79] offset:30464
    ds_write_b128 v9, v[28:31] offset:16896
    ds_write_b128 v9, v[32:35] offset:21120
    s_waitcnt lgkmcnt(0)
    s_add_u32 s49, s53, 32768
    buffer_load_dwordx4 v[28:31], v13, s[32:35], s49 offen nt
    s_add_u32 s49, s53, 16384
    buffer_load_dwordx4 v[32:35], v13, s[32:35], s49 offen nt
    s_add_u32 s49, s53, 49152
    buffer_load_dwordx4 v[40:43], v13, s[32:35], s49 offen nt
    s_barrier
    s_waitcnt vmcnt(4)
    ds_write_b128 v8, v[52:55] offset:34816
    ds_write_b128 v8, v[56:59] offset:39168
    ds_write_b128 v8, v[60:63] offset:43520
    ds_write_b128 v8, v[24:27] offset:47872
    ds_write_b128 v9, v[44:47] offset:33792
    s_waitcnt lgkmcnt(0)
    s_add_u32 s47, s51, 0
    s_and_b32 s47, s47, 7
    s_lshl_b32 s47, s47, 17
    s_add_u32 s47, s47, s22
    s_add_u32 m0, s24, 69632
    s_add_u32 s47, s47, 0
    buffer_load_dwordx4 v245, s[40:43], s47 offen lds
    s_add_u32 s47, s51, 0
    s_and_b32 s47, s47, 7
    s_lshl_b32 s47, s47, 17
    s_add_u32 s47, s47, s22
    s_add_u32 m0, s24, 73728
    s_add_u32 s47, s47, 32768
    buffer_load_dwordx4 v245, s[40:43], s47 offen lds
    s_add_u32 s47, s51, 0
    s_and_b32 s47, s47, 7
    s_lshl_b32 s47, s47, 17
    s_add_u32 s47, s47, s22
    s_add_u32 m0, s24, 77824
    s_add_u32 s47, s47, 65536
    buffer_load_dwordx4 v245, s[40:43], s47 offen lds
    s_add_u32 s47, s51, 0
    s_and_b32 s47, s47, 7
    s_lshl_b32 s47, s47, 17
    s_add_u32 s47, s47, s22
    s_add_u32 m0, s24, 81920
    s_add_u32 s47, s47, 98304
    buffer_load_dwordx4 v245, s[40:43], s47 offen lds
    s_add_u32 s47, s51, 1
    s_and_b32 s47, s47, 7
    s_lshl_b32 s47, s47, 17
    s_add_u32 s47, s47, s22
    s_add_u32 m0, s24, 86016
    s_add_u32 s47, s47, 0
    buffer_load_dwordx4 v245, s[40:43], s47 offen lds
    s_add_u32 s47, s51, 1
    s_and_b32 s47, s47, 7
    s_lshl_b32 s47, s47, 17
    s_add_u32 s47, s47, s22
    s_add_u32 m0, s24, 90112
    s_add_u32 s47, s47, 32768
    buffer_load_dwordx4 v245, s[40:43], s47 offen lds
    s_add_u32 s47, s51, 1
    s_and_b32 s47, s47, 7
    s_lshl_b32 s47, s47, 17
    s_add_u32 s47, s47, s22
    s_add_u32 s47, s47, 65536
    buffer_load_dwordx4 v[24:27], v245, s[40:43], s47 offen
    s_add_u32 s47, s51, 4
    s_and_b32 s47, s47, 7
    s_lshl_b32 s47, s47, 17
    s_add_u32 s47, s47, s22
    s_add_u32 s47, s47, 0
    buffer_load_dwordx4 v[44:47], v245, s[40:43], s47 offen
    s_add_u32 s47, s51, 1
    s_and_b32 s47, s47, 7
    s_lshl_b32 s47, s47, 17
    s_add_u32 s47, s47, s22
    s_add_u32 s47, s47, 98304
    buffer_load_dwordx4 v[52:55], v245, s[40:43], s47 offen
    s_add_u32 s47, s51, 4
    s_and_b32 s47, s47, 7
    s_lshl_b32 s47, s47, 17
    s_add_u32 s47, s47, s22
    s_add_u32 s47, s47, 32768
    buffer_load_dwordx4 v[56:59], v245, s[40:43], s47 offen
    s_add_u32 s47, s51, 2
    s_and_b32 s47, s47, 7
    s_lshl_b32 s47, s47, 17
    s_add_u32 s47, s47, s22
    s_add_u32 s47, s47, 0
    buffer_load_dwordx4 v[60:63], v245, s[40:43], s47 offen
    s_mov_b32 s3, 0
A_cpoll:
    v_cmp_gt_u32 vcc, 64, v2
    s_cbranch_vccz A_cok
    s_sleep 4
    global_load_dword v2, v1, s[16:17] sc1
    s_add_u32 s3, s3, 1
    s_waitcnt vmcnt(0)
    s_cmp_lt_u32 s3, 0x40000
    s_cbranch_scc1 A_cpoll
A_cok:
    s_barrier
    s_waitcnt vmcnt(11)
    ds_write_b128 v8, v[36:39] offset:52224
    ds_write_b128 v8, v[64:67] offset:56576
    ds_write_b128 v8, v[16:19] offset:60928
    ds_write_b128 v8, v[20:23] offset:65280
    ds_write_b128 v9, v[48:51] offset:50688
    ds_write_b128 v9, v[28:31] offset:54912
    ds_write_b128 v9, v[32:35] offset:59136
    ds_write_b128 v9, v[40:43] offset:63360
    s_waitcnt lgkmcnt(0)
    s_add_u32 s47, s51, 4
    s_and_b32 s47, s47, 7
    s_lshl_b32 s47, s47, 17
    s_add_u32 s47, s47, s22
    s_add_u32 s47, s47, 65536
    buffer_load_dwordx4 v[16:19], v245, s[40:43], s47 offen
    s_add_u32 s47, s51, 2
    s_and_b32 s47, s47, 7
    s_lshl_b32 s47, s47, 17
    s_add_u32 s47, s47, s22
    s_add_u32 s47, s47, 32768
    buffer_load_dwordx4 v[20:23], v245, s[40:43], s47 offen
    s_add_u32 s47, s51, 4
    s_and_b32 s47, s47, 7
    s_lshl_b32 s47, s47, 17
    s_add_u32 s47, s47, s22
    s_add_u32 s47, s47, 98304
    buffer_load_dwordx4 v[28:31], v245, s[40:43], s47 offen
    s_add_u32 s47, s51, 2
    s_and_b32 s47, s47, 7
    s_lshl_b32 s47, s47, 17
    s_add_u32 s47, s47, s22
    s_add_u32 s47, s47, 65536
    buffer_load_dwordx4 v[32:35], v245, s[40:43], s47 offen
    s_add_u32 s47, s51, 5
    s_and_b32 s47, s47, 7
    s_lshl_b32 s47, s47, 17
    s_add_u32 s47, s47, s22
    s_add_u32 s47, s47, 0
    buffer_load_dwordx4 v[36:39], v245, s[40:43], s47 offen
    s_add_u32 s47, s51, 2
    s_and_b32 s47, s47, 7
    s_lshl_b32 s47, s47, 17
    s_add_u32 s47, s47, s22
    s_add_u32 s47, s47, 98304
    buffer_load_dwordx4 v[40:43], v245, s[40:43], s47 offen
    s_add_u32 s47, s51, 5
    s_and_b32 s47, s47, 7
    s_lshl_b32 s47, s47, 17
    s_add_u32 s47, s47, s22
    s_add_u32 s47, s47, 32768
    buffer_load_dwordx4 v[48:51], v245, s[40:43], s47 offen
    s_add_u32 s47, s51, 3
    s_and_b32 s47, s47, 7
    s_lshl_b32 s47, s47, 17
    s_add_u32 s47, s47, s22
    s_add_u32 s47, s47, 0
    buffer_load_dwordx4 v[64:67], v245, s[40:43], s47 offen
    s_add_u32 s47, s51, 5
    s_and_b32 s47, s47, 7
    s_lshl_b32 s47, s47, 17
    s_add_u32 s47, s47, s22
    s_add_u32 s47, s47, 65536
    buffer_load_dwordx4 v[68:71], v245, s[40:43], s47 offen
    s_add_u32 s47, s51, 3
    s_and_b32 s47, s47, 7
    s_lshl_b32 s47, s47, 17
    s_add_u32 s47, s47, s22
    s_add_u32 s47, s47, 32768
    buffer_load_dwordx4 v[72:75], v245, s[40:43], s47 offen
    s_add_u32 s47, s51, 5
    s_and_b32 s47, s47, 7
    s_lshl_b32 s47, s47, 17
    s_add_u32 s47, s47, s22
    s_add_u32 s47, s47, 98304
    buffer_load_dwordx4 v[76:79], v245, s[40:43], s47 offen
    s_barrier
    s_add_u32 s47, s51, 3
    s_and_b32 s47, s47, 7
    s_lshl_b32 s47, s47, 17
    s_add_u32 s47, s47, s22
    s_add_u32 s47, s47, 65536
    buffer_load_dwordx4 v[80:83], v245, s[40:43], s47 offen
    s_add_u32 s47, s51, 3
    s_and_b32 s47, s47, 7
    s_lshl_b32 s47, s47, 17
    s_add_u32 s47, s47, s22
    s_add_u32 s47, s47, 98304
    buffer_load_dwordx4 v[84:87], v245, s[40:43], s47 offen
    s_add_u32 s47, s51, 6
    s_and_b32 s47, s47, 7
    s_lshl_b32 s47, s47, 17
    s_add_u32 s47, s47, s22
    s_add_u32 s47, s47, 0
    buffer_load_dwordx4 v[88:91], v245, s[40:43], s47 offen
    s_add_u32 s47, s51, 6
    s_and_b32 s47, s47, 7
    s_lshl_b32 s47, s47, 17
    s_add_u32 s47, s47, s22
    s_add_u32 s47, s47, 32768
    buffer_load_dwordx4 v[92:95], v245, s[40:43], s47 offen
    s_add_u32 s47, s51, 6
    s_and_b32 s47, s47, 7
    s_lshl_b32 s47, s47, 17
    s_add_u32 s47, s47, s22
    s_add_u32 s47, s47, 65536
    buffer_load_dwordx4 v[96:99], v245, s[40:43], s47 offen
    s_add_u32 s47, s51, 6
    s_and_b32 s47, s47, 7
    s_lshl_b32 s47, s47, 17
    s_add_u32 s47, s47, s22
    s_add_u32 s47, s47, 98304
    buffer_load_dwordx4 v[100:103], v245, s[40:43], s47 offen
    s_add_u32 s47, s51, 7
    s_and_b32 s47, s47, 7
    s_lshl_b32 s47, s47, 17
    s_add_u32 s47, s47, s22
    s_add_u32 s47, s47, 0
    buffer_load_dwordx4 v[104:107], v245, s[40:43], s47 offen
    s_add_u32 s47, s51, 7
    s_and_b32 s47, s47, 7
    s_lshl_b32 s47, s47, 17
    s_add_u32 s47, s47, s22
    s_add_u32 s47, s47, 32768
    buffer_load_dwordx4 v[108:111], v245, s[40:43], s47 offen
    s_add_u32 s47, s51, 7
    s_and_b32 s47, s47, 7
    s_lshl_b32 s47, s47, 17
    s_add_u32 s47, s47, s22
    s_add_u32 s47, s47, 65536
    buffer_load_dwordx4 v[112:115], v245, s[40:43], s47 offen
    s_add_u32 s47, s51, 7
    s_and_b32 s47, s47, 7
    s_lshl_b32 s47, s47, 17
    s_add_u32 s47, s47, s22
    s_add_u32 s47, s47, 98304
    buffer_load_dwordx4 v[116:119], v245, s[40:43], s47 offen
    s_waitcnt vmcnt(25)
    ds_write_b128 v15, v[24:27] offset:24576
    s_waitcnt vmcnt(24)
    ds_write_b128 v14, v[44:47] offset:0
    s_waitcnt vmcnt(23)
    ds_write_b128 v15, v[52:55] offset:28672
    s_waitcnt vmcnt(22)
    ds_write_b128 v14, v[56:59] offset:4096
    s_waitcnt vmcnt(21)
    ds_write_b128 v15, v[60:63] offset:32768
    s_waitcnt vmcnt(20)
    ds_write_b128 v14, v[16:19] offset:8192
    s_waitcnt vmcnt(19)
    ds_write_b128 v15, v[20:23] offset:36864
    s_waitcnt vmcnt(18)
    ds_write_b128 v14, v[28:31] offset:12288
    s_waitcnt vmcnt(17)
    ds_write_b128 v15, v[32:35] offset:40960
    s_waitcnt vmcnt(16)
    ds_write_b128 v14, v[36:39] offset:16384
    s_waitcnt vmcnt(15)
    ds_write_b128 v15, v[40:43] offset:45056
    s_waitcnt vmcnt(14)
    ds_write_b128 v14, v[48:51] offset:20480
    s_waitcnt vmcnt(13)
    ds_write_b128 v15, v[64:67] offset:49152
    s_waitcnt vmcnt(12)
    ds_write_b128 v14, v[68:71] offset:24576
    s_waitcnt vmcnt(11)
    ds_write_b128 v15, v[72:75] offset:53248
    s_waitcnt vmcnt(10)
    ds_write_b128 v14, v[76:79] offset:28672
    s_waitcnt vmcnt(0)
    s_barrier
    ds_write_b128 v15, v[80:83] offset:57344
    ds_write_b128 v15, v[84:87] offset:61440
    ds_write_b128 v14, v[88:91] offset:32768
    ds_write_b128 v14, v[92:95] offset:36864
    ds_write_b128 v14, v[96:99] offset:40960
    ds_write_b128 v14, v[100:103] offset:45056
    ds_write_b128 v14, v[104:107] offset:49152
    ds_write_b128 v14, v[108:111] offset:53248
    ds_write_b128 v14, v[112:115] offset:57344
    ds_write_b128 v14, v[116:119] offset:61440
    s_waitcnt lgkmcnt(0)
    s_barrier
    s_waitcnt vmcnt(0)
    s_endpgm
A_hot_end:
A_rare0:
    s_waitcnt lgkmcnt(0)
    ds_read_b128 v[220:223], v244 offset:0
    s_waitcnt lgkmcnt(0)
    v_mfma_f32_16x16x32_bf16 v[144:147], v[220:223], v[96:99], v[192:195]
    v_mfma_f32_16x16x32_bf16 v[148:151], v[220:223], v[100:103], v[196:199]
    v_mfma_f32_16x16x32_bf16 v[152:155], v[220:223], v[104:107], v[200:203]
    ds_read_b128 v[248:251], v244 offset:64
    s_waitcnt lgkmcnt(0)
    v_mfma_f32_16x16x32_bf16 v[144:147], v[248:251], v[108:111], v[144:147]
    v_mfma_f32_16x16x32_bf16 v[148:151], v[248:251], v[112:115], v[148:151]
    v_mfma_f32_16x16x32_bf16 v[152:155], v[248:251], v[116:119], v[152:155]
    ds_read_b128 v[220:223], v244 offset:128
    s_waitcnt lgkmcnt(0)
    v_mfma_f32_16x16x32_bf16 v[144:147], v[220:223], v[120:123], v[144:147]
    v_mfma_f32_16x16x32_bf16 v[148:151], v[220:223], v[124:127], v[148:151]
    v_mfma_f32_16x16x32_bf16 v[152:155], v[220:223], v[128:131], v[152:155]
    ds_read_b128 v[248:251], v244 offset:192
    s_waitcnt lgkmcnt(0)
    v_mfma_f32_16x16x32_bf16 v[144:147], v[248:251], v[132:135], v[144:147]
    v_mfma_f32_16x16x32_bf16 v[148:151], v[248:251], v[136:139], v[148:151]
    v_mfma_f32_16x16x32_bf16 v[152:155], v[248:251], v[140:143], v[152:155]
    ds_read_b128 v[220:223], v244 offset:4352
    s_waitcnt lgkmcnt(0)
    v_mfma_f32_16x16x32_bf16 v[156:159], v[220:223], v[96:99], v[192:195]
    v_mfma_f32_16x16x32_bf16 v[160:163], v[220:223], v[100:103], v[196:199]
    v_mfma_f32_16x16x32_bf16 v[164:167], v[220:223], v[104:107], v[200:203]
    ds_read_b128 v[248:251], v244 offset:4416
    s_waitcnt lgkmcnt(0)
    v_mfma_f32_16x16x32_bf16 v[156:159], v[248:251], v[108:111], v[156:159]
    v_mfma_f32_16x16x32_bf16 v[160:163], v[248:251], v[112:115], v[160:163]
    v_mfma_f32_16x16x32_bf16 v[164:167], v[248:251], v[116:119], v[164:167]
    ds_read_b128 v[220:223], v244 offset:4480
    s_waitcnt lgkmcnt(0)
    v_mfma_f32_16x16x32_bf16 v[156:159], v[220:223], v[120:123], v[156:159]
    v_mfma_f32_16x16x32_bf16 v[160:163], v[220:223], v[124:127], v[160:163]
    v_mfma_f32_16x16x32_bf16 v[164:167], v[220:223], v[128:131], v[164:167]
    ds_read_b128 v[248:251], v244 offset:4544
    s_waitcnt lgkmcnt(0)
    v_mfma_f32_16x16x32_bf16 v[156:159], v[248:251], v[132:135], v[156:159]
    v_mfma_f32_16x16x32_bf16 v[160:163], v[248:251], v[136:139], v[160:163]
    v_mfma_f32_16x16x32_bf16 v[164:167], v[248:251], v[140:143], v[164:167]
    v_max3_f32 v180, v144, v145, v146
    s_nop 4
    v_max3_f32 v180, v180, v147, v156
    v_max3_f32 v180, v180, v157, v158
    v_max_f32 v180, v180, v159
    v_max3_f32 v182, v148, v149, v150
    v_max3_f32 v182, v182, v151, v160
    v_max3_f32 v182, v182, v161, v162
    v_max_f32 v182, v182, v163
    v_max3_f32 v184, v152, v153, v154
    v_max3_f32 v184, v184, v155, v164
    v_max3_f32 v184, v184, v165, v166
    v_max_f32 v184, v184, v167
    v_mov_b32 v181, v180
    v_mov_b32 v183, v182
    v_mov_b32 v185, v184
    v_permlane16_swap_b32 v180, v181
    v_permlane16_swap_b32 v182, v183
    v_permlane16_swap_b32 v184, v185
    v_max_f32 v180, v180, v181
    v_max_f32 v182, v182, v183
    v_max_f32 v184, v184, v185
    v_mov_b32 v181, v180
    v_mov_b32 v183, v182
    v_mov_b32 v185, v184
    v_permlane32_swap_b32 v180, v181
    v_permlane32_swap_b32 v182, v183
    v_permlane32_swap_b32 v184, v185
    v_max_f32 v180, v180, v181
    v_max_f32 v182, v182, v183
    v_max_f32 v184, v184, v185
    v_add_f32 v180, 0x41800000, v180
    v_max_f32 v180, 0, v180
    v_exp_f32 v181, -v180
    v_add_f32 v182, 0x41800000, v182
    v_max_f32 v182, 0, v182
    v_exp_f32 v183, -v182
    v_add_f32 v184, 0x41800000, v184
    v_max_f32 v184, 0, v184
    v_exp_f32 v185, -v184
    v_sub_f32 v192, v192, v180
    v_sub_f32 v193, v193, v180
    v_sub_f32 v194, v194, v180
    v_sub_f32 v195, v195, v180
    v_sub_f32 v144, v144, v180
    v_sub_f32 v145, v145, v180
    v_sub_f32 v146, v146, v180
    v_sub_f32 v147, v147, v180
    v_sub_f32 v156, v156, v180
    v_sub_f32 v157, v157, v180
    v_sub_f32 v158, v158, v180
    v_sub_f32 v159, v159, v180
    v_sub_f32 v196, v196, v182
    v_sub_f32 v197, v197, v182
    v_sub_f32 v198, v198, v182
    v_sub_f32 v199, v199, v182
    v_sub_f32 v148, v148, v182
    v_sub_f32 v149, v149, v182
    v_sub_f32 v150, v150, v182
    v_sub_f32 v151, v151, v182
    v_sub_f32 v160, v160, v182
    v_sub_f32 v161, v161, v182
    v_sub_f32 v162, v162, v182
    v_sub_f32 v163, v163, v182
    v_sub_f32 v200, v200, v184
    v_sub_f32 v201, v201, v184
    v_sub_f32 v202, v202, v184
    v_sub_f32 v203, v203, v184
    v_sub_f32 v152, v152, v184
    v_sub_f32 v153, v153, v184
    v_sub_f32 v154, v154, v184
    v_sub_f32 v155, v155, v184
    v_sub_f32 v164, v164, v184
    v_sub_f32 v165, v165, v184
    v_sub_f32 v166, v166, v184
    v_sub_f32 v167, v167, v184
    v_exp_f32 v144, v144
    v_exp_f32 v145, v145
    v_exp_f32 v146, v146
    v_exp_f32 v147, v147
    v_exp_f32 v148, v148
    v_exp_f32 v149, v149
    v_exp_f32 v150, v150
    v_exp_f32 v151, v151
    v_exp_f32 v152, v152
    v_exp_f32 v153, v153
    v_exp_f32 v154, v154
    v_exp_f32 v155, v155
    v_exp_f32 v156, v156
    v_exp_f32 v157, v157
    v_exp_f32 v158, v158
    v_exp_f32 v159, v159
    v_exp_f32 v160, v160
    v_exp_f32 v161, v161
    v_exp_f32 v162, v162
    v_exp_f32 v163, v163
    v_exp_f32 v164, v164
    v_exp_f32 v165, v165
    v_exp_f32 v166, v166
    v_exp_f32 v167, v167
    v_cvt_pk_bf16_f32 v168, v144, v145
    v_cvt_pk_bf16_f32 v169, v146, v147
    v_cvt_pk_bf16_f32 v172, v148, v149
    v_cvt_pk_bf16_f32 v173, v150, v151
    v_cvt_pk_bf16_f32 v176, v152, v153
    v_cvt_pk_bf16_f32 v177, v154, v155
    v_cvt_pk_bf16_f32 v170, v156, v157
    v_cvt_pk_bf16_f32 v171, v158, v159
    v_cvt_pk_bf16_f32 v174, v160, v161
    v_cvt_pk_bf16_f32 v175, v162, v163
    v_cvt_pk_bf16_f32 v178, v164, v165
    v_cvt_pk_bf16_f32 v179, v166, v167
    v_mul_f32 v204, v204, v181
    v_mul_f32 v205, v205, v181
    v_mul_f32 v206, v206, v181
    v_mul_f32 v207, v207, v181
    v_mul_f32 v0, v0, v181
    v_mul_f32 v1, v1, v181
    v_mul_f32 v2, v2, v181
    v_mul_f32 v3, v3, v181
    v_mul_f32 v12, v12, v181
    v_mul_f32 v13, v13, v181
    v_mul_f32 v14, v14, v181
    v_mul_f32 v15, v15, v181
    v_mul_f32 v24, v24, v181
    v_mul_f32 v25, v25, v181
    v_mul_f32 v26, v26, v181
    v_mul_f32 v27, v27, v181
    v_mul_f32 v36, v36, v181
    v_mul_f32 v37, v37, v181
    v_mul_f32 v38, v38, v181
    v_mul_f32 v39, v39, v181
    v_mul_f32 v48, v48, v181
    v_mul_f32 v49, v49, v181
    v_mul_f32 v50, v50, v181
    v_mul_f32 v51, v51, v181
    v_mul_f32 v60, v60, v181
    v_mul_f32 v61, v61, v181
    v_mul_f32 v62, v62, v181
    v_mul_f32 v63, v63, v181
    v_mul_f32 v72, v72, v181
    v_mul_f32 v73, v73, v181
    v_mul_f32 v74, v74, v181
    v_mul_f32 v75, v75, v181
    v_mul_f32 v84, v84, v181
    v_mul_f32 v85, v85, v181
    v_mul_f32 v86, v86, v181
    v_mul_f32 v87, v87, v181
    v_mul_f32 v208, v208, v183
    v_mul_f32 v209, v209, v183
    v_mul_f32 v210, v210, v183
    v_mul_f32 v211, v211, v183
    v_mul_f32 v4, v4, v183
    v_mul_f32 v5, v5, v183
    v_mul_f32 v6, v6, v183
    v_mul_f32 v7, v7, v183
    v_mul_f32 v16, v16, v183
    v_mul_f32 v17, v17, v183
    v_mul_f32 v18, v18, v183
    v_mul_f32 v19, v19, v183
    v_mul_f32 v28, v28, v183
    v_mul_f32 v29, v29, v183
    v_mul_f32 v30, v30, v183
    v_mul_f32 v31, v31, v183
    v_mul_f32 v40, v40, v183
    v_mul_f32 v41, v41, v183
    v_mul_f32 v42, v42, v183
    v_mul_f32 v43, v43, v183
    v_mul_f32 v52, v52, v183
    v_mul_f32 v53, v53, v183
    v_mul_f32 v54, v54, v183
    v_mul_f32 v55, v55, v183
    v_mul_f32 v64, v64, v183
    v_mul_f32 v65, v65, v183
    v_mul_f32 v66, v66, v183
    v_mul_f32 v67, v67, v183
    v_mul_f32 v76, v76, v183
    v_mul_f32 v77, v77, v183
    v_mul_f32 v78, v78, v183
    v_mul_f32 v79, v79, v183
    v_mul_f32 v88, v88, v183
    v_mul_f32 v89, v89, v183
    v_mul_f32 v90, v90, v183
    v_mul_f32 v91, v91, v183
    v_mul_f32 v212, v212, v185
    v_mul_f32 v213, v213, v185
    v_mul_f32 v214, v214, v185
    v_mul_f32 v215, v215, v185
    v_mul_f32 v8, v8, v185
    v_mul_f32 v9, v9, v185
    v_mul_f32 v10, v10, v185
    v_mul_f32 v11, v11, v185
    v_mul_f32 v20, v20, v185
    v_mul_f32 v21, v21, v185
    v_mul_f32 v22, v22, v185
    v_mul_f32 v23, v23, v185
    v_mul_f32 v32, v32, v185
    v_mul_f32 v33, v33, v185
    v_mul_f32 v34, v34, v185
    v_mul_f32 v35, v35, v185
    v_mul_f32 v44, v44, v185
    v_mul_f32 v45, v45, v185
    v_mul_f32 v46, v46, v185
    v_mul_f32 v47, v47, v185
    v_mul_f32 v56, v56, v185
    v_mul_f32 v57, v57, v185
    v_mul_f32 v58, v58, v185
    v_mul_f32 v59, v59, v185
    v_mul_f32 v68, v68, v185
    v_mul_f32 v69, v69, v185
    v_mul_f32 v70, v70, v185
    v_mul_f32 v71, v71, v185
    v_mul_f32 v80, v80, v185
    v_mul_f32 v81, v81, v185
    v_mul_f32 v82, v82, v185
    v_mul_f32 v83, v83, v185
    v_mul_f32 v92, v92, v185
    v_mul_f32 v93, v93, v185
    v_mul_f32 v94, v94, v185
    v_mul_f32 v95, v95, v185
    ds_read_b128 v[220:223], v244 offset:8704
    s_waitcnt lgkmcnt(0)
    v_mfma_f32_16x16x32_bf16 v[144:147], v[220:223], v[96:99], v[192:195]
    v_mfma_f32_16x16x32_bf16 v[148:151], v[220:223], v[100:103], v[196:199]
    v_mfma_f32_16x16x32_bf16 v[152:155], v[220:223], v[104:107], v[200:203]
    ds_read_b128 v[248:251], v244 offset:8768
    s_waitcnt lgkmcnt(0)
    v_mfma_f32_16x16x32_bf16 v[144:147], v[248:251], v[108:111], v[144:147]
    v_mfma_f32_16x16x32_bf16 v[148:151], v[248:251], v[112:115], v[148:151]
    v_mfma_f32_16x16x32_bf16 v[152:155], v[248:251], v[116:119], v[152:155]
    ds_read_b128 v[220:223], v244 offset:8832
    s_waitcnt lgkmcnt(0)
    v_mfma_f32_16x16x32_bf16 v[144:147], v[220:223], v[120:123], v[144:147]
    v_mfma_f32_16x16x32_bf16 v[148:151], v[220:223], v[124:127], v[148:151]
    v_mfma_f32_16x16x32_bf16 v[152:155], v[220:223], v[128:131], v[152:155]
    ds_read_b128 v[248:251], v244 offset:8896
    s_waitcnt lgkmcnt(0)
    v_mfma_f32_16x16x32_bf16 v[144:147], v[248:251], v[132:135], v[144:147]
    v_mfma_f32_16x16x32_bf16 v[148:151], v[248:251], v[136:139], v[148:151]
    v_mfma_f32_16x16x32_bf16 v[152:155], v[248:251], v[140:143], v[152:155]
    ds_read_b128 v[220:223], v244 offset:13056
    s_waitcnt lgkmcnt(0)
    v_mfma_f32_16x16x32_bf16 v[156:159], v[220:223], v[96:99], v[192:195]
    v_mfma_f32_16x16x32_bf16 v[160:163], v[220:223], v[100:103], v[196:199]
    v_mfma_f32_16x16x32_bf16 v[164:167], v[220:223], v[104:107], v[200:203]
    ds_read_b128 v[248:251], v244 offset:13120
    s_waitcnt lgkmcnt(0)
    v_mfma_f32_16x16x32_bf16 v[156:159], v[248:251], v[108:111], v[156:159]
    v_mfma_f32_16x16x32_bf16 v[160:163], v[248:251], v[112:115], v[160:163]
    v_mfma_f32_16x16x32_bf16 v[164:167], v[248:251], v[116:119], v[164:167]
    ds_read_b128 v[220:223], v244 offset:13184
    s_waitcnt lgkmcnt(0)
    v_mfma_f32_16x16x32_bf16 v[156:159], v[220:223], v[120:123], v[156:159]
    v_mfma_f32_16x16x32_bf16 v[160:163], v[220:223], v[124:127], v[160:163]
    v_mfma_f32_16x16x32_bf16 v[164:167], v[220:223], v[128:131], v[164:167]
    ds_read_b128 v[248:251], v244 offset:13248
    s_waitcnt lgkmcnt(0)
    v_mfma_f32_16x16x32_bf16 v[156:159], v[248:251], v[132:135], v[156:159]
    v_mfma_f32_16x16x32_bf16 v[160:163], v[248:251], v[136:139], v[160:163]
    v_mfma_f32_16x16x32_bf16 v[164:167], v[248:251], v[140:143], v[164:167]
    v_exp_f32 v144, v144
    v_exp_f32 v145, v145
    v_exp_f32 v146, v146
    v_exp_f32 v147, v147
    v_exp_f32 v148, v148
    v_exp_f32 v149, v149
    s_branch A_back0
A_rare1:
    s_waitcnt lgkmcnt(0)
    ds_read_b128 v[220:223], v244 offset:8704
    s_waitcnt lgkmcnt(0)
    v_mfma_f32_16x16x32_bf16 v[144:147], v[220:223], v[96:99], v[192:195]
    v_mfma_f32_16x16x32_bf16 v[148:151], v[220:223], v[100:103], v[196:199]
    v_mfma_f32_16x16x32_bf16 v[152:155], v[220:223], v[104:107], v[200:203]
    ds_read_b128 v[248:251], v244 offset:8768
    s_waitcnt lgkmcnt(0)
    v_mfma_f32_16x16x32_bf16 v[144:147], v[248:251], v[108:111], v[144:147]
    v_mfma_f32_16x16x32_bf16 v[148:151], v[248:251], v[112:115], v[148:151]
    v_mfma_f32_16x16x32_bf16 v[152:155], v[248:251], v[116:119], v[152:155]
    ds_read_b128 v[220:223], v244 offset:8832
    s_waitcnt lgkmcnt(0)
    v_mfma_f32_16x16x32_bf16 v[144:147], v[220:223], v[120:123], v[144:147]
    v_mfma_f32_16x16x32_bf16 v[148:151], v[220:223], v[124:127], v[148:151]
    v_mfma_f32_16x16x32_bf16 v[152:155], v[220:223], v[128:131], v[152:155]
    ds_read_b128 v[248:251], v244 offset:8896
    s_waitcnt lgkmcnt(0)
    v_mfma_f32_16x16x32_bf16 v[144:147], v[248:251], v[132:135], v[144:147]
    v_mfma_f32_16x16x32_bf16 v[148:151], v[248:251], v[136:139], v[148:151]
    v_mfma_f32_16x16x32_bf16 v[152:155], v[248:251], v[140:143], v[152:155]
    ds_read_b128 v[220:223], v244 offset:13056
    s_waitcnt lgkmcnt(0)
    v_mfma_f32_16x16x32_bf16 v[156:159], v[220:223], v[96:99], v[192:195]
    v_mfma_f32_16x16x32_bf16 v[160:163], v[220:223], v[100:103], v[196:199]
    v_mfma_f32_16x16x32_bf16 v[164:167], v[220:223], v[104:107], v[200:203]
    ds_read_b128 v[248:251], v244 offset:13120
    s_waitcnt lgkmcnt(0)
    v_mfma_f32_16x16x32_bf16 v[156:159], v[248:251], v[108:111], v[156:159]
    v_mfma_f32_16x16x32_bf16 v[160:163], v[248:251], v[112:115], v[160:163]
    v_mfma_f32_16x16x32_bf16 v[164:167], v[248:251], v[116:119], v[164:167]
    ds_read_b128 v[220:223], v244 offset:13184
    s_waitcnt lgkmcnt(0)
    v_mfma_f32_16x16x32_bf16 v[156:159], v[220:223], v[120:123], v[156:159]
    v_mfma_f32_16x16x32_bf16 v[160:163], v[220:223], v[124:127], v[160:163]
    v_mfma_f32_16x16x32_bf16 v[164:167], v[220:223], v[128:131], v[164:167]
    ds_read_b128 v[248:251], v244 offset:13248
    s_waitcnt lgkmcnt(0)
    v_mfma_f32_16x16x32_bf16 v[156:159], v[248:251], v[132:135], v[156:159]
    v_mfma_f32_16x16x32_bf16 v[160:163], v[248:251], v[136:139], v[160:163]
    v_mfma_f32_16x16x32_bf16 v[164:167], v[248:251], v[140:143], v[164:167]
    v_max3_f32 v168, v144, v145, v146
    s_nop 4
    v_max3_f32 v168, v168, v147, v156
    v_max3_f32 v168, v168, v157, v158
    v_max_f32 v168, v168, v159
    v_max3_f32 v170, v148, v149, v150
    v_max3_f32 v170, v170, v151, v160
    v_max3_f32 v170, v170, v161, v162
    v_max_f32 v170, v170, v163
    v_max3_f32 v172, v152, v153, v154
    v_max3_f32 v172, v172, v155, v164
    v_max3_f32 v172, v172, v165, v166
    v_max_f32 v172, v172, v167
    v_mov_b32 v169, v168
    v_mov_b32 v171, v170
    v_mov_b32 v173, v172
    v_permlane16_swap_b32 v168, v169
    v_permlane16_swap_b32 v170, v171
    v_permlane16_swap_b32 v172, v173
    v_max_f32 v168, v168, v169
    v_max_f32 v170, v170, v171
    v_max_f32 v172, v172, v173
    v_mov_b32 v169, v168
    v_mov_b32 v171, v170
    v_mov_b32 v173, v172
    v_permlane32_swap_b32 v168, v169
    v_permlane32_swap_b32 v170, v171
    v_permlane32_swap_b32 v172, v173
    v_max_f32 v168, v168, v169
    v_max_f32 v170, v170, v171
    v_max_f32 v172, v172, v173
    v_add_f32 v168, 0x41800000, v168
    v_max_f32 v168, 0, v168
    v_exp_f32 v169, -v168
    v_add_f32 v170, 0x41800000, v170
    v_max_f32 v170, 0, v170
    v_exp_f32 v171, -v170
    v_add_f32 v172, 0x41800000, v172
    v_max_f32 v172, 0, v172
    v_exp_f32 v173, -v172
    v_sub_f32 v192, v192, v168
    v_sub_f32 v193, v193, v168
    v_sub_f32 v194, v194, v168
    v_sub_f32 v195, v195, v168
    v_sub_f32 v144, v144, v168
    v_sub_f32 v145, v145, v168
    v_sub_f32 v146, v146, v168
    v_sub_f32 v147, v147, v168
    v_sub_f32 v156, v156, v168
    v_sub_f32 v157, v157, v168
    v_sub_f32 v158, v158, v168
    v_sub_f32 v159, v159, v168
    v_sub_f32 v196, v196, v170
    v_sub_f32 v197, v197, v170
    v_sub_f32 v198, v198, v170
    v_sub_f32 v199, v199, v170
    v_sub_f32 v148, v148, v170
    v_sub_f32 v149, v149, v170
    v_sub_f32 v150, v150, v170
    v_sub_f32 v151, v151, v170
    v_sub_f32 v160, v160, v170
    v_sub_f32 v161, v161, v170
    v_sub_f32 v162, v162, v170
    v_sub_f32 v163, v163, v170
    v_sub_f32 v200, v200, v172
    v_sub_f32 v201, v201, v172
    v_sub_f32 v202, v202, v172
    v_sub_f32 v203, v203, v172
    v_sub_f32 v152, v152, v172
    v_sub_f32 v153, v153, v172
    v_sub_f32 v154, v154, v172
    v_sub_f32 v155, v155, v172
    v_sub_f32 v164, v164, v172
    v_sub_f32 v165, v165, v172
    v_sub_f32 v166, v166, v172
    v_sub_f32 v167, v167, v172
    v_exp_f32 v144, v144
    v_exp_f32 v145, v145
    v_exp_f32 v146, v146
    v_exp_f32 v147, v147
    v_exp_f32 v148, v148
    v_exp_f32 v149, v149
    v_exp_f32 v150, v150
    v_exp_f32 v151, v151
    v_exp_f32 v152, v152
    v_exp_f32 v153, v153
    v_exp_f32 v154, v154
    v_exp_f32 v155, v155
    v_exp_f32 v156, v156
    v_exp_f32 v157, v157
    v_exp_f32 v158, v158
    v_exp_f32 v159, v159
    v_exp_f32 v160, v160
    v_exp_f32 v161, v161
    v_exp_f32 v162, v162
    v_exp_f32 v163, v163
    v_exp_f32 v164, v164
    v_exp_f32 v165, v165
    v_exp_f32 v166, v166
    v_exp_f32 v167, v167
    v_cvt_pk_bf16_f32 v180, v144, v145
    v_cvt_pk_bf16_f32 v181, v146, v147
    v_cvt_pk_bf16_f32 v184, v148, v149
    v_cvt_pk_bf16_f32 v185, v150, v151
    v_cvt_pk_bf16_f32 v188, v152, v153
    v_cvt_pk_bf16_f32 v189, v154, v155
    v_cvt_pk_bf16_f32 v182, v156, v157
    v_cvt_pk_bf16_f32 v183, v158, v159
    v_cvt_pk_bf16_f32 v186, v160, v161
    v_cvt_pk_bf16_f32 v187, v162, v163
    v_cvt_pk_bf16_f32 v190, v164, v165
    v_cvt_pk_bf16_f32 v191, v166, v167
    v_mul_f32 v204, v204, v169
    v_mul_f32 v205, v205, v169
    v_mul_f32 v206, v206, v169
    v_mul_f32 v207, v207, v169
    v_mul_f32 v0, v0, v169
    v_mul_f32 v1, v1, v169
    v_mul_f32 v2, v2, v169
    v_mul_f32 v3, v3, v169
    v_mul_f32 v12, v12, v169
    v_mul_f32 v13, v13, v169
    v_mul_f32 v14, v14, v169
    v_mul_f32 v15, v15, v169
    v_mul_f32 v24, v24, v169
    v_mul_f32 v25, v25, v169
    v_mul_f32 v26, v26, v169
    v_mul_f32 v27, v27, v169
    v_mul_f32 v36, v36, v169
    v_mul_f32 v37, v37, v169
    v_mul_f32 v38, v38, v169
    v_mul_f32 v39, v39, v169
    v_mul_f32 v48, v48, v169
    v_mul_f32 v49, v49, v169
    v_mul_f32 v50, v50, v169
    v_mul_f32 v51, v51, v169
    v_mul_f32 v60, v60, v169
    v_mul_f32 v61, v61, v169
    v_mul_f32 v62, v62, v169
    v_mul_f32 v63, v63, v169
    v_mul_f32 v72, v72, v169
    v_mul_f32 v73, v73, v169
    v_mul_f32 v74, v74, v169
    v_mul_f32 v75, v75, v169
    v_mul_f32 v84, v84, v169
    v_mul_f32 v85, v85, v169
    v_mul_f32 v86, v86, v169
    v_mul_f32 v87, v87, v169
    v_mul_f32 v208, v208, v171
    v_mul_f32 v209, v209, v171
    v_mul_f32 v210, v210, v171
    v_mul_f32 v211, v211, v171
    v_mul_f32 v4, v4, v171
    v_mul_f32 v5, v5, v171
    v_mul_f32 v6, v6, v171
    v_mul_f32 v7, v7, v171
    v_mul_f32 v16, v16, v171
    v_mul_f32 v17, v17, v171
    v_mul_f32 v18, v18, v171
    v_mul_f32 v19, v19, v171
    v_mul_f32 v28, v28, v171
    v_mul_f32 v29, v29, v171
    v_mul_f32 v30, v30, v171
    v_mul_f32 v31, v31, v171
    v_mul_f32 v40, v40, v171
    v_mul_f32 v41, v41, v171
    v_mul_f32 v42, v42, v171
    v_mul_f32 v43, v43, v171
    v_mul_f32 v52, v52, v171
    v_mul_f32 v53, v53, v171
    v_mul_f32 v54, v54, v171
    v_mul_f32 v55, v55, v171
    v_mul_f32 v64, v64, v171
    v_mul_f32 v65, v65, v171
    v_mul_f32 v66, v66, v171
    v_mul_f32 v67, v67, v171
    v_mul_f32 v76, v76, v171
    v_mul_f32 v77, v77, v171
    v_mul_f32 v78, v78, v171
    v_mul_f32 v79, v79, v171
    v_mul_f32 v88, v88, v171
    v_mul_f32 v89, v89, v171
    v_mul_f32 v90, v90, v171
    v_mul_f32 v91, v91, v171
    v_mul_f32 v212, v212, v173
    v_mul_f32 v213, v213, v173
    v_mul_f32 v214, v214, v173
    v_mul_f32 v215, v215, v173
    v_mul_f32 v8, v8, v173
    v_mul_f32 v9, v9, v173
    v_mul_f32 v10, v10, v173
    v_mul_f32 v11, v11, v173
    v_mul_f32 v20, v20, v173
    v_mul_f32 v21, v21, v173
    v_mul_f32 v22, v22, v173
    v_mul_f32 v23, v23, v173
    v_mul_f32 v32, v32, v173
    v_mul_f32 v33, v33, v173
    v_mul_f32 v34, v34, v173
    v_mul_f32 v35, v35, v173
    v_mul_f32 v44, v44, v173
    v_mul_f32 v45, v45, v173
    v_mul_f32 v46, v46, v173
    v_mul_f32 v47, v47, v173
    v_mul_f32 v56, v56, v173
    v_mul_f32 v57, v57, v173
    v_mul_f32 v58, v58, v173
    v_mul_f32 v59, v59, v173
    v_mul_f32 v68, v68, v173
    v_mul_f32 v69, v69, v173
    v_mul_f32 v70, v70, v173
    v_mul_f32 v71, v71, v173
    v_mul_f32 v80, v80, v173
    v_mul_f32 v81, v81, v173
    v_mul_f32 v82, v82, v173
    v_mul_f32 v83, v83, v173
    v_mul_f32 v92, v92, v173
    v_mul_f32 v93, v93, v173
    v_mul_f32 v94, v94, v173
    v_mul_f32 v95, v95, v173
    ds_read_b128 v[220:223], v244 offset:17408
    s_waitcnt lgkmcnt(0)
    v_mfma_f32_16x16x32_bf16 v[144:147], v[220:223], v[96:99], v[192:195]
    v_mfma_f32_16x16x32_bf16 v[148:151], v[220:223], v[100:103], v[196:199]
    v_mfma_f32_16x16x32_bf16 v[152:155], v[220:223], v[104:107], v[200:203]
    ds_read_b128 v[248:251], v244 offset:17472
    s_waitcnt lgkmcnt(0)
    v_mfma_f32_16x16x32_bf16 v[144:147], v[248:251], v[108:111], v[144:147]
    v_mfma_f32_16x16x32_bf16 v[148:151], v[248:251], v[112:115], v[148:151]
    v_mfma_f32_16x16x32_bf16 v[152:155], v[248:251], v[116:119], v[152:155]
    ds_read_b128 v[220:223], v244 offset:17536
    s_waitcnt lgkmcnt(0)
    v_mfma_f32_16x16x32_bf16 v[144:147], v[220:223], v[120:123], v[144:147]
    v_mfma_f32_16x16x32_bf16 v[148:151], v[220:223], v[124:127], v[148:151]
    v_mfma_f32_16x16x32_bf16 v[152:155], v[220:223], v[128:131], v[152:155]
    ds_read_b128 v[248:251], v244 offset:17600
    s_waitcnt lgkmcnt(0)
    v_mfma_f32_16x16x32_bf16 v[144:147], v[248:251], v[132:135], v[144:147]
    v_mfma_f32_16x16x32_bf16 v[148:151], v[248:251], v[136:139], v[148:151]
    v_mfma_f32_16x16x32_bf16 v[152:155], v[248:251], v[140:143], v[152:155]
    ds_read_b128 v[220:223], v244 offset:21760
    s_waitcnt lgkmcnt(0)
    v_mfma_f32_16x16x32_bf16 v[156:159], v[220:223], v[96:99], v[192:195]
    v_mfma_f32_16x16x32_bf16 v[160:163], v[220:223], v[100:103], v[196:199]
    v_mfma_f32_16x16x32_bf16 v[164:167], v[220:223], v[104:107], v[200:203]
    ds_read_b128 v[248:251], v244 offset:21824
    s_waitcnt lgkmcnt(0)
    v_mfma_f32_16x16x32_bf16 v[156:159], v[248:251], v[108:111], v[156:159]
    v_mfma_f32_16x16x32_bf16 v[160:163], v[248:251], v[112:115], v[160:163]
    v_mfma_f32_16x16x32_bf16 v[164:167], v[248:251], v[116:119], v[164:167]
    ds_read_b128 v[220:223], v244 offset:21888
    s_waitcnt lgkmcnt(0)
    v_mfma_f32_16x16x32_bf16 v[156:159], v[220:223], v[120:123], v[156:159]
    v_mfma_f32_16x16x32_bf16 v[160:163], v[220:223], v[124:127], v[160:163]
    v_mfma_f32_16x16x32_bf16 v[164:167], v[220:223], v[128:131], v[164:167]
    ds_read_b128 v[248:251], v244 offset:21952
    s_waitcnt lgkmcnt(0)
    v_mfma_f32_16x16x32_bf16 v[156:159], v[248:251], v[132:135], v[156:159]
    v_mfma_f32_16x16x32_bf16 v[160:163], v[248:251], v[136:139], v[160:163]
    v_mfma_f32_16x16x32_bf16 v[164:167], v[248:251], v[140:143], v[164:167]
    v_exp_f32 v144, v144
    v_exp_f32 v145, v145
    v_exp_f32 v146, v146
    v_exp_f32 v147, v147
    v_exp_f32 v148, v148
    v_exp_f32 v149, v149
    s_branch A_back1
A_rare2:
    s_waitcnt lgkmcnt(0)
    ds_read_b128 v[220:223], v244 offset:17408
    s_waitcnt lgkmcnt(0)
    v_mfma_f32_16x16x32_bf16 v[144:147], v[220:223], v[96:99], v[192:195]
    v_mfma_f32_16x16x32_bf16 v[148:151], v[220:223], v[100:103], v[196:199]
    v_mfma_f32_16x16x32_bf16 v[152:155], v[220:223], v[104:107], v[200:203]
    ds_read_b128 v[248:251], v244 offset:17472
    s_waitcnt lgkmcnt(0)
    v_mfma_f32_16x16x32_bf16 v[144:147], v[248:251], v[108:111], v[144:147]
    v_mfma_f32_16x16x32_bf16 v[148:151], v[248:251], v[112:115], v[148:151]
    v_mfma_f32_16x16x32_bf16 v[152:155], v[248:251], v[116:119], v[152:155]
    ds_read_b128 v[220:223], v244 offset:17536
    s_waitcnt lgkmcnt(0)
    v_mfma_f32_16x16x32_bf16 v[144:147], v[220:223], v[120:123], v[144:147]
    v_mfma_f32_16x16x32_bf16 v[148:151], v[220:223], v[124:127], v[148:151]
    v_mfma_f32_16x16x32_bf16 v[152:155], v[220:223], v[128:131], v[152:155]
    ds_read_b128 v[248:251], v244 offset:17600
    s_waitcnt lgkmcnt(0)
    v_mfma_f32_16x16x32_bf16 v[144:147], v[248:251], v[132:135], v[144:147]
    v_mfma_f32_16x16x32_bf16 v[148:151], v[248:251], v[136:139], v[148:151]
    v_mfma_f32_16x16x32_bf16 v[152:155], v[248:251], v[140:143], v[152:155]
    ds_read_b128 v[220:223], v244 offset:21760
    s_waitcnt lgkmcnt(0)
    v_mfma_f32_16x16x32_bf16 v[156:159], v[220:223], v[96:99], v[192:195]
    v_mfma_f32_16x16x32_bf16 v[160:163], v[220:223], v[100:103], v[196:199]
    v_mfma_f32_16x16x32_bf16 v[164:167], v[220:223], v[104:107], v[200:203]
    ds_read_b128 v[248:251], v244 offset:21824
    s_waitcnt lgkmcnt(0)
    v_mfma_f32_16x16x32_bf16 v[156:159], v[248:251], v[108:111], v[156:159]
    v_mfma_f32_16x16x32_bf16 v[160:163], v[248:251], v[112:115], v[160:163]
    v_mfma_f32_16x16x32_bf16 v[164:167], v[248:251], v[116:119], v[164:167]
    ds_read_b128 v[220:223], v244 offset:21888
    s_waitcnt lgkmcnt(0)
    v_mfma_f32_16x16x32_bf16 v[156:159], v[220:223], v[120:123], v[156:159]
    v_mfma_f32_16x16x32_bf16 v[160:163], v[220:223], v[124:127], v[160:163]
    v_mfma_f32_16x16x32_bf16 v[164:167], v[220:223], v[128:131], v[164:167]
    ds_read_b128 v[248:251], v244 offset:21952
    s_waitcnt lgkmcnt(0)
    v_mfma_f32_16x16x32_bf16 v[156:159], v[248:251], v[132:135], v[156:159]
    v_mfma_f32_16x16x32_bf16 v[160:163], v[248:251], v[136:139], v[160:163]
    v_mfma_f32_16x16x32_bf16 v[164:167], v[248:251], v[140:143], v[164:167]
    v_max3_f32 v180, v144, v145, v146
    s_nop 4
    v_max3_f32 v180, v180, v147, v156
    v_max3_f32 v180, v180, v157, v158
    v_max_f32 v180, v180, v159
    v_max3_f32 v182, v148, v149, v150
    v_max3_f32 v182, v182, v151, v160
    v_max3_f32 v182, v182, v161, v162
    v_max_f32 v182, v182, v163
    v_max3_f32 v184, v152, v153, v154
    v_max3_f32 v184, v184, v155, v164
    v_max3_f32 v184, v184, v165, v166
    v_max_f32 v184, v184, v167
    v_mov_b32 v181, v180
    v_mov_b32 v183, v182
    v_mov_b32 v185, v184
    v_permlane16_swap_b32 v180, v181
    v_permlane16_swap_b32 v182, v183
    v_permlane16_swap_b32 v184, v185
    v_max_f32 v180, v180, v181
    v_max_f32 v182, v182, v183
    v_max_f32 v184, v184, v185
    v_mov_b32 v181, v180
    v_mov_b32 v183, v182
    v_mov_b32 v185, v184
    v_permlane32_swap_b32 v180, v181
    v_permlane32_swap_b32 v182, v183
    v_permlane32_swap_b32 v184, v185
    v_max_f32 v180, v180, v181
    v_max_f32 v182, v182, v183
    v_max_f32 v184, v184, v185
    v_add_f32 v180, 0x41800000, v180
    v_max_f32 v180, 0, v180
    v_exp_f32 v181, -v180
    v_add_f32 v182, 0x41800000, v182
    v_max_f32 v182, 0, v182
    v_exp_f32 v183, -v182
    v_add_f32 v184, 0x41800000, v184
    v_max_f32 v184, 0, v184
    v_exp_f32 v185, -v184
    v_sub_f32 v192, v192, v180
    v_sub_f32 v193, v193, v180
    v_sub_f32 v194, v194, v180
    v_sub_f32 v195, v195, v180
    v_sub_f32 v144, v144, v180
    v_sub_f32 v145, v145, v180
    v_sub_f32 v146, v146, v180
    v_sub_f32 v147, v147, v180
    v_sub_f32 v156, v156, v180
    v_sub_f32 v157, v157, v180
    v_sub_f32 v158, v158, v180
    v_sub_f32 v159, v159, v180
    v_sub_f32 v196, v196, v182
    v_sub_f32 v197, v197, v182
    v_sub_f32 v198, v198, v182
    v_sub_f32 v199, v199, v182
    v_sub_f32 v148, v148, v182
    v_sub_f32 v149, v149, v182
    v_sub_f32 v150, v150, v182
    v_sub_f32 v151, v151, v182
    v_sub_f32 v160, v160, v182
    v_sub_f32 v161, v161, v182
    v_sub_f32 v162, v162, v182
    v_sub_f32 v163, v163, v182
    v_sub_f32 v200, v200, v184
    v_sub_f32 v201, v201, v184
    v_sub_f32 v202, v202, v184
    v_sub_f32 v203, v203, v184
    v_sub_f32 v152, v152, v184
    v_sub_f32 v153, v153, v184
    v_sub_f32 v154, v154, v184
    v_sub_f32 v155, v155, v184
    v_sub_f32 v164, v164, v184
    v_sub_f32 v165, v165, v184
    v_sub_f32 v166, v166, v184
    v_sub_f32 v167, v167, v184
    v_exp_f32 v144, v144
    v_exp_f32 v145, v145
    v_exp_f32 v146, v146
    v_exp_f32 v147, v147
    v_exp_f32 v148, v148
    v_exp_f32 v149, v149
    v_exp_f32 v150, v150
    v_exp_f32 v151, v151
    v_exp_f32 v152, v152
    v_exp_f32 v153, v153
    v_exp_f32 v154, v154
    v_exp_f32 v155, v155
    v_exp_f32 v156, v156
    v_exp_f32 v157, v157
    v_exp_f32 v158, v158
    v_exp_f32 v159, v159
    v_exp_f32 v160, v160
    v_exp_f32 v161, v161
    v_exp_f32 v162, v162
    v_exp_f32 v163, v163
    v_exp_f32 v164, v164
    v_exp_f32 v165, v165
    v_exp_f32 v166, v166
    v_exp_f32 v167, v167
    v_cvt_pk_bf16_f32 v168, v144, v145
    v_cvt_pk_bf16_f32 v169, v146, v147
    v_cvt_pk_bf16_f32 v172, v148, v149
    v_cvt_pk_bf16_f32 v173, v150, v151
    v_cvt_pk_bf16_f32 v176, v152, v153
    v_cvt_pk_bf16_f32 v177, v154, v155
    v_cvt_pk_bf16_f32 v170, v156, v157
    v_cvt_pk_bf16_f32 v171, v158, v159
    v_cvt_pk_bf16_f32 v174, v160, v161
    v_cvt_pk_bf16_f32 v175, v162, v163
    v_cvt_pk_bf16_f32 v178, v164, v165
    v_cvt_pk_bf16_f32 v179, v166, v167
    v_mul_f32 v204, v204, v181
    v_mul_f32 v205, v205, v181
    v_mul_f32 v206, v206, v181
    v_mul_f32 v207, v207, v181
    v_mul_f32 v0, v0, v181
    v_mul_f32 v1, v1, v181
    v_mul_f32 v2, v2, v181
    v_mul_f32 v3, v3, v181
    v_mul_f32 v12, v12, v181
    v_mul_f32 v13, v13, v181
    v_mul_f32 v14, v14, v181
    v_mul_f32 v15, v15, v181
    v_mul_f32 v24, v24, v181
    v_mul_f32 v25, v25, v181
    v_mul_f32 v26, v26, v181
    v_mul_f32 v27, v27, v181
    v_mul_f32 v36, v36, v181
    v_mul_f32 v37, v37, v181
    v_mul_f32 v38, v38, v181
    v_mul_f32 v39, v39, v181
    v_mul_f32 v48, v48, v181
    v_mul_f32 v49, v49, v181
    v_mul_f32 v50, v50, v181
    v_mul_f32 v51, v51, v181
    v_mul_f32 v60, v60, v181
    v_mul_f32 v61, v61, v181
    v_mul_f32 v62, v62, v181
    v_mul_f32 v63, v63, v181
    v_mul_f32 v72, v72, v181
    v_mul_f32 v73, v73, v181
    v_mul_f32 v74, v74, v181
    v_mul_f32 v75, v75, v181
    v_mul_f32 v84, v84, v181
    v_mul_f32 v85, v85, v181
    v_mul_f32 v86, v86, v181
    v_mul_f32 v87, v87, v181
    v_mul_f32 v208, v208, v183
    v_mul_f32 v209, v209, v183
    v_mul_f32 v210, v210, v183
    v_mul_f32 v211, v211, v183
    v_mul_f32 v4, v4, v183
    v_mul_f32 v5, v5, v183
    v_mul_f32 v6, v6, v183
    v_mul_f32 v7, v7, v183
    v_mul_f32 v16, v16, v183
    v_mul_f32 v17, v17, v183
    v_mul_f32 v18, v18, v183
    v_mul_f32 v19, v19, v183
    v_mul_f32 v28, v28, v183
    v_mul_f32 v29, v29, v183
    v_mul_f32 v30, v30, v183
    v_mul_f32 v31, v31, v183
    v_mul_f32 v40, v40, v183
    v_mul_f32 v41, v41, v183
    v_mul_f32 v42, v42, v183
    v_mul_f32 v43, v43, v183
    v_mul_f32 v52, v52, v183
    v_mul_f32 v53, v53, v183
    v_mul_f32 v54, v54, v183
    v_mul_f32 v55, v55, v183
    v_mul_f32 v64, v64, v183
    v_mul_f32 v65, v65, v183
    v_mul_f32 v66, v66, v183
    v_mul_f32 v67, v67, v183
    v_mul_f32 v76, v76, v183
    v_mul_f32 v77, v77, v183
    v_mul_f32 v78, v78, v183
    v_mul_f32 v79, v79, v183
    v_mul_f32 v88, v88, v183
    v_mul_f32 v89, v89, v183
    v_mul_f32 v90, v90, v183
    v_mul_f32 v91, v91, v183
    v_mul_f32 v212, v212, v185
    v_mul_f32 v213, v213, v185
    v_mul_f32 v214, v214, v185
    v_mul_f32 v215, v215, v185
    v_mul_f32 v8, v8, v185
    v_mul_f32 v9, v9, v185
    v_mul_f32 v10, v10, v185
    v_mul_f32 v11, v11, v185
    v_mul_f32 v20, v20, v185
    v_mul_f32 v21, v21, v185
    v_mul_f32 v22, v22, v185
    v_mul_f32 v23, v23, v185
    v_mul_f32 v32, v32, v185
    v_mul_f32 v33, v33, v185
    v_mul_f32 v34, v34, v185
    v_mul_f32 v35, v35, v185
    v_mul_f32 v44, v44, v185
    v_mul_f32 v45, v45, v185
    v_mul_f32 v46, v46, v185
    v_mul_f32 v47, v47, v185
    v_mul_f32 v56, v56, v185
    v_mul_f32 v57, v57, v185
    v_mul_f32 v58, v58, v185
    v_mul_f32 v59, v59, v185
    v_mul_f32 v68, v68, v185
    v_mul_f32 v69, v69, v185
    v_mul_f32 v70, v70, v185
    v_mul_f32 v71, v71, v185
    v_mul_f32 v80, v80, v185
    v_mul_f32 v81, v81, v185
    v_mul_f32 v82, v82, v185
    v_mul_f32 v83, v83, v185
    v_mul_f32 v92, v92, v185
    v_mul_f32 v93, v93, v185
    v_mul_f32 v94, v94, v185
    v_mul_f32 v95, v95, v185
    ds_read_b128 v[220:223], v244 offset:26112
    s_waitcnt lgkmcnt(0)
    v_mfma_f32_16x16x32_bf16 v[144:147], v[220:223], v[96:99], v[192:195]
    v_mfma_f32_16x16x32_bf16 v[148:151], v[220:223], v[100:103], v[196:199]
    v_mfma_f32_16x16x32_bf16 v[152:155], v[220:223], v[104:107], v[200:203]
    ds_read_b128 v[248:251], v244 offset:26176
    s_waitcnt lgkmcnt(0)
    v_mfma_f32_16x16x32_bf16 v[144:147], v[248:251], v[108:111], v[144:147]
    v_mfma_f32_16x16x32_bf16 v[148:151], v[248:251], v[112:115], v[148:151]
    v_mfma_f32_16x16x32_bf16 v[152:155], v[248:251], v[116:119], v[152:155]
    ds_read_b128 v[220:223], v244 offset:26240
    s_waitcnt lgkmcnt(0)
    v_mfma_f32_16x16x32_bf16 v[144:147], v[220:223], v[120:123], v[144:147]
    v_mfma_f32_16x16x32_bf16 v[148:151], v[220:223], v[124:127], v[148:151]
    v_mfma_f32_16x16x32_bf16 v[152:155], v[220:223], v[128:131], v[152:155]
    ds_read_b128 v[248:251], v244 offset:26304
    s_waitcnt lgkmcnt(0)
    v_mfma_f32_16x16x32_bf16 v[144:147], v[248:251], v[132:135], v[144:147]
    v_mfma_f32_16x16x32_bf16 v[148:151], v[248:251], v[136:139], v[148:151]
    v_mfma_f32_16x16x32_bf16 v[152:155], v[248:251], v[140:143], v[152:155]
    ds_read_b128 v[220:223], v244 offset:30464
    s_waitcnt lgkmcnt(0)
    v_mfma_f32_16x16x32_bf16 v[156:159], v[220:223], v[96:99], v[192:195]
    v_mfma_f32_16x16x32_bf16 v[160:163], v[220:223], v[100:103], v[196:199]
    v_mfma_f32_16x16x32_bf16 v[164:167], v[220:223], v[104:107], v[200:203]
    ds_read_b128 v[248:251], v244 offset:30528
    s_waitcnt lgkmcnt(0)
    v_mfma_f32_16x16x32_bf16 v[156:159], v[248:251], v[108:111], v[156:159]
    v_mfma_f32_16x16x32_bf16 v[160:163], v[248:251], v[112:115], v[160:163]
    v_mfma_f32_16x16x32_bf16 v[164:167], v[248:251], v[116:119], v[164:167]
    ds_read_b128 v[220:223], v244 offset:30592
    s_waitcnt lgkmcnt(0)
    v_mfma_f32_16x16x32_bf16 v[156:159], v[220:223], v[120:123], v[156:159]
    v_mfma_f32_16x16x32_bf16 v[160:163], v[220:223], v[124:127], v[160:163]
    v_mfma_f32_16x16x32_bf16 v[164:167], v[220:223], v[128:131], v[164:167]
    ds_read_b128 v[248:251], v244 offset:30656
    s_waitcnt lgkmcnt(0)
    v_mfma_f32_16x16x32_bf16 v[156:159], v[248:251], v[132:135], v[156:159]
    v_mfma_f32_16x16x32_bf16 v[160:163], v[248:251], v[136:139], v[160:163]
    v_mfma_f32_16x16x32_bf16 v[164:167], v[248:251], v[140:143], v[164:167]
    v_exp_f32 v144, v144
    v_exp_f32 v145, v145
    v_exp_f32 v146, v146
    v_exp_f32 v147, v147
    v_exp_f32 v148, v148
    v_exp_f32 v149, v149
    s_branch A_back2
A_rare3:
    s_waitcnt lgkmcnt(0)
    ds_read_b128 v[220:223], v244 offset:26112
    s_waitcnt lgkmcnt(0)
    v_mfma_f32_16x16x32_bf16 v[144:147], v[220:223], v[96:99], v[192:195]
    v_mfma_f32_16x16x32_bf16 v[148:151], v[220:223], v[100:103], v[196:199]
    v_mfma_f32_16x16x32_bf16 v[152:155], v[220:223], v[104:107], v[200:203]
    ds_read_b128 v[248:251], v244 offset:26176
    s_waitcnt lgkmcnt(0)
    v_mfma_f32_16x16x32_bf16 v[144:147], v[248:251], v[108:111], v[144:147]
    v_mfma_f32_16x16x32_bf16 v[148:151], v[248:251], v[112:115], v[148:151]
    v_mfma_f32_16x16x32_bf16 v[152:155], v[248:251], v[116:119], v[152:155]
    ds_read_b128 v[220:223], v244 offset:26240
    s_waitcnt lgkmcnt(0)
    v_mfma_f32_16x16x32_bf16 v[144:147], v[220:223], v[120:123], v[144:147]
    v_mfma_f32_16x16x32_bf16 v[148:151], v[220:223], v[124:127], v[148:151]
    v_mfma_f32_16x16x32_bf16 v[152:155], v[220:223], v[128:131], v[152:155]
    ds_read_b128 v[248:251], v244 offset:26304
    s_waitcnt lgkmcnt(0)
    v_mfma_f32_16x16x32_bf16 v[144:147], v[248:251], v[132:135], v[144:147]
    v_mfma_f32_16x16x32_bf16 v[148:151], v[248:251], v[136:139], v[148:151]
    v_mfma_f32_16x16x32_bf16 v[152:155], v[248:251], v[140:143], v[152:155]
    ds_read_b128 v[220:223], v244 offset:30464
    s_waitcnt lgkmcnt(0)
    v_mfma_f32_16x16x32_bf16 v[156:159], v[220:223], v[96:99], v[192:195]
    v_mfma_f32_16x16x32_bf16 v[160:163], v[220:223], v[100:103], v[196:199]
    v_mfma_f32_16x16x32_bf16 v[164:167], v[220:223], v[104:107], v[200:203]
    ds_read_b128 v[248:251], v244 offset:30528
    s_waitcnt lgkmcnt(0)
    v_mfma_f32_16x16x32_bf16 v[156:159], v[248:251], v[108:111], v[156:159]
    v_mfma_f32_16x16x32_bf16 v[160:163], v[248:251], v[112:115], v[160:163]
    v_mfma_f32_16x16x32_bf16 v[164:167], v[248:251], v[116:119], v[164:167]
    ds_read_b128 v[220:223], v244 offset:30592
    s_waitcnt lgkmcnt(0)
    v_mfma_f32_16x16x32_bf16 v[156:159], v[220:223], v[120:123], v[156:159]
    v_mfma_f32_16x16x32_bf16 v[160:163], v[220:223], v[124:127], v[160:163]
    v_mfma_f32_16x16x32_bf16 v[164:167], v[220:223], v[128:131], v[164:167]
    ds_read_b128 v[248:251], v244 offset:30656
    s_waitcnt lgkmcnt(0)
    v_mfma_f32_16x16x32_bf16 v[156:159], v[248:251], v[132:135], v[156:159]
    v_mfma_f32_16x16x32_bf16 v[160:163], v[248:251], v[136:139], v[160:163]
    v_mfma_f32_16x16x32_bf16 v[164:167], v[248:251], v[140:143], v[164:167]
    v_max3_f32 v168, v144, v145, v146
    s_nop 4
    v_max3_f32 v168, v168, v147, v156
    v_max3_f32 v168, v168, v157, v158
    v_max_f32 v168, v168, v159
    v_max3_f32 v170, v148, v149, v150
    v_max3_f32 v170, v170, v151, v160
    v_max3_f32 v170, v170, v161, v162
    v_max_f32 v170, v170, v163
    v_max3_f32 v172, v152, v153, v154
    v_max3_f32 v172, v172, v155, v164
    v_max3_f32 v172, v172, v165, v166
    v_max_f32 v172, v172, v167
    v_mov_b32 v169, v168
    v_mov_b32 v171, v170
    v_mov_b32 v173, v172
    v_permlane16_swap_b32 v168, v169
    v_permlane16_swap_b32 v170, v171
    v_permlane16_swap_b32 v172, v173
    v_max_f32 v168, v168, v169
    v_max_f32 v170, v170, v171
    v_max_f32 v172, v172, v173
    v_mov_b32 v169, v168
    v_mov_b32 v171, v170
    v_mov_b32 v173, v172
    v_permlane32_swap_b32 v168, v169
    v_permlane32_swap_b32 v170, v171
    v_permlane32_swap_b32 v172, v173
    v_max_f32 v168, v168, v169
    v_max_f32 v170, v170, v171
    v_max_f32 v172, v172, v173
    v_add_f32 v168, 0x41800000, v168
    v_max_f32 v168, 0, v168
    v_exp_f32 v169, -v168
    v_add_f32 v170, 0x41800000, v170
    v_max_f32 v170, 0, v170
    v_exp_f32 v171, -v170
    v_add_f32 v172, 0x41800000, v172
    v_max_f32 v172, 0, v172
    v_exp_f32 v173, -v172
    v_sub_f32 v192, v192, v168
    v_sub_f32 v193, v193, v168
    v_sub_f32 v194, v194, v168
    v_sub_f32 v195, v195, v168
    v_sub_f32 v144, v144, v168
    v_sub_f32 v145, v145, v168
    v_sub_f32 v146, v146, v168
    v_sub_f32 v147, v147, v168
    v_sub_f32 v156, v156, v168
    v_sub_f32 v157, v157, v168
    v_sub_f32 v158, v158, v168
    v_sub_f32 v159, v159, v168
    v_sub_f32 v196, v196, v170
    v_sub_f32 v197, v197, v170
    v_sub_f32 v198, v198, v170
    v_sub_f32 v199, v199, v170
    v_sub_f32 v148, v148, v170
    v_sub_f32 v149, v149, v170
    v_sub_f32 v150, v150, v170
    v_sub_f32 v151, v151, v170
    v_sub_f32 v160, v160, v170
    v_sub_f32 v161, v161, v170
    v_sub_f32 v162, v162, v170
    v_sub_f32 v163, v163, v170
    v_sub_f32 v200, v200, v172
    v_sub_f32 v201, v201, v172
    v_sub_f32 v202, v202, v172
    v_sub_f32 v203, v203, v172
    v_sub_f32 v152, v152, v172
    v_sub_f32 v153, v153, v172
    v_sub_f32 v154, v154, v172
    v_sub_f32 v155, v155, v172
    v_sub_f32 v164, v164, v172
    v_sub_f32 v165, v165, v172
    v_sub_f32 v166, v166, v172
    v_sub_f32 v167, v167, v172
    v_exp_f32 v144, v144
    v_exp_f32 v145, v145
    v_exp_f32 v146, v146
    v_exp_f32 v147, v147
    v_exp_f32 v148, v148
    v_exp_f32 v149, v149
    v_exp_f32 v150, v150
    v_exp_f32 v151, v151
    v_exp_f32 v152, v152
    v_exp_f32 v153, v153
    v_exp_f32 v154, v154
    v_exp_f32 v155, v155
    v_exp_f32 v156, v156
    v_exp_f32 v157, v157
    v_exp_f32 v158, v158
    v_exp_f32 v159, v159
    v_exp_f32 v160, v160
    v_exp_f32 v161, v161
    v_exp_f32 v162, v162
    v_exp_f32 v163, v163
    v_exp_f32 v164, v164
    v_exp_f32 v165, v165
    v_exp_f32 v166, v166
    v_exp_f32 v167, v167
    v_cvt_pk_bf16_f32 v180, v144, v145
    v_cvt_pk_bf16_f32 v181, v146, v147
    v_cvt_pk_bf16_f32 v184, v148, v149
    v_cvt_pk_bf16_f32 v185, v150, v151
    v_cvt_pk_bf16_f32 v188, v152, v153
    v_cvt_pk_bf16_f32 v189, v154, v155
    v_cvt_pk_bf16_f32 v182, v156, v157
    v_cvt_pk_bf16_f32 v183, v158, v159
    v_cvt_pk_bf16_f32 v186, v160, v161
    v_cvt_pk_bf16_f32 v187, v162, v163
    v_cvt_pk_bf16_f32 v190, v164, v165
    v_cvt_pk_bf16_f32 v191, v166, v167
    v_mul_f32 v204, v204, v169
    v_mul_f32 v205, v205, v169
    v_mul_f32 v206, v206, v169
    v_mul_f32 v207, v207, v169
    v_mul_f32 v0, v0, v169
    v_mul_f32 v1, v1, v169
    v_mul_f32 v2, v2, v169
    v_mul_f32 v3, v3, v169
    v_mul_f32 v12, v12, v169
    v_mul_f32 v13, v13, v169
    v_mul_f32 v14, v14, v169
    v_mul_f32 v15, v15, v169
    v_mul_f32 v24, v24, v169
    v_mul_f32 v25, v25, v169
    v_mul_f32 v26, v26, v169
    v_mul_f32 v27, v27, v169
    v_mul_f32 v36, v36, v169
    v_mul_f32 v37, v37, v169
    v_mul_f32 v38, v38, v169
    v_mul_f32 v39, v39, v169
    v_mul_f32 v48, v48, v169
    v_mul_f32 v49, v49, v169
    v_mul_f32 v50, v50, v169
    v_mul_f32 v51, v51, v169
    v_mul_f32 v60, v60, v169
    v_mul_f32 v61, v61, v169
    v_mul_f32 v62, v62, v169
    v_mul_f32 v63, v63, v169
    v_mul_f32 v72, v72, v169
    v_mul_f32 v73, v73, v169
    v_mul_f32 v74, v74, v169
    v_mul_f32 v75, v75, v169
    v_mul_f32 v84, v84, v169
    v_mul_f32 v85, v85, v169
    v_mul_f32 v86, v86, v169
    v_mul_f32 v87, v87, v169
    v_mul_f32 v208, v208, v171
    v_mul_f32 v209, v209, v171
    v_mul_f32 v210, v210, v171
    v_mul_f32 v211, v211, v171
    v_mul_f32 v4, v4, v171
    v_mul_f32 v5, v5, v171
    v_mul_f32 v6, v6, v171
    v_mul_f32 v7, v7, v171
    v_mul_f32 v16, v16, v171
    v_mul_f32 v17, v17, v171
    v_mul_f32 v18, v18, v171
    v_mul_f32 v19, v19, v171
    v_mul_f32 v28, v28, v171
    v_mul_f32 v29, v29, v171
    v_mul_f32 v30, v30, v171
    v_mul_f32 v31, v31, v171
    v_mul_f32 v40, v40, v171
    v_mul_f32 v41, v41, v171
    v_mul_f32 v42, v42, v171
    v_mul_f32 v43, v43, v171
    v_mul_f32 v52, v52, v171
    v_mul_f32 v53, v53, v171
    v_mul_f32 v54, v54, v171
    v_mul_f32 v55, v55, v171
    v_mul_f32 v64, v64, v171
    v_mul_f32 v65, v65, v171
    v_mul_f32 v66, v66, v171
    v_mul_f32 v67, v67, v171
    v_mul_f32 v76, v76, v171
    v_mul_f32 v77, v77, v171
    v_mul_f32 v78, v78, v171
    v_mul_f32 v79, v79, v171
    v_mul_f32 v88, v88, v171
    v_mul_f32 v89, v89, v171
    v_mul_f32 v90, v90, v171
    v_mul_f32 v91, v91, v171
    v_mul_f32 v212, v212, v173
    v_mul_f32 v213, v213, v173
    v_mul_f32 v214, v214, v173
    v_mul_f32 v215, v215, v173
    v_mul_f32 v8, v8, v173
    v_mul_f32 v9, v9, v173
    v_mul_f32 v10, v10, v173
    v_mul_f32 v11, v11, v173
    v_mul_f32 v20, v20, v173
    v_mul_f32 v21, v21, v173
    v_mul_f32 v22, v22, v173
    v_mul_f32 v23, v23, v173
    v_mul_f32 v32, v32, v173
    v_mul_f32 v33, v33, v173
    v_mul_f32 v34, v34, v173
    v_mul_f32 v35, v35, v173
    v_mul_f32 v44, v44, v173
    v_mul_f32 v45, v45, v173
    v_mul_f32 v46, v46, v173
    v_mul_f32 v47, v47, v173
    v_mul_f32 v56, v56, v173
    v_mul_f32 v57, v57, v173
    v_mul_f32 v58, v58, v173
    v_mul_f32 v59, v59, v173
    v_mul_f32 v68, v68, v173
    v_mul_f32 v69, v69, v173
    v_mul_f32 v70, v70, v173
    v_mul_f32 v71, v71, v173
    v_mul_f32 v80, v80, v173
    v_mul_f32 v81, v81, v173
    v_mul_f32 v82, v82, v173
    v_mul_f32 v83, v83, v173
    v_mul_f32 v92, v92, v173
    v_mul_f32 v93, v93, v173
    v_mul_f32 v94, v94, v173
    v_mul_f32 v95, v95, v173
    ds_read_b128 v[220:223], v244 offset:34816
    s_waitcnt lgkmcnt(0)
    v_mfma_f32_16x16x32_bf16 v[144:147], v[220:223], v[96:99], v[192:195]
    v_mfma_f32_16x16x32_bf16 v[148:151], v[220:223], v[100:103], v[196:199]
    v_mfma_f32_16x16x32_bf16 v[152:155], v[220:223], v[104:107], v[200:203]
    ds_read_b128 v[248:251], v244 offset:34880
    s_waitcnt lgkmcnt(0)
    v_mfma_f32_16x16x32_bf16 v[144:147], v[248:251], v[108:111], v[144:147]
    v_mfma_f32_16x16x32_bf16 v[148:151], v[248:251], v[112:115], v[148:151]
    v_mfma_f32_16x16x32_bf16 v[152:155], v[248:251], v[116:119], v[152:155]
    ds_read_b128 v[220:223], v244 offset:34944
    s_waitcnt lgkmcnt(0)
    v_mfma_f32_16x16x32_bf16 v[144:147], v[220:223], v[120:123], v[144:147]
    v_mfma_f32_16x16x32_bf16 v[148:151], v[220:223], v[124:127], v[148:151]
    v_mfma_f32_16x16x32_bf16 v[152:155], v[220:223], v[128:131], v[152:155]
    ds_read_b128 v[248:251], v244 offset:35008
    s_waitcnt lgkmcnt(0)
    v_mfma_f32_16x16x32_bf16 v[144:147], v[248:251], v[132:135], v[144:147]
    v_mfma_f32_16x16x32_bf16 v[148:151], v[248:251], v[136:139], v[148:151]
    v_mfma_f32_16x16x32_bf16 v[152:155], v[248:251], v[140:143], v[152:155]
    ds_read_b128 v[220:223], v244 offset:39168
    s_waitcnt lgkmcnt(0)
    v_mfma_f32_16x16x32_bf16 v[156:159], v[220:223], v[96:99], v[192:195]
    v_mfma_f32_16x16x32_bf16 v[160:163], v[220:223], v[100:103], v[196:199]
    v_mfma_f32_16x16x32_bf16 v[164:167], v[220:223], v[104:107], v[200:203]
    ds_read_b128 v[248:251], v244 offset:39232
    s_waitcnt lgkmcnt(0)
    v_mfma_f32_16x16x32_bf16 v[156:159], v[248:251], v[108:111], v[156:159]
    v_mfma_f32_16x16x32_bf16 v[160:163], v[248:251], v[112:115], v[160:163]
    v_mfma_f32_16x16x32_bf16 v[164:167], v[248:251], v[116:119], v[164:167]
    ds_read_b128 v[220:223], v244 offset:39296
    s_waitcnt lgkmcnt(0)
    v_mfma_f32_16x16x32_bf16 v[156:159], v[220:223], v[120:123], v[156:159]
    v_mfma_f32_16x16x32_bf16 v[160:163], v[220:223], v[124:127], v[160:163]
    v_mfma_f32_16x16x32_bf16 v[164:167], v[220:223], v[128:131], v[164:167]
    ds_read_b128 v[248:251], v244 offset:39360
    s_waitcnt lgkmcnt(0)
    v_mfma_f32_16x16x32_bf16 v[156:159], v[248:251], v[132:135], v[156:159]
    v_mfma_f32_16x16x32_bf16 v[160:163], v[248:251], v[136:139], v[160:163]
    v_mfma_f32_16x16x32_bf16 v[164:167], v[248:251], v[140:143], v[164:167]
    v_exp_f32 v144, v144
    v_exp_f32 v145, v145
    v_exp_f32 v146, v146
    v_exp_f32 v147, v147
    v_exp_f32 v148, v148
    v_exp_f32 v149, v149
    s_branch A_back3
A_rare4:
    s_waitcnt lgkmcnt(0)
    ds_read_b128 v[220:223], v244 offset:34816
    s_waitcnt lgkmcnt(0)
    v_mfma_f32_16x16x32_bf16 v[144:147], v[220:223], v[96:99], v[192:195]
    v_mfma_f32_16x16x32_bf16 v[148:151], v[220:223], v[100:103], v[196:199]
    v_mfma_f32_16x16x32_bf16 v[152:155], v[220:223], v[104:107], v[200:203]
    ds_read_b128 v[248:251], v244 offset:34880
    s_waitcnt lgkmcnt(0)
    v_mfma_f32_16x16x32_bf16 v[144:147], v[248:251], v[108:111], v[144:147]
    v_mfma_f32_16x16x32_bf16 v[148:151], v[248:251], v[112:115], v[148:151]
    v_mfma_f32_16x16x32_bf16 v[152:155], v[248:251], v[116:119], v[152:155]
    ds_read_b128 v[220:223], v244 offset:34944
    s_waitcnt lgkmcnt(0)
    v_mfma_f32_16x16x32_bf16 v[144:147], v[220:223], v[120:123], v[144:147]
    v_mfma_f32_16x16x32_bf16 v[148:151], v[220:223], v[124:127], v[148:151]
    v_mfma_f32_16x16x32_bf16 v[152:155], v[220:223], v[128:131], v[152:155]
    ds_read_b128 v[248:251], v244 offset:35008
    s_waitcnt lgkmcnt(0)
    v_mfma_f32_16x16x32_bf16 v[144:147], v[248:251], v[132:135], v[144:147]
    v_mfma_f32_16x16x32_bf16 v[148:151], v[248:251], v[136:139], v[148:151]
    v_mfma_f32_16x16x32_bf16 v[152:155], v[248:251], v[140:143], v[152:155]
    ds_read_b128 v[220:223], v244 offset:39168
    s_waitcnt lgkmcnt(0)
    v_mfma_f32_16x16x32_bf16 v[156:159], v[220:223], v[96:99], v[192:195]
    v_mfma_f32_16x16x32_bf16 v[160:163], v[220:223], v[100:103], v[196:199]
    v_mfma_f32_16x16x32_bf16 v[164:167], v[220:223], v[104:107], v[200:203]
    ds_read_b128 v[248:251], v244 offset:39232
    s_waitcnt lgkmcnt(0)
    v_mfma_f32_16x16x32_bf16 v[156:159], v[248:251], v[108:111], v[156:159]
    v_mfma_f32_16x16x32_bf16 v[160:163], v[248:251], v[112:115], v[160:163]
    v_mfma_f32_16x16x32_bf16 v[164:167], v[248:251], v[116:119], v[164:167]
    ds_read_b128 v[220:223], v244 offset:39296
    s_waitcnt lgkmcnt(0)
    v_mfma_f32_16x16x32_bf16 v[156:159], v[220:223], v[120:123], v[156:159]
    v_mfma_f32_16x16x32_bf16 v[160:163], v[220:223], v[124:127], v[160:163]
    v_mfma_f32_16x16x32_bf16 v[164:167], v[220:223], v[128:131], v[164:167]
    ds_read_b128 v[248:251], v244 offset:39360
    s_waitcnt lgkmcnt(0)
    v_mfma_f32_16x16x32_bf16 v[156:159], v[248:251], v[132:135], v[156:159]
    v_mfma_f32_16x16x32_bf16 v[160:163], v[248:251], v[136:139], v[160:163]
    v_mfma_f32_16x16x32_bf16 v[164:167], v[248:251], v[140:143], v[164:167]
    v_max3_f32 v180, v144, v145, v146
    s_nop 4
    v_max3_f32 v180, v180, v147, v156
    v_max3_f32 v180, v180, v157, v158
    v_max_f32 v180, v180, v159
    v_max3_f32 v182, v148, v149, v150
    v_max3_f32 v182, v182, v151, v160
    v_max3_f32 v182, v182, v161, v162
    v_max_f32 v182, v182, v163
    v_max3_f32 v184, v152, v153, v154
    v_max3_f32 v184, v184, v155, v164
    v_max3_f32 v184, v184, v165, v166
    v_max_f32 v184, v184, v167
    v_mov_b32 v181, v180
    v_mov_b32 v183, v182
    v_mov_b32 v185, v184
    v_permlane16_swap_b32 v180, v181
    v_permlane16_swap_b32 v182, v183
    v_permlane16_swap_b32 v184, v185
    v_max_f32 v180, v180, v181
    v_max_f32 v182, v182, v183
    v_max_f32 v184, v184, v185
    v_mov_b32 v181, v180
    v_mov_b32 v183, v182
    v_mov_b32 v185, v184
    v_permlane32_swap_b32 v180, v181
    v_permlane32_swap_b32 v182, v183
    v_permlane32_swap_b32 v184, v185
    v_max_f32 v180, v180, v181
    v_max_f32 v182, v182, v183
    v_max_f32 v184, v184, v185
    v_add_f32 v180, 0x41800000, v180
    v_max_f32 v180, 0, v180
    v_exp_f32 v181, -v180
    v_add_f32 v182, 0x41800000, v182
    v_max_f32 v182, 0, v182
    v_exp_f32 v183, -v182
    v_add_f32 v184, 0x41800000, v184
    v_max_f32 v184, 0, v184
    v_exp_f32 v185, -v184
    v_sub_f32 v192, v192, v180
    v_sub_f32 v193, v193, v180
    v_sub_f32 v194, v194, v180
    v_sub_f32 v195, v195, v180
    v_sub_f32 v144, v144, v180
    v_sub_f32 v145, v145, v180
    v_sub_f32 v146, v146, v180
    v_sub_f32 v147, v147, v180
    v_sub_f32 v156, v156, v180
    v_sub_f32 v157, v157, v180
    v_sub_f32 v158, v158, v180
    v_sub_f32 v159, v159, v180
    v_sub_f32 v196, v196, v182
    v_sub_f32 v197, v197, v182
    v_sub_f32 v198, v198, v182
    v_sub_f32 v199, v199, v182
    v_sub_f32 v148, v148, v182
    v_sub_f32 v149, v149, v182
    v_sub_f32 v150, v150, v182
    v_sub_f32 v151, v151, v182
    v_sub_f32 v160, v160, v182
    v_sub_f32 v161, v161, v182
    v_sub_f32 v162, v162, v182
    v_sub_f32 v163, v163, v182
    v_sub_f32 v200, v200, v184
    v_sub_f32 v201, v201, v184
    v_sub_f32 v202, v202, v184
    v_sub_f32 v203, v203, v184
    v_sub_f32 v152, v152, v184
    v_sub_f32 v153, v153, v184
    v_sub_f32 v154, v154, v184
    v_sub_f32 v155, v155, v184
    v_sub_f32 v164, v164, v184
    v_sub_f32 v165, v165, v184
    v_sub_f32 v166, v166, v184
    v_sub_f32 v167, v167, v184
    v_exp_f32 v144, v144
    v_exp_f32 v145, v145
    v_exp_f32 v146, v146
    v_exp_f32 v147, v147
    v_exp_f32 v148, v148
    v_exp_f32 v149, v149
    v_exp_f32 v150, v150
    v_exp_f32 v151, v151
    v_exp_f32 v152, v152
    v_exp_f32 v153, v153
    v_exp_f32 v154, v154
    v_exp_f32 v155, v155
    v_exp_f32 v156, v156
    v_exp_f32 v157, v157
    v_exp_f32 v158, v158
    v_exp_f32 v159, v159
    v_exp_f32 v160, v160
    v_exp_f32 v161, v161
    v_exp_f32 v162, v162
    v_exp_f32 v163, v163
    v_exp_f32 v164, v164
    v_exp_f32 v165, v165
    v_exp_f32 v166, v166
    v_exp_f32 v167, v167
    v_cvt_pk_bf16_f32 v168, v144, v145
    v_cvt_pk_bf16_f32 v169, v146, v147
    v_cvt_pk_bf16_f32 v172, v148, v149
    v_cvt_pk_bf16_f32 v173, v150, v151
    v_cvt_pk_bf16_f32 v176, v152, v153
    v_cvt_pk_bf16_f32 v177, v154, v155
    v_cvt_pk_bf16_f32 v170, v156, v157
    v_cvt_pk_bf16_f32 v171, v158, v159
    v_cvt_pk_bf16_f32 v174, v160, v161
    v_cvt_pk_bf16_f32 v175, v162, v163
    v_cvt_pk_bf16_f32 v178, v164, v165
    v_cvt_pk_bf16_f32 v179, v166, v167
    v_mul_f32 v204, v204, v181
    v_mul_f32 v205, v205, v181
    v_mul_f32 v206, v206, v181
    v_mul_f32 v207, v207, v181
    v_mul_f32 v0, v0, v181
    v_mul_f32 v1, v1, v181
    v_mul_f32 v2, v2, v181
    v_mul_f32 v3, v3, v181
    v_mul_f32 v12, v12, v181
    v_mul_f32 v13, v13, v181
    v_mul_f32 v14, v14, v181
    v_mul_f32 v15, v15, v181
    v_mul_f32 v24, v24, v181
    v_mul_f32 v25, v25, v181
    v_mul_f32 v26, v26, v181
    v_mul_f32 v27, v27, v181
    v_mul_f32 v36, v36, v181
    v_mul_f32 v37, v37, v181
    v_mul_f32 v38, v38, v181
    v_mul_f32 v39, v39, v181
    v_mul_f32 v48, v48, v181
    v_mul_f32 v49, v49, v181
    v_mul_f32 v50, v50, v181
    v_mul_f32 v51, v51, v181
    v_mul_f32 v60, v60, v181
    v_mul_f32 v61, v61, v181
    v_mul_f32 v62, v62, v181
    v_mul_f32 v63, v63, v181
    v_mul_f32 v72, v72, v181
    v_mul_f32 v73, v73, v181
    v_mul_f32 v74, v74, v181
    v_mul_f32 v75, v75, v181
    v_mul_f32 v84, v84, v181
    v_mul_f32 v85, v85, v181
    v_mul_f32 v86, v86, v181
    v_mul_f32 v87, v87, v181
    v_mul_f32 v208, v208, v183
    v_mul_f32 v209, v209, v183
    v_mul_f32 v210, v210, v183
    v_mul_f32 v211, v211, v183
    v_mul_f32 v4, v4, v183
    v_mul_f32 v5, v5, v183
    v_mul_f32 v6, v6, v183
    v_mul_f32 v7, v7, v183
    v_mul_f32 v16, v16, v183
    v_mul_f32 v17, v17, v183
    v_mul_f32 v18, v18, v183
    v_mul_f32 v19, v19, v183
    v_mul_f32 v28, v28, v183
    v_mul_f32 v29, v29, v183
    v_mul_f32 v30, v30, v183
    v_mul_f32 v31, v31, v183
    v_mul_f32 v40, v40, v183
    v_mul_f32 v41, v41, v183
    v_mul_f32 v42, v42, v183
    v_mul_f32 v43, v43, v183
    v_mul_f32 v52, v52, v183
    v_mul_f32 v53, v53, v183
    v_mul_f32 v54, v54, v183
    v_mul_f32 v55, v55, v183
    v_mul_f32 v64, v64, v183
    v_mul_f32 v65, v65, v183
    v_mul_f32 v66, v66, v183
    v_mul_f32 v67, v67, v183
    v_mul_f32 v76, v76, v183
    v_mul_f32 v77, v77, v183
    v_mul_f32 v78, v78, v183
    v_mul_f32 v79, v79, v183
    v_mul_f32 v88, v88, v183
    v_mul_f32 v89, v89, v183
    v_mul_f32 v90, v90, v183
    v_mul_f32 v91, v91, v183
    v_mul_f32 v212, v212, v185
    v_mul_f32 v213, v213, v185
    v_mul_f32 v214, v214, v185
    v_mul_f32 v215, v215, v185
    v_mul_f32 v8, v8, v185
    v_mul_f32 v9, v9, v185
    v_mul_f32 v10, v10, v185
    v_mul_f32 v11, v11, v185
    v_mul_f32 v20, v20, v185
    v_mul_f32 v21, v21, v185
    v_mul_f32 v22, v22, v185
    v_mul_f32 v23, v23, v185
    v_mul_f32 v32, v32, v185
    v_mul_f32 v33, v33, v185
    v_mul_f32 v34, v34, v185
    v_mul_f32 v35, v35, v185
    v_mul_f32 v44, v44, v185
    v_mul_f32 v45, v45, v185
    v_mul_f32 v46, v46, v185
    v_mul_f32 v47, v47, v185
    v_mul_f32 v56, v56, v185
    v_mul_f32 v57, v57, v185
    v_mul_f32 v58, v58, v185
    v_mul_f32 v59, v59, v185
    v_mul_f32 v68, v68, v185
    v_mul_f32 v69, v69, v185
    v_mul_f32 v70, v70, v185
    v_mul_f32 v71, v71, v185
    v_mul_f32 v80, v80, v185
    v_mul_f32 v81, v81, v185
    v_mul_f32 v82, v82, v185
    v_mul_f32 v83, v83, v185
    v_mul_f32 v92, v92, v185
    v_mul_f32 v93, v93, v185
    v_mul_f32 v94, v94, v185
    v_mul_f32 v95, v95, v185
    ds_read_b128 v[220:223], v244 offset:43520
    s_waitcnt lgkmcnt(0)
    v_mfma_f32_16x16x32_bf16 v[144:147], v[220:223], v[96:99], v[192:195]
    v_mfma_f32_16x16x32_bf16 v[148:151], v[220:223], v[100:103], v[196:199]
    v_mfma_f32_16x16x32_bf16 v[152:155], v[220:223], v[104:107], v[200:203]
    ds_read_b128 v[248:251], v244 offset:43584
    s_waitcnt lgkmcnt(0)
    v_mfma_f32_16x16x32_bf16 v[144:147], v[248:251], v[108:111], v[144:147]
    v_mfma_f32_16x16x32_bf16 v[148:151], v[248:251], v[112:115], v[148:151]
    v_mfma_f32_16x16x32_bf16 v[152:155], v[248:251], v[116:119], v[152:155]
    ds_read_b128 v[220:223], v244 offset:43648
    s_waitcnt lgkmcnt(0)
    v_mfma_f32_16x16x32_bf16 v[144:147], v[220:223], v[120:123], v[144:147]
    v_mfma_f32_16x16x32_bf16 v[148:151], v[220:223], v[124:127], v[148:151]
    v_mfma_f32_16x16x32_bf16 v[152:155], v[220:223], v[128:131], v[152:155]
    ds_read_b128 v[248:251], v244 offset:43712
    s_waitcnt lgkmcnt(0)
    v_mfma_f32_16x16x32_bf16 v[144:147], v[248:251], v[132:135], v[144:147]
    v_mfma_f32_16x16x32_bf16 v[148:151], v[248:251], v[136:139], v[148:151]
    v_mfma_f32_16x16x32_bf16 v[152:155], v[248:251], v[140:143], v[152:155]
    ds_read_b128 v[220:223], v244 offset:47872
    s_waitcnt lgkmcnt(0)
    v_mfma_f32_16x16x32_bf16 v[156:159], v[220:223], v[96:99], v[192:195]
    v_mfma_f32_16x16x32_bf16 v[160:163], v[220:223], v[100:103], v[196:199]
    v_mfma_f32_16x16x32_bf16 v[164:167], v[220:223], v[104:107], v[200:203]
    ds_read_b128 v[248:251], v244 offset:47936
    s_waitcnt lgkmcnt(0)
    v_mfma_f32_16x16x32_bf16 v[156:159], v[248:251], v[108:111], v[156:159]
    v_mfma_f32_16x16x32_bf16 v[160:163], v[248:251], v[112:115], v[160:163]
    v_mfma_f32_16x16x32_bf16 v[164:167], v[248:251], v[116:119], v[164:167]
    ds_read_b128 v[220:223], v244 offset:48000
    s_waitcnt lgkmcnt(0)
    v_mfma_f32_16x16x32_bf16 v[156:159], v[220:223], v[120:123], v[156:159]
    v_mfma_f32_16x16x32_bf16 v[160:163], v[220:223], v[124:127], v[160:163]
    v_mfma_f32_16x16x32_bf16 v[164:167], v[220:223], v[128:131], v[164:167]
    ds_read_b128 v[248:251], v244 offset:48064
    s_waitcnt lgkmcnt(0)
    v_mfma_f32_16x16x32_bf16 v[156:159], v[248:251], v[132:135], v[156:159]
    v_mfma_f32_16x16x32_bf16 v[160:163], v[248:251], v[136:139], v[160:163]
    v_mfma_f32_16x16x32_bf16 v[164:167], v[248:251], v[140:143], v[164:167]
    v_exp_f32 v144, v144
    v_exp_f32 v145, v145
    v_exp_f32 v146, v146
    v_exp_f32 v147, v147
    v_exp_f32 v148, v148
    v_exp_f32 v149, v149
    s_branch A_back4
A_rare5:
    s_waitcnt lgkmcnt(0)
    ds_read_b128 v[220:223], v244 offset:43520
    s_waitcnt lgkmcnt(0)
    v_mfma_f32_16x16x32_bf16 v[144:147], v[220:223], v[96:99], v[192:195]
    v_mfma_f32_16x16x32_bf16 v[148:151], v[220:223], v[100:103], v[196:199]
    v_mfma_f32_16x16x32_bf16 v[152:155], v[220:223], v[104:107], v[200:203]
    ds_read_b128 v[248:251], v244 offset:43584
    s_waitcnt lgkmcnt(0)
    v_mfma_f32_16x16x32_bf16 v[144:147], v[248:251], v[108:111], v[144:147]
    v_mfma_f32_16x16x32_bf16 v[148:151], v[248:251], v[112:115], v[148:151]
    v_mfma_f32_16x16x32_bf16 v[152:155], v[248:251], v[116:119], v[152:155]
    ds_read_b128 v[220:223], v244 offset:43648
    s_waitcnt lgkmcnt(0)
    v_mfma_f32_16x16x32_bf16 v[144:147], v[220:223], v[120:123], v[144:147]
    v_mfma_f32_16x16x32_bf16 v[148:151], v[220:223], v[124:127], v[148:151]
    v_mfma_f32_16x16x32_bf16 v[152:155], v[220:223], v[128:131], v[152:155]
    ds_read_b128 v[248:251], v244 offset:43712
    s_waitcnt lgkmcnt(0)
    v_mfma_f32_16x16x32_bf16 v[144:147], v[248:251], v[132:135], v[144:147]
    v_mfma_f32_16x16x32_bf16 v[148:151], v[248:251], v[136:139], v[148:151]
    v_mfma_f32_16x16x32_bf16 v[152:155], v[248:251], v[140:143], v[152:155]
    ds_read_b128 v[220:223], v244 offset:47872
    s_waitcnt lgkmcnt(0)
    v_mfma_f32_16x16x32_bf16 v[156:159], v[220:223], v[96:99], v[192:195]
    v_mfma_f32_16x16x32_bf16 v[160:163], v[220:223], v[100:103], v[196:199]
    v_mfma_f32_16x16x32_bf16 v[164:167], v[220:223], v[104:107], v[200:203]
    ds_read_b128 v[248:251], v244 offset:47936
    s_waitcnt lgkmcnt(0)
    v_mfma_f32_16x16x32_bf16 v[156:159], v[248:251], v[108:111], v[156:159]
    v_mfma_f32_16x16x32_bf16 v[160:163], v[248:251], v[112:115], v[160:163]
    v_mfma_f32_16x16x32_bf16 v[164:167], v[248:251], v[116:119], v[164:167]
    ds_read_b128 v[220:223], v244 offset:48000
    s_waitcnt lgkmcnt(0)
    v_mfma_f32_16x16x32_bf16 v[156:159], v[220:223], v[120:123], v[156:159]
    v_mfma_f32_16x16x32_bf16 v[160:163], v[220:223], v[124:127], v[160:163]
    v_mfma_f32_16x16x32_bf16 v[164:167], v[220:223], v[128:131], v[164:167]
    ds_read_b128 v[248:251], v244 offset:48064
    s_waitcnt lgkmcnt(0)
    v_mfma_f32_16x16x32_bf16 v[156:159], v[248:251], v[132:135], v[156:159]
    v_mfma_f32_16x16x32_bf16 v[160:163], v[248:251], v[136:139], v[160:163]
    v_mfma_f32_16x16x32_bf16 v[164:167], v[248:251], v[140:143], v[164:167]
    v_max3_f32 v168, v144, v145, v146
    s_nop 4
    v_max3_f32 v168, v168, v147, v156
    v_max3_f32 v168, v168, v157, v158
    v_max_f32 v168, v168, v159
    v_max3_f32 v170, v148, v149, v150
    v_max3_f32 v170, v170, v151, v160
    v_max3_f32 v170, v170, v161, v162
    v_max_f32 v170, v170, v163
    v_max3_f32 v172, v152, v153, v154
    v_max3_f32 v172, v172, v155, v164
    v_max3_f32 v172, v172, v165, v166
    v_max_f32 v172, v172, v167
    v_mov_b32 v169, v168
    v_mov_b32 v171, v170
    v_mov_b32 v173, v172
    v_permlane16_swap_b32 v168, v169
    v_permlane16_swap_b32 v170, v171
    v_permlane16_swap_b32 v172, v173
    v_max_f32 v168, v168, v169
    v_max_f32 v170, v170, v171
    v_max_f32 v172, v172, v173
    v_mov_b32 v169, v168
    v_mov_b32 v171, v170
    v_mov_b32 v173, v172
    v_permlane32_swap_b32 v168, v169
    v_permlane32_swap_b32 v170, v171
    v_permlane32_swap_b32 v172, v173
    v_max_f32 v168, v168, v169
    v_max_f32 v170, v170, v171
    v_max_f32 v172, v172, v173
    v_add_f32 v168, 0x41800000, v168
    v_max_f32 v168, 0, v168
    v_exp_f32 v169, -v168
    v_add_f32 v170, 0x41800000, v170
    v_max_f32 v170, 0, v170
    v_exp_f32 v171, -v170
    v_add_f32 v172, 0x41800000, v172
    v_max_f32 v172, 0, v172
    v_exp_f32 v173, -v172
    v_sub_f32 v192, v192, v168
    v_sub_f32 v193, v193, v168
    v_sub_f32 v194, v194, v168
    v_sub_f32 v195, v195, v168
    v_sub_f32 v144, v144, v168
    v_sub_f32 v145, v145, v168
    v_sub_f32 v146, v146, v168
    v_sub_f32 v147, v147, v168
    v_sub_f32 v156, v156, v168
    v_sub_f32 v157, v157, v168
    v_sub_f32 v158, v158, v168
    v_sub_f32 v159, v159, v168
    v_sub_f32 v196, v196, v170
    v_sub_f32 v197, v197, v170
    v_sub_f32 v198, v198, v170
    v_sub_f32 v199, v199, v170
    v_sub_f32 v148, v148, v170
    v_sub_f32 v149, v149, v170
    v_sub_f32 v150, v150, v170
    v_sub_f32 v151, v151, v170
    v_sub_f32 v160, v160, v170
    v_sub_f32 v161, v161, v170
    v_sub_f32 v162, v162, v170
    v_sub_f32 v163, v163, v170
    v_sub_f32 v200, v200, v172
    v_sub_f32 v201, v201, v172
    v_sub_f32 v202, v202, v172
    v_sub_f32 v203, v203, v172
    v_sub_f32 v152, v152, v172
    v_sub_f32 v153, v153, v172
    v_sub_f32 v154, v154, v172
    v_sub_f32 v155, v155, v172
    v_sub_f32 v164, v164, v172
    v_sub_f32 v165, v165, v172
    v_sub_f32 v166, v166, v172
    v_sub_f32 v167, v167, v172
    v_exp_f32 v144, v144
    v_exp_f32 v145, v145
    v_exp_f32 v146, v146
    v_exp_f32 v147, v147
    v_exp_f32 v148, v148
    v_exp_f32 v149, v149
    v_exp_f32 v150, v150
    v_exp_f32 v151, v151
    v_exp_f32 v152, v152
    v_exp_f32 v153, v153
    v_exp_f32 v154, v154
    v_exp_f32 v155, v155
    v_exp_f32 v156, v156
    v_exp_f32 v157, v157
    v_exp_f32 v158, v158
    v_exp_f32 v159, v159
    v_exp_f32 v160, v160
    v_exp_f32 v161, v161
    v_exp_f32 v162, v162
    v_exp_f32 v163, v163
    v_exp_f32 v164, v164
    v_exp_f32 v165, v165
    v_exp_f32 v166, v166
    v_exp_f32 v167, v167
    v_cvt_pk_bf16_f32 v180, v144, v145
    v_cvt_pk_bf16_f32 v181, v146, v147
    v_cvt_pk_bf16_f32 v184, v148, v149
    v_cvt_pk_bf16_f32 v185, v150, v151
    v_cvt_pk_bf16_f32 v188, v152, v153
    v_cvt_pk_bf16_f32 v189, v154, v155
    v_cvt_pk_bf16_f32 v182, v156, v157
    v_cvt_pk_bf16_f32 v183, v158, v159
    v_cvt_pk_bf16_f32 v186, v160, v161
    v_cvt_pk_bf16_f32 v187, v162, v163
    v_cvt_pk_bf16_f32 v190, v164, v165
    v_cvt_pk_bf16_f32 v191, v166, v167
    v_mul_f32 v204, v204, v169
    v_mul_f32 v205, v205, v169
    v_mul_f32 v206, v206, v169
    v_mul_f32 v207, v207, v169
    v_mul_f32 v0, v0, v169
    v_mul_f32 v1, v1, v169
    v_mul_f32 v2, v2, v169
    v_mul_f32 v3, v3, v169
    v_mul_f32 v12, v12, v169
    v_mul_f32 v13, v13, v169
    v_mul_f32 v14, v14, v169
    v_mul_f32 v15, v15, v169
    v_mul_f32 v24, v24, v169
    v_mul_f32 v25, v25, v169
    v_mul_f32 v26, v26, v169
    v_mul_f32 v27, v27, v169
    v_mul_f32 v36, v36, v169
    v_mul_f32 v37, v37, v169
    v_mul_f32 v38, v38, v169
    v_mul_f32 v39, v39, v169
    v_mul_f32 v48, v48, v169
    v_mul_f32 v49, v49, v169
    v_mul_f32 v50, v50, v169
    v_mul_f32 v51, v51, v169
    v_mul_f32 v60, v60, v169
    v_mul_f32 v61, v61, v169
    v_mul_f32 v62, v62, v169
    v_mul_f32 v63, v63, v169
    v_mul_f32 v72, v72, v169
    v_mul_f32 v73, v73, v169
    v_mul_f32 v74, v74, v169
    v_mul_f32 v75, v75, v169
    v_mul_f32 v84, v84, v169
    v_mul_f32 v85, v85, v169
    v_mul_f32 v86, v86, v169
    v_mul_f32 v87, v87, v169
    v_mul_f32 v208, v208, v171
    v_mul_f32 v209, v209, v171
    v_mul_f32 v210, v210, v171
    v_mul_f32 v211, v211, v171
    v_mul_f32 v4, v4, v171
    v_mul_f32 v5, v5, v171
    v_mul_f32 v6, v6, v171
    v_mul_f32 v7, v7, v171
    v_mul_f32 v16, v16, v171
    v_mul_f32 v17, v17, v171
    v_mul_f32 v18, v18, v171
    v_mul_f32 v19, v19, v171
    v_mul_f32 v28, v28, v171
    v_mul_f32 v29, v29, v171
    v_mul_f32 v30, v30, v171
    v_mul_f32 v31, v31, v171
    v_mul_f32 v40, v40, v171
    v_mul_f32 v41, v41, v171
    v_mul_f32 v42, v42, v171
    v_mul_f32 v43, v43, v171
    v_mul_f32 v52, v52, v171
    v_mul_f32 v53, v53, v171
    v_mul_f32 v54, v54, v171
    v_mul_f32 v55, v55, v171
    v_mul_f32 v64, v64, v171
    v_mul_f32 v65, v65, v171
    v_mul_f32 v66, v66, v171
    v_mul_f32 v67, v67, v171
    v_mul_f32 v76, v76, v171
    v_mul_f32 v77, v77, v171
    v_mul_f32 v78, v78, v171
    v_mul_f32 v79, v79, v171
    v_mul_f32 v88, v88, v171
    v_mul_f32 v89, v89, v171
    v_mul_f32 v90, v90, v171
    v_mul_f32 v91, v91, v171
    v_mul_f32 v212, v212, v173
    v_mul_f32 v213, v213, v173
    v_mul_f32 v214, v214, v173
    v_mul_f32 v215, v215, v173
    v_mul_f32 v8, v8, v173
    v_mul_f32 v9, v9, v173
    v_mul_f32 v10, v10, v173
    v_mul_f32 v11, v11, v173
    v_mul_f32 v20, v20, v173
    v_mul_f32 v21, v21, v173
    v_mul_f32 v22, v22, v173
    v_mul_f32 v23, v23, v173
    v_mul_f32 v32, v32, v173
    v_mul_f32 v33, v33, v173
    v_mul_f32 v34, v34, v173
    v_mul_f32 v35, v35, v173
    v_mul_f32 v44, v44, v173
    v_mul_f32 v45, v45, v173
    v_mul_f32 v46, v46, v173
    v_mul_f32 v47, v47, v173
    v_mul_f32 v56, v56, v173
    v_mul_f32 v57, v57, v173
    v_mul_f32 v58, v58, v173
    v_mul_f32 v59, v59, v173
    v_mul_f32 v68, v68, v173
    v_mul_f32 v69, v69, v173
    v_mul_f32 v70, v70, v173
    v_mul_f32 v71, v71, v173
    v_mul_f32 v80, v80, v173
    v_mul_f32 v81, v81, v173
    v_mul_f32 v82, v82, v173
    v_mul_f32 v83, v83, v173
    v_mul_f32 v92, v92, v173
    v_mul_f32 v93, v93, v173
    v_mul_f32 v94, v94, v173
    v_mul_f32 v95, v95, v173
    ds_read_b128 v[220:223], v244 offset:52224
    s_waitcnt lgkmcnt(0)
    v_mfma_f32_16x16x32_bf16 v[144:147], v[220:223], v[96:99], v[192:195]
    v_mfma_f32_16x16x32_bf16 v[148:151], v[220:223], v[100:103], v[196:199]
    v_mfma_f32_16x16x32_bf16 v[152:155], v[220:223], v[104:107], v[200:203]
    ds_read_b128 v[248:251], v244 offset:52288
    s_waitcnt lgkmcnt(0)
    v_mfma_f32_16x16x32_bf16 v[144:147], v[248:251], v[108:111], v[144:147]
    v_mfma_f32_16x16x32_bf16 v[148:151], v[248:251], v[112:115], v[148:151]
    v_mfma_f32_16x16x32_bf16 v[152:155], v[248:251], v[116:119], v[152:155]
    ds_read_b128 v[220:223], v244 offset:52352
    s_waitcnt lgkmcnt(0)
    v_mfma_f32_16x16x32_bf16 v[144:147], v[220:223], v[120:123], v[144:147]
    v_mfma_f32_16x16x32_bf16 v[148:151], v[220:223], v[124:127], v[148:151]
    v_mfma_f32_16x16x32_bf16 v[152:155], v[220:223], v[128:131], v[152:155]
    ds_read_b128 v[248:251], v244 offset:52416
    s_waitcnt lgkmcnt(0)
    v_mfma_f32_16x16x32_bf16 v[144:147], v[248:251], v[132:135], v[144:147]
    v_mfma_f32_16x16x32_bf16 v[148:151], v[248:251], v[136:139], v[148:151]
    v_mfma_f32_16x16x32_bf16 v[152:155], v[248:251], v[140:143], v[152:155]
    ds_read_b128 v[220:223], v244 offset:56576
    s_waitcnt lgkmcnt(0)
    v_mfma_f32_16x16x32_bf16 v[156:159], v[220:223], v[96:99], v[192:195]
    v_mfma_f32_16x16x32_bf16 v[160:163], v[220:223], v[100:103], v[196:199]
    v_mfma_f32_16x16x32_bf16 v[164:167], v[220:223], v[104:107], v[200:203]
    ds_read_b128 v[248:251], v244 offset:56640
    s_waitcnt lgkmcnt(0)
    v_mfma_f32_16x16x32_bf16 v[156:159], v[248:251], v[108:111], v[156:159]
    v_mfma_f32_16x16x32_bf16 v[160:163], v[248:251], v[112:115], v[160:163]
    v_mfma_f32_16x16x32_bf16 v[164:167], v[248:251], v[116:119], v[164:167]
    ds_read_b128 v[220:223], v244 offset:56704
    s_waitcnt lgkmcnt(0)
    v_mfma_f32_16x16x32_bf16 v[156:159], v[220:223], v[120:123], v[156:159]
    v_mfma_f32_16x16x32_bf16 v[160:163], v[220:223], v[124:127], v[160:163]
    v_mfma_f32_16x16x32_bf16 v[164:167], v[220:223], v[128:131], v[164:167]
    ds_read_b128 v[248:251], v244 offset:56768
    s_waitcnt lgkmcnt(0)
    v_mfma_f32_16x16x32_bf16 v[156:159], v[248:251], v[132:135], v[156:159]
    v_mfma_f32_16x16x32_bf16 v[160:163], v[248:251], v[136:139], v[160:163]
    v_mfma_f32_16x16x32_bf16 v[164:167], v[248:251], v[140:143], v[164:167]
    v_exp_f32 v144, v144
    v_exp_f32 v145, v145
    v_exp_f32 v146, v146
    v_exp_f32 v147, v147
    v_exp_f32 v148, v148
    v_exp_f32 v149, v149
    s_branch A_back5
A_rare6:
    s_waitcnt lgkmcnt(0)
    ds_read_b128 v[220:223], v244 offset:52224
    s_waitcnt lgkmcnt(0)
    v_mfma_f32_16x16x32_bf16 v[144:147], v[220:223], v[96:99], v[192:195]
    v_mfma_f32_16x16x32_bf16 v[148:151], v[220:223], v[100:103], v[196:199]
    v_mfma_f32_16x16x32_bf16 v[152:155], v[220:223], v[104:107], v[200:203]
    ds_read_b128 v[248:251], v244 offset:52288
    s_waitcnt lgkmcnt(0)
    v_mfma_f32_16x16x32_bf16 v[144:147], v[248:251], v[108:111], v[144:147]
    v_mfma_f32_16x16x32_bf16 v[148:151], v[248:251], v[112:115], v[148:151]
    v_mfma_f32_16x16x32_bf16 v[152:155], v[248:251], v[116:119], v[152:155]
    ds_read_b128 v[220:223], v244 offset:52352
    s_waitcnt lgkmcnt(0)
    v_mfma_f32_16x16x32_bf16 v[144:147], v[220:223], v[120:123], v[144:147]
    v_mfma_f32_16x16x32_bf16 v[148:151], v[220:223], v[124:127], v[148:151]
    v_mfma_f32_16x16x32_bf16 v[152:155], v[220:223], v[128:131], v[152:155]
    ds_read_b128 v[248:251], v244 offset:52416
    s_waitcnt lgkmcnt(0)
    v_mfma_f32_16x16x32_bf16 v[144:147], v[248:251], v[132:135], v[144:147]
    v_mfma_f32_16x16x32_bf16 v[148:151], v[248:251], v[136:139], v[148:151]
    v_mfma_f32_16x16x32_bf16 v[152:155], v[248:251], v[140:143], v[152:155]
    ds_read_b128 v[220:223], v244 offset:56576
    s_waitcnt lgkmcnt(0)
    v_mfma_f32_16x16x32_bf16 v[156:159], v[220:223], v[96:99], v[192:195]
    v_mfma_f32_16x16x32_bf16 v[160:163], v[220:223], v[100:103], v[196:199]
    v_mfma_f32_16x16x32_bf16 v[164:167], v[220:223], v[104:107], v[200:203]
    ds_read_b128 v[248:251], v244 offset:56640
    s_waitcnt lgkmcnt(0)
    v_mfma_f32_16x16x32_bf16 v[156:159], v[248:251], v[108:111], v[156:159]
    v_mfma_f32_16x16x32_bf16 v[160:163], v[248:251], v[112:115], v[160:163]
    v_mfma_f32_16x16x32_bf16 v[164:167], v[248:251], v[116:119], v[164:167]
    ds_read_b128 v[220:223], v244 offset:56704
    s_waitcnt lgkmcnt(0)
    v_mfma_f32_16x16x32_bf16 v[156:159], v[220:223], v[120:123], v[156:159]
    v_mfma_f32_16x16x32_bf16 v[160:163], v[220:223], v[124:127], v[160:163]
    v_mfma_f32_16x16x32_bf16 v[164:167], v[220:223], v[128:131], v[164:167]
    ds_read_b128 v[248:251], v244 offset:56768
    s_waitcnt lgkmcnt(0)
    v_mfma_f32_16x16x32_bf16 v[156:159], v[248:251], v[132:135], v[156:159]
    v_mfma_f32_16x16x32_bf16 v[160:163], v[248:251], v[136:139], v[160:163]
    v_mfma_f32_16x16x32_bf16 v[164:167], v[248:251], v[140:143], v[164:167]
    v_max3_f32 v180, v144, v145, v146
    s_nop 4
    v_max3_f32 v180, v180, v147, v156
    v_max3_f32 v180, v180, v157, v158
    v_max_f32 v180, v180, v159
    v_max3_f32 v182, v148, v149, v150
    v_max3_f32 v182, v182, v151, v160
    v_max3_f32 v182, v182, v161, v162
    v_max_f32 v182, v182, v163
    v_max3_f32 v184, v152, v153, v154
    v_max3_f32 v184, v184, v155, v164
    v_max3_f32 v184, v184, v165, v166
    v_max_f32 v184, v184, v167
    v_mov_b32 v181, v180
    v_mov_b32 v183, v182
    v_mov_b32 v185, v184
    v_permlane16_swap_b32 v180, v181
    v_permlane16_swap_b32 v182, v183
    v_permlane16_swap_b32 v184, v185
    v_max_f32 v180, v180, v181
    v_max_f32 v182, v182, v183
    v_max_f32 v184, v184, v185
    v_mov_b32 v181, v180
    v_mov_b32 v183, v182
    v_mov_b32 v185, v184
    v_permlane32_swap_b32 v180, v181
    v_permlane32_swap_b32 v182, v183
    v_permlane32_swap_b32 v184, v185
    v_max_f32 v180, v180, v181
    v_max_f32 v182, v182, v183
    v_max_f32 v184, v184, v185
    v_add_f32 v180, 0x41800000, v180
    v_max_f32 v180, 0, v180
    v_exp_f32 v181, -v180
    v_add_f32 v182, 0x41800000, v182
    v_max_f32 v182, 0, v182
    v_exp_f32 v183, -v182
    v_add_f32 v184, 0x41800000, v184
    v_max_f32 v184, 0, v184
    v_exp_f32 v185, -v184
    v_sub_f32 v192, v192, v180
    v_sub_f32 v193, v193, v180
    v_sub_f32 v194, v194, v180
    v_sub_f32 v195, v195, v180
    v_sub_f32 v144, v144, v180
    v_sub_f32 v145, v145, v180
    v_sub_f32 v146, v146, v180
    v_sub_f32 v147, v147, v180
    v_sub_f32 v156, v156, v180
    v_sub_f32 v157, v157, v180
    v_sub_f32 v158, v158, v180
    v_sub_f32 v159, v159, v180
    v_sub_f32 v196, v196, v182
    v_sub_f32 v197, v197, v182
    v_sub_f32 v198, v198, v182
    v_sub_f32 v199, v199, v182
    v_sub_f32 v148, v148, v182
    v_sub_f32 v149, v149, v182
    v_sub_f32 v150, v150, v182
    v_sub_f32 v151, v151, v182
    v_sub_f32 v160, v160, v182
    v_sub_f32 v161, v161, v182
    v_sub_f32 v162, v162, v182
    v_sub_f32 v163, v163, v182
    v_sub_f32 v200, v200, v184
    v_sub_f32 v201, v201, v184
    v_sub_f32 v202, v202, v184
    v_sub_f32 v203, v203, v184
    v_sub_f32 v152, v152, v184
    v_sub_f32 v153, v153, v184
    v_sub_f32 v154, v154, v184
    v_sub_f32 v155, v155, v184
    v_sub_f32 v164, v164, v184
    v_sub_f32 v165, v165, v184
    v_sub_f32 v166, v166, v184
    v_sub_f32 v167, v167, v184
    v_exp_f32 v144, v144
    v_exp_f32 v145, v145
    v_exp_f32 v146, v146
    v_exp_f32 v147, v147
    v_exp_f32 v148, v148
    v_exp_f32 v149, v149
    v_exp_f32 v150, v150
    v_exp_f32 v151, v151
    v_exp_f32 v152, v152
    v_exp_f32 v153, v153
    v_exp_f32 v154, v154
    v_exp_f32 v155, v155
    v_exp_f32 v156, v156
    v_exp_f32 v157, v157
    v_exp_f32 v158, v158
    v_exp_f32 v159, v159
    v_exp_f32 v160, v160
    v_exp_f32 v161, v161
    v_exp_f32 v162, v162
    v_exp_f32 v163, v163
    v_exp_f32 v164, v164
    v_exp_f32 v165, v165
    v_exp_f32 v166, v166
    v_exp_f32 v167, v167
    v_cvt_pk_bf16_f32 v168, v144, v145
    v_cvt_pk_bf16_f32 v169, v146, v147
    v_cvt_pk_bf16_f32 v172, v148, v149
    v_cvt_pk_bf16_f32 v173, v150, v151
    v_cvt_pk_bf16_f32 v176, v152, v153
    v_cvt_pk_bf16_f32 v177, v154, v155
    v_cvt_pk_bf16_f32 v170, v156, v157
    v_cvt_pk_bf16_f32 v171, v158, v159
    v_cvt_pk_bf16_f32 v174, v160, v161
    v_cvt_pk_bf16_f32 v175, v162, v163
    v_cvt_pk_bf16_f32 v178, v164, v165
    v_cvt_pk_bf16_f32 v179, v166, v167
    v_mul_f32 v204, v204, v181
    v_mul_f32 v205, v205, v181
    v_mul_f32 v206, v206, v181
    v_mul_f32 v207, v207, v181
    v_mul_f32 v0, v0, v181
    v_mul_f32 v1, v1, v181
    v_mul_f32 v2, v2, v181
    v_mul_f32 v3, v3, v181
    v_mul_f32 v12, v12, v181
    v_mul_f32 v13, v13, v181
    v_mul_f32 v14, v14, v181
    v_mul_f32 v15, v15, v181
    v_mul_f32 v24, v24, v181
    v_mul_f32 v25, v25, v181
    v_mul_f32 v26, v26, v181
    v_mul_f32 v27, v27, v181
    v_mul_f32 v36, v36, v181
    v_mul_f32 v37, v37, v181
    v_mul_f32 v38, v38, v181
    v_mul_f32 v39, v39, v181
    v_mul_f32 v48, v48, v181
    v_mul_f32 v49, v49, v181
    v_mul_f32 v50, v50, v181
    v_mul_f32 v51, v51, v181
    v_mul_f32 v60, v60, v181
    v_mul_f32 v61, v61, v181
    v_mul_f32 v62, v62, v181
    v_mul_f32 v63, v63, v181
    v_mul_f32 v72, v72, v181
    v_mul_f32 v73, v73, v181
    v_mul_f32 v74, v74, v181
    v_mul_f32 v75, v75, v181
    v_mul_f32 v84, v84, v181
    v_mul_f32 v85, v85, v181
    v_mul_f32 v86, v86, v181
    v_mul_f32 v87, v87, v181
    v_mul_f32 v208, v208, v183
    v_mul_f32 v209, v209, v183
    v_mul_f32 v210, v210, v183
    v_mul_f32 v211, v211, v183
    v_mul_f32 v4, v4, v183
    v_mul_f32 v5, v5, v183
    v_mul_f32 v6, v6, v183
    v_mul_f32 v7, v7, v183
    v_mul_f32 v16, v16, v183
    v_mul_f32 v17, v17, v183
    v_mul_f32 v18, v18, v183
    v_mul_f32 v19, v19, v183
    v_mul_f32 v28, v28, v183
    v_mul_f32 v29, v29, v183
    v_mul_f32 v30, v30, v183
    v_mul_f32 v31, v31, v183
    v_mul_f32 v40, v40, v183
    v_mul_f32 v41, v41, v183
    v_mul_f32 v42, v42, v183
    v_mul_f32 v43, v43, v183
    v_mul_f32 v52, v52, v183
    v_mul_f32 v53, v53, v183
    v_mul_f32 v54, v54, v183
    v_mul_f32 v55, v55, v183
    v_mul_f32 v64, v64, v183
    v_mul_f32 v65, v65, v183
    v_mul_f32 v66, v66, v183
    v_mul_f32 v67, v67, v183
    v_mul_f32 v76, v76, v183
    v_mul_f32 v77, v77, v183
    v_mul_f32 v78, v78, v183
    v_mul_f32 v79, v79, v183
    v_mul_f32 v88, v88, v183
    v_mul_f32 v89, v89, v183
    v_mul_f32 v90, v90, v183
    v_mul_f32 v91, v91, v183
    v_mul_f32 v212, v212, v185
    v_mul_f32 v213, v213, v185
    v_mul_f32 v214, v214, v185
    v_mul_f32 v215, v215, v185
    v_mul_f32 v8, v8, v185
    v_mul_f32 v9, v9, v185
    v_mul_f32 v10, v10, v185
    v_mul_f32 v11, v11, v185
    v_mul_f32 v20, v20, v185
    v_mul_f32 v21, v21, v185
    v_mul_f32 v22, v22, v185
    v_mul_f32 v23, v23, v185
    v_mul_f32 v32, v32, v185
    v_mul_f32 v33, v33, v185
    v_mul_f32 v34, v34, v185
    v_mul_f32 v35, v35, v185
    v_mul_f32 v44, v44, v185
    v_mul_f32 v45, v45, v185
    v_mul_f32 v46, v46, v185
    v_mul_f32 v47, v47, v185
    v_mul_f32 v56, v56, v185
    v_mul_f32 v57, v57, v185
    v_mul_f32 v58, v58, v185
    v_mul_f32 v59, v59, v185
    v_mul_f32 v68, v68, v185
    v_mul_f32 v69, v69, v185
    v_mul_f32 v70, v70, v185
    v_mul_f32 v71, v71, v185
    v_mul_f32 v80, v80, v185
    v_mul_f32 v81, v81, v185
    v_mul_f32 v82, v82, v185
    v_mul_f32 v83, v83, v185
    v_mul_f32 v92, v92, v185
    v_mul_f32 v93, v93, v185
    v_mul_f32 v94, v94, v185
    v_mul_f32 v95, v95, v185
    ds_read_b128 v[220:223], v244 offset:60928
    s_waitcnt lgkmcnt(0)
    v_mfma_f32_16x16x32_bf16 v[144:147], v[220:223], v[96:99], v[192:195]
    v_mfma_f32_16x16x32_bf16 v[148:151], v[220:223], v[100:103], v[196:199]
    v_mfma_f32_16x16x32_bf16 v[152:155], v[220:223], v[104:107], v[200:203]
    ds_read_b128 v[248:251], v244 offset:60992
    s_waitcnt lgkmcnt(0)
    v_mfma_f32_16x16x32_bf16 v[144:147], v[248:251], v[108:111], v[144:147]
    v_mfma_f32_16x16x32_bf16 v[148:151], v[248:251], v[112:115], v[148:151]
    v_mfma_f32_16x16x32_bf16 v[152:155], v[248:251], v[116:119], v[152:155]
    ds_read_b128 v[220:223], v244 offset:61056
    s_waitcnt lgkmcnt(0)
    v_mfma_f32_16x16x32_bf16 v[144:147], v[220:223], v[120:123], v[144:147]
    v_mfma_f32_16x16x32_bf16 v[148:151], v[220:223], v[124:127], v[148:151]
    v_mfma_f32_16x16x32_bf16 v[152:155], v[220:223], v[128:131], v[152:155]
    ds_read_b128 v[248:251], v244 offset:61120
    s_waitcnt lgkmcnt(0)
    v_mfma_f32_16x16x32_bf16 v[144:147], v[248:251], v[132:135], v[144:147]
    v_mfma_f32_16x16x32_bf16 v[148:151], v[248:251], v[136:139], v[148:151]
    v_mfma_f32_16x16x32_bf16 v[152:155], v[248:251], v[140:143], v[152:155]
    ds_read_b128 v[220:223], v244 offset:65280
    s_waitcnt lgkmcnt(0)
    v_mfma_f32_16x16x32_bf16 v[156:159], v[220:223], v[96:99], v[192:195]
    v_mfma_f32_16x16x32_bf16 v[160:163], v[220:223], v[100:103], v[196:199]
    v_mfma_f32_16x16x32_bf16 v[164:167], v[220:223], v[104:107], v[200:203]
    ds_read_b128 v[248:251], v244 offset:65344
    s_waitcnt lgkmcnt(0)
    v_mfma_f32_16x16x32_bf16 v[156:159], v[248:251], v[108:111], v[156:159]
    v_mfma_f32_16x16x32_bf16 v[160:163], v[248:251], v[112:115], v[160:163]
    v_mfma_f32_16x16x32_bf16 v[164:167], v[248:251], v[116:119], v[164:167]
    ds_read_b128 v[220:223], v244 offset:65408
    s_waitcnt lgkmcnt(0)
    v_mfma_f32_16x16x32_bf16 v[156:159], v[220:223], v[120:123], v[156:159]
    v_mfma_f32_16x16x32_bf16 v[160:163], v[220:223], v[124:127], v[160:163]
    v_mfma_f32_16x16x32_bf16 v[164:167], v[220:223], v[128:131], v[164:167]
    ds_read_b128 v[248:251], v244 offset:65472
    s_waitcnt lgkmcnt(0)
    v_mfma_f32_16x16x32_bf16 v[156:159], v[248:251], v[132:135], v[156:159]
    v_mfma_f32_16x16x32_bf16 v[160:163], v[248:251], v[136:139], v[160:163]
    v_mfma_f32_16x16x32_bf16 v[164:167], v[248:251], v[140:143], v[164:167]
    v_exp_f32 v144, v144
    v_exp_f32 v145, v145
    v_exp_f32 v146, v146
    v_exp_f32 v147, v147
    v_exp_f32 v148, v148
    v_exp_f32 v149, v149
    s_branch A_back6
A_rare7:
    s_waitcnt lgkmcnt(0)
    ds_read_b128 v[220:223], v244 offset:60928
    s_waitcnt lgkmcnt(0)
    v_mfma_f32_16x16x32_bf16 v[144:147], v[220:223], v[96:99], v[192:195]
    v_mfma_f32_16x16x32_bf16 v[148:151], v[220:223], v[100:103], v[196:199]
    v_mfma_f32_16x16x32_bf16 v[152:155], v[220:223], v[104:107], v[200:203]
    ds_read_b128 v[248:251], v244 offset:60992
    s_waitcnt lgkmcnt(0)
    v_mfma_f32_16x16x32_bf16 v[144:147], v[248:251], v[108:111], v[144:147]
    v_mfma_f32_16x16x32_bf16 v[148:151], v[248:251], v[112:115], v[148:151]
    v_mfma_f32_16x16x32_bf16 v[152:155], v[248:251], v[116:119], v[152:155]
    ds_read_b128 v[220:223], v244 offset:61056
    s_waitcnt lgkmcnt(0)
    v_mfma_f32_16x16x32_bf16 v[144:147], v[220:223], v[120:123], v[144:147]
    v_mfma_f32_16x16x32_bf16 v[148:151], v[220:223], v[124:127], v[148:151]
    v_mfma_f32_16x16x32_bf16 v[152:155], v[220:223], v[128:131], v[152:155]
    ds_read_b128 v[248:251], v244 offset:61120
    s_waitcnt lgkmcnt(0)
    v_mfma_f32_16x16x32_bf16 v[144:147], v[248:251], v[132:135], v[144:147]
    v_mfma_f32_16x16x32_bf16 v[148:151], v[248:251], v[136:139], v[148:151]
    v_mfma_f32_16x16x32_bf16 v[152:155], v[248:251], v[140:143], v[152:155]
    ds_read_b128 v[220:223], v244 offset:65280
    s_waitcnt lgkmcnt(0)
    v_mfma_f32_16x16x32_bf16 v[156:159], v[220:223], v[96:99], v[192:195]
    v_mfma_f32_16x16x32_bf16 v[160:163], v[220:223], v[100:103], v[196:199]
    v_mfma_f32_16x16x32_bf16 v[164:167], v[220:223], v[104:107], v[200:203]
    ds_read_b128 v[248:251], v244 offset:65344
    s_waitcnt lgkmcnt(0)
    v_mfma_f32_16x16x32_bf16 v[156:159], v[248:251], v[108:111], v[156:159]
    v_mfma_f32_16x16x32_bf16 v[160:163], v[248:251], v[112:115], v[160:163]
    v_mfma_f32_16x16x32_bf16 v[164:167], v[248:251], v[116:119], v[164:167]
    ds_read_b128 v[220:223], v244 offset:65408
    s_waitcnt lgkmcnt(0)
    v_mfma_f32_16x16x32_bf16 v[156:159], v[220:223], v[120:123], v[156:159]
    v_mfma_f32_16x16x32_bf16 v[160:163], v[220:223], v[124:127], v[160:163]
    v_mfma_f32_16x16x32_bf16 v[164:167], v[220:223], v[128:131], v[164:167]
    ds_read_b128 v[248:251], v244 offset:65472
    s_waitcnt lgkmcnt(0)
    v_mfma_f32_16x16x32_bf16 v[156:159], v[248:251], v[132:135], v[156:159]
    v_mfma_f32_16x16x32_bf16 v[160:163], v[248:251], v[136:139], v[160:163]
    v_mfma_f32_16x16x32_bf16 v[164:167], v[248:251], v[140:143], v[164:167]
    v_max3_f32 v168, v144, v145, v146
    s_nop 4
    v_max3_f32 v168, v168, v147, v156
    v_max3_f32 v168, v168, v157, v158
    v_max_f32 v168, v168, v159
    v_max3_f32 v170, v148, v149, v150
    v_max3_f32 v170, v170, v151, v160
    v_max3_f32 v170, v170, v161, v162
    v_max_f32 v170, v170, v163
    v_max3_f32 v172, v152, v153, v154
    v_max3_f32 v172, v172, v155, v164
    v_max3_f32 v172, v172, v165, v166
    v_max_f32 v172, v172, v167
    v_mov_b32 v169, v168
    v_mov_b32 v171, v170
    v_mov_b32 v173, v172
    v_permlane16_swap_b32 v168, v169
    v_permlane16_swap_b32 v170, v171
    v_permlane16_swap_b32 v172, v173
    v_max_f32 v168, v168, v169
    v_max_f32 v170, v170, v171
    v_max_f32 v172, v172, v173
    v_mov_b32 v169, v168
    v_mov_b32 v171, v170
    v_mov_b32 v173, v172
    v_permlane32_swap_b32 v168, v169
    v_permlane32_swap_b32 v170, v171
    v_permlane32_swap_b32 v172, v173
    v_max_f32 v168, v168, v169
    v_max_f32 v170, v170, v171
    v_max_f32 v172, v172, v173
    v_add_f32 v168, 0x41800000, v168
    v_max_f32 v168, 0, v168
    v_exp_f32 v169, -v168
    v_add_f32 v170, 0x41800000, v170
    v_max_f32 v170, 0, v170
    v_exp_f32 v171, -v170
    v_add_f32 v172, 0x41800000, v172
    v_max_f32 v172, 0, v172
    v_exp_f32 v173, -v172
    v_sub_f32 v192, v192, v168
    v_sub_f32 v193, v193, v168
    v_sub_f32 v194, v194, v168
    v_sub_f32 v195, v195, v168
    v_sub_f32 v144, v144, v168
    v_sub_f32 v145, v145, v168
    v_sub_f32 v146, v146, v168
    v_sub_f32 v147, v147, v168
    v_sub_f32 v156, v156, v168
    v_sub_f32 v157, v157, v168
    v_sub_f32 v158, v158, v168
    v_sub_f32 v159, v159, v168
    v_sub_f32 v196, v196, v170
    v_sub_f32 v197, v197, v170
    v_sub_f32 v198, v198, v170
    v_sub_f32 v199, v199, v170
    v_sub_f32 v148, v148, v170
    v_sub_f32 v149, v149, v170
    v_sub_f32 v150, v150, v170
    v_sub_f32 v151, v151, v170
    v_sub_f32 v160, v160, v170
    v_sub_f32 v161, v161, v170
    v_sub_f32 v162, v162, v170
    v_sub_f32 v163, v163, v170
    v_sub_f32 v200, v200, v172
    v_sub_f32 v201, v201, v172
    v_sub_f32 v202, v202, v172
    v_sub_f32 v203, v203, v172
    v_sub_f32 v152, v152, v172
    v_sub_f32 v153, v153, v172
    v_sub_f32 v154, v154, v172
    v_sub_f32 v155, v155, v172
    v_sub_f32 v164, v164, v172
    v_sub_f32 v165, v165, v172
    v_sub_f32 v166, v166, v172
    v_sub_f32 v167, v167, v172
    v_exp_f32 v144, v144
    v_exp_f32 v145, v145
    v_exp_f32 v146, v146
    v_exp_f32 v147, v147
    v_exp_f32 v148, v148
    v_exp_f32 v149, v149
    v_exp_f32 v150, v150
    v_exp_f32 v151, v151
    v_exp_f32 v152, v152
    v_exp_f32 v153, v153
    v_exp_f32 v154, v154
    v_exp_f32 v155, v155
    v_exp_f32 v156, v156
    v_exp_f32 v157, v157
    v_exp_f32 v158, v158
    v_exp_f32 v159, v159
    v_exp_f32 v160, v160
    v_exp_f32 v161, v161
    v_exp_f32 v162, v162
    v_exp_f32 v163, v163
    v_exp_f32 v164, v164
    v_exp_f32 v165, v165
    v_exp_f32 v166, v166
    v_exp_f32 v167, v167
    v_cvt_pk_bf16_f32 v180, v144, v145
    v_cvt_pk_bf16_f32 v181, v146, v147
    v_cvt_pk_bf16_f32 v184, v148, v149
    v_cvt_pk_bf16_f32 v185, v150, v151
    v_cvt_pk_bf16_f32 v188, v152, v153
    v_cvt_pk_bf16_f32 v189, v154, v155
    v_cvt_pk_bf16_f32 v182, v156, v157
    v_cvt_pk_bf16_f32 v183, v158, v159
    v_cvt_pk_bf16_f32 v186, v160, v161
    v_cvt_pk_bf16_f32 v187, v162, v163
    v_cvt_pk_bf16_f32 v190, v164, v165
    v_cvt_pk_bf16_f32 v191, v166, v167
    v_mul_f32 v204, v204, v169
    v_mul_f32 v205, v205, v169
    v_mul_f32 v206, v206, v169
    v_mul_f32 v207, v207, v169
    v_mul_f32 v0, v0, v169
    v_mul_f32 v1, v1, v169
    v_mul_f32 v2, v2, v169
    v_mul_f32 v3, v3, v169
    v_mul_f32 v12, v12, v169
    v_mul_f32 v13, v13, v169
    v_mul_f32 v14, v14, v169
    v_mul_f32 v15, v15, v169
    v_mul_f32 v24, v24, v169
    v_mul_f32 v25, v25, v169
    v_mul_f32 v26, v26, v169
    v_mul_f32 v27, v27, v169
    v_mul_f32 v36, v36, v169
    v_mul_f32 v37, v37, v169
    v_mul_f32 v38, v38, v169
    v_mul_f32 v39, v39, v169
    v_mul_f32 v48, v48, v169
    v_mul_f32 v49, v49, v169
    v_mul_f32 v50, v50, v169
    v_mul_f32 v51, v51, v169
    v_mul_f32 v60, v60, v169
    v_mul_f32 v61, v61, v169
    v_mul_f32 v62, v62, v169
    v_mul_f32 v63, v63, v169
    v_mul_f32 v72, v72, v169
    v_mul_f32 v73, v73, v169
    v_mul_f32 v74, v74, v169
    v_mul_f32 v75, v75, v169
    v_mul_f32 v84, v84, v169
    v_mul_f32 v85, v85, v169
    v_mul_f32 v86, v86, v169
    v_mul_f32 v87, v87, v169
    v_mul_f32 v208, v208, v171
    v_mul_f32 v209, v209, v171
    v_mul_f32 v210, v210, v171
    v_mul_f32 v211, v211, v171
    v_mul_f32 v4, v4, v171
    v_mul_f32 v5, v5, v171
    v_mul_f32 v6, v6, v171
    v_mul_f32 v7, v7, v171
    v_mul_f32 v16, v16, v171
    v_mul_f32 v17, v17, v171
    v_mul_f32 v18, v18, v171
    v_mul_f32 v19, v19, v171
    v_mul_f32 v28, v28, v171
    v_mul_f32 v29, v29, v171
    v_mul_f32 v30, v30, v171
    v_mul_f32 v31, v31, v171
    v_mul_f32 v40, v40, v171
    v_mul_f32 v41, v41, v171
    v_mul_f32 v42, v42, v171
    v_mul_f32 v43, v43, v171
    v_mul_f32 v52, v52, v171
    v_mul_f32 v53, v53, v171
    v_mul_f32 v54, v54, v171
    v_mul_f32 v55, v55, v171
    v_mul_f32 v64, v64, v171
    v_mul_f32 v65, v65, v171
    v_mul_f32 v66, v66, v171
    v_mul_f32 v67, v67, v171
    v_mul_f32 v76, v76, v171
    v_mul_f32 v77, v77, v171
    v_mul_f32 v78, v78, v171
    v_mul_f32 v79, v79, v171
    v_mul_f32 v88, v88, v171
    v_mul_f32 v89, v89, v171
    v_mul_f32 v90, v90, v171
    v_mul_f32 v91, v91, v171
    v_mul_f32 v212, v212, v173
    v_mul_f32 v213, v213, v173
    v_mul_f32 v214, v214, v173
    v_mul_f32 v215, v215, v173
    v_mul_f32 v8, v8, v173
    v_mul_f32 v9, v9, v173
    v_mul_f32 v10, v10, v173
    v_mul_f32 v11, v11, v173
    v_mul_f32 v20, v20, v173
    v_mul_f32 v21, v21, v173
    v_mul_f32 v22, v22, v173
    v_mul_f32 v23, v23, v173
    v_mul_f32 v32, v32, v173
    v_mul_f32 v33, v33, v173
    v_mul_f32 v34, v34, v173
    v_mul_f32 v35, v35, v173
    v_mul_f32 v44, v44, v173
    v_mul_f32 v45, v45, v173
    v_mul_f32 v46, v46, v173
    v_mul_f32 v47, v47, v173
    v_mul_f32 v56, v56, v173
    v_mul_f32 v57, v57, v173
    v_mul_f32 v58, v58, v173
    v_mul_f32 v59, v59, v173
    v_mul_f32 v68, v68, v173
    v_mul_f32 v69, v69, v173
    v_mul_f32 v70, v70, v173
    v_mul_f32 v71, v71, v173
    v_mul_f32 v80, v80, v173
    v_mul_f32 v81, v81, v173
    v_mul_f32 v82, v82, v173
    v_mul_f32 v83, v83, v173
    v_mul_f32 v92, v92, v173
    v_mul_f32 v93, v93, v173
    v_mul_f32 v94, v94, v173
    v_mul_f32 v95, v95, v173
    ds_read_b128 v[220:223], v244 offset:0
    s_waitcnt lgkmcnt(0)
    v_mfma_f32_16x16x32_bf16 v[144:147], v[220:223], v[96:99], v[192:195]
    v_mfma_f32_16x16x32_bf16 v[148:151], v[220:223], v[100:103], v[196:199]
    v_mfma_f32_16x16x32_bf16 v[152:155], v[220:223], v[104:107], v[200:203]
    ds_read_b128 v[248:251], v244 offset:64
    s_waitcnt lgkmcnt(0)
    v_mfma_f32_16x16x32_bf16 v[144:147], v[248:251], v[108:111], v[144:147]
    v_mfma_f32_16x16x32_bf16 v[148:151], v[248:251], v[112:115], v[148:151]
    v_mfma_f32_16x16x32_bf16 v[152:155], v[248:251], v[116:119], v[152:155]
    ds_read_b128 v[220:223], v244 offset:128
    s_waitcnt lgkmcnt(0)
    v_mfma_f32_16x16x32_bf16 v[144:147], v[220:223], v[120:123], v[144:147]
    v_mfma_f32_16x16x32_bf16 v[148:151], v[220:223], v[124:127], v[148:151]
    v_mfma_f32_16x16x32_bf16 v[152:155], v[220:223], v[128:131], v[152:155]
    ds_read_b128 v[248:251], v244 offset:192
    s_waitcnt lgkmcnt(0)
    v_mfma_f32_16x16x32_bf16 v[144:147], v[248:251], v[132:135], v[144:147]
    v_mfma_f32_16x16x32_bf16 v[148:151], v[248:251], v[136:139], v[148:151]
    v_mfma_f32_16x16x32_bf16 v[152:155], v[248:251], v[140:143], v[152:155]
    ds_read_b128 v[220:223], v244 offset:4352
    s_waitcnt lgkmcnt(0)
    v_mfma_f32_16x16x32_bf16 v[156:159], v[220:223], v[96:99], v[192:195]
    v_mfma_f32_16x16x32_bf16 v[160:163], v[220:223], v[100:103], v[196:199]
    v_mfma_f32_16x16x32_bf16 v[164:167], v[220:223], v[104:107], v[200:203]
    ds_read_b128 v[248:251], v244 offset:4416
    s_waitcnt lgkmcnt(0)
    v_mfma_f32_16x16x32_bf16 v[156:159], v[248:251], v[108:111], v[156:159]
    v_mfma_f32_16x16x32_bf16 v[160:163], v[248:251], v[112:115], v[160:163]
    v_mfma_f32_16x16x32_bf16 v[164:167], v[248:251], v[116:119], v[164:167]
    ds_read_b128 v[220:223], v244 offset:4480
    s_waitcnt lgkmcnt(0)
    v_mfma_f32_16x16x32_bf16 v[156:159], v[220:223], v[120:123], v[156:159]
    v_mfma_f32_16x16x32_bf16 v[160:163], v[220:223], v[124:127], v[160:163]
    v_mfma_f32_16x16x32_bf16 v[164:167], v[220:223], v[128:131], v[164:167]
    ds_read_b128 v[248:251], v244 offset:4544
    s_waitcnt lgkmcnt(0)
    v_mfma_f32_16x16x32_bf16 v[156:159], v[248:251], v[132:135], v[156:159]
    v_mfma_f32_16x16x32_bf16 v[160:163], v[248:251], v[136:139], v[160:163]
    v_mfma_f32_16x16x32_bf16 v[164:167], v[248:251], v[140:143], v[164:167]
    v_exp_f32 v144, v144
    v_exp_f32 v145, v145
    v_exp_f32 v146, v146
    v_exp_f32 v147, v147
    v_exp_f32 v148, v148
    v_exp_f32 v149, v149
    s_branch A_back7
A_rareL:
    s_waitcnt lgkmcnt(0)
    ds_read_b128 v[220:223], v244 offset:60928
    s_waitcnt lgkmcnt(0)
    v_mfma_f32_16x16x32_bf16 v[144:147], v[220:223], v[96:99], v[192:195]
    v_mfma_f32_16x16x32_bf16 v[148:151], v[220:223], v[100:103], v[196:199]
    v_mfma_f32_16x16x32_bf16 v[152:155], v[220:223], v[104:107], v[200:203]
    ds_read_b128 v[248:251], v244 offset:60992
    s_waitcnt lgkmcnt(0)
    v_mfma_f32_16x16x32_bf16 v[144:147], v[248:251], v[108:111], v[144:147]
    v_mfma_f32_16x16x32_bf16 v[148:151], v[248:251], v[112:115], v[148:151]
    v_mfma_f32_16x16x32_bf16 v[152:155], v[248:251], v[116:119], v[152:155]
    ds_read_b128 v[220:223], v244 offset:61056
    s_waitcnt lgkmcnt(0)
    v_mfma_f32_16x16x32_bf16 v[144:147], v[220:223], v[120:123], v[144:147]
    v_mfma_f32_16x16x32_bf16 v[148:151], v[220:223], v[124:127], v[148:151]
    v_mfma_f32_16x16x32_bf16 v[152:155], v[220:223], v[128:131], v[152:155]
    ds_read_b128 v[248:251], v244 offset:61120
    s_waitcnt lgkmcnt(0)
    v_mfma_f32_16x16x32_bf16 v[144:147], v[248:251], v[132:135], v[144:147]
    v_mfma_f32_16x16x32_bf16 v[148:151], v[248:251], v[136:139], v[148:151]
    v_mfma_f32_16x16x32_bf16 v[152:155], v[248:251], v[140:143], v[152:155]
    ds_read_b128 v[220:223], v244 offset:65280
    s_waitcnt lgkmcnt(0)
    v_mfma_f32_16x16x32_bf16 v[156:159], v[220:223], v[96:99], v[192:195]
    v_mfma_f32_16x16x32_bf16 v[160:163], v[220:223], v[100:103], v[196:199]
    v_mfma_f32_16x16x32_bf16 v[164:167], v[220:223], v[104:107], v[200:203]
    ds_read_b128 v[248:251], v244 offset:65344
    s_waitcnt lgkmcnt(0)
    v_mfma_f32_16x16x32_bf16 v[156:159], v[248:251], v[108:111], v[156:159]
    v_mfma_f32_16x16x32_bf16 v[160:163], v[248:251], v[112:115], v[160:163]
    v_mfma_f32_16x16x32_bf16 v[164:167], v[248:251], v[116:119], v[164:167]
    ds_read_b128 v[220:223], v244 offset:65408
    s_waitcnt lgkmcnt(0)
    v_mfma_f32_16x16x32_bf16 v[156:159], v[220:223], v[120:123], v[156:159]
    v_mfma_f32_16x16x32_bf16 v[160:163], v[220:223], v[124:127], v[160:163]
    v_mfma_f32_16x16x32_bf16 v[164:167], v[220:223], v[128:131], v[164:167]
    ds_read_b128 v[248:251], v244 offset:65472
    s_waitcnt lgkmcnt(0)
    v_mfma_f32_16x16x32_bf16 v[156:159], v[248:251], v[132:135], v[156:159]
    v_mfma_f32_16x16x32_bf16 v[160:163], v[248:251], v[136:139], v[160:163]
    v_mfma_f32_16x16x32_bf16 v[164:167], v[248:251], v[140:143], v[164:167]
    v_max3_f32 v168, v144, v145, v146
    s_nop 4
    v_max3_f32 v168, v168, v147, v156
    v_max3_f32 v168, v168, v157, v158
    v_max_f32 v168, v168, v159
    v_max3_f32 v170, v148, v149, v150
    v_max3_f32 v170, v170, v151, v160
    v_max3_f32 v170, v170, v161, v162
    v_max_f32 v170, v170, v163
    v_max3_f32 v172, v152, v153, v154
    v_max3_f32 v172, v172, v155, v164
    v_max3_f32 v172, v172, v165, v166
    v_max_f32 v172, v172, v167
    v_mov_b32 v169, v168
    v_mov_b32 v171, v170
    v_mov_b32 v173, v172
    v_permlane16_swap_b32 v168, v169
    v_permlane16_swap_b32 v170, v171
    v_permlane16_swap_b32 v172, v173
    v_max_f32 v168, v168, v169
    v_max_f32 v170, v170, v171
    v_max_f32 v172, v172, v173
    v_mov_b32 v169, v168
    v_mov_b32 v171, v170
    v_mov_b32 v173, v172
    v_permlane32_swap_b32 v168, v169
    v_permlane32_swap_b32 v170, v171
    v_permlane32_swap_b32 v172, v173
    v_max_f32 v168, v168, v169
    v_max_f32 v170, v170, v171
    v_max_f32 v172, v172, v173
    v_add_f32 v168, 0x41800000, v168
    v_max_f32 v168, 0, v168
    v_exp_f32 v169, -v168
    v_add_f32 v170, 0x41800000, v170
    v_max_f32 v170, 0, v170
    v_exp_f32 v171, -v170
    v_add_f32 v172, 0x41800000, v172
    v_max_f32 v172, 0, v172
    v_exp_f32 v173, -v172
    v_sub_f32 v192, v192, v168
    v_sub_f32 v193, v193, v168
    v_sub_f32 v194, v194, v168
    v_sub_f32 v195, v195, v168
    v_sub_f32 v144, v144, v168
    v_sub_f32 v145, v145, v168
    v_sub_f32 v146, v146, v168
    v_sub_f32 v147, v147, v168
    v_sub_f32 v156, v156, v168
    v_sub_f32 v157, v157, v168
    v_sub_f32 v158, v158, v168
    v_sub_f32 v159, v159, v168
    v_sub_f32 v196, v196, v170
    v_sub_f32 v197, v197, v170
    v_sub_f32 v198, v198, v170
    v_sub_f32 v199, v199, v170
    v_sub_f32 v148, v148, v170
    v_sub_f32 v149, v149, v170
    v_sub_f32 v150, v150, v170
    v_sub_f32 v151, v151, v170
    v_sub_f32 v160, v160, v170
    v_sub_f32 v161, v161, v170
    v_sub_f32 v162, v162, v170
    v_sub_f32 v163, v163, v170
    v_sub_f32 v200, v200, v172
    v_sub_f32 v201, v201, v172
    v_sub_f32 v202, v202, v172
    v_sub_f32 v203, v203, v172
    v_sub_f32 v152, v152, v172
    v_sub_f32 v153, v153, v172
    v_sub_f32 v154, v154, v172
    v_sub_f32 v155, v155, v172
    v_sub_f32 v164, v164, v172
    v_sub_f32 v165, v165, v172
    v_sub_f32 v166, v166, v172
    v_sub_f32 v167, v167, v172
    v_exp_f32 v144, v144
    v_exp_f32 v145, v145
    v_exp_f32 v146, v146
    v_exp_f32 v147, v147
    v_exp_f32 v148, v148
    v_exp_f32 v149, v149
    v_exp_f32 v150, v150
    v_exp_f32 v151, v151
    v_exp_f32 v152, v152
    v_exp_f32 v153, v153
    v_exp_f32 v154, v154
    v_exp_f32 v155, v155
    v_exp_f32 v156, v156
    v_exp_f32 v157, v157
    v_exp_f32 v158, v158
    v_exp_f32 v159, v159
    v_exp_f32 v160, v160
    v_exp_f32 v161, v161
    v_exp_f32 v162, v162
    v_exp_f32 v163, v163
    v_exp_f32 v164, v164
    v_exp_f32 v165, v165
    v_exp_f32 v166, v166
    v_exp_f32 v167, v167
    v_cvt_pk_bf16_f32 v180, v144, v145
    v_cvt_pk_bf16_f32 v181, v146, v147
    v_cvt_pk_bf16_f32 v184, v148, v149
    v_cvt_pk_bf16_f32 v185, v150, v151
    v_cvt_pk_bf16_f32 v188, v152, v153
    v_cvt_pk_bf16_f32 v189, v154, v155
    v_cvt_pk_bf16_f32 v182, v156, v157
    v_cvt_pk_bf16_f32 v183, v158, v159
    v_cvt_pk_bf16_f32 v186, v160, v161
    v_cvt_pk_bf16_f32 v187, v162, v163
    v_cvt_pk_bf16_f32 v190, v164, v165
    v_cvt_pk_bf16_f32 v191, v166, v167
    v_mul_f32 v204, v204, v169
    v_mul_f32 v205, v205, v169
    v_mul_f32 v206, v206, v169
    v_mul_f32 v207, v207, v169
    v_mul_f32 v0, v0, v169
    v_mul_f32 v1, v1, v169
    v_mul_f32 v2, v2, v169
    v_mul_f32 v3, v3, v169
    v_mul_f32 v12, v12, v169
    v_mul_f32 v13, v13, v169
    v_mul_f32 v14, v14, v169
    v_mul_f32 v15, v15, v169
    v_mul_f32 v24, v24, v169
    v_mul_f32 v25, v25, v169
    v_mul_f32 v26, v26, v169
    v_mul_f32 v27, v27, v169
    v_mul_f32 v36, v36, v169
    v_mul_f32 v37, v37, v169
    v_mul_f32 v38, v38, v169
    v_mul_f32 v39, v39, v169
    v_mul_f32 v48, v48, v169
    v_mul_f32 v49, v49, v169
    v_mul_f32 v50, v50, v169
    v_mul_f32 v51, v51, v169
    v_mul_f32 v60, v60, v169
    v_mul_f32 v61, v61, v169
    v_mul_f32 v62, v62, v169
    v_mul_f32 v63, v63, v169
    v_mul_f32 v72, v72, v169
    v_mul_f32 v73, v73, v169
    v_mul_f32 v74, v74, v169
    v_mul_f32 v75, v75, v169
    v_mul_f32 v84, v84, v169
    v_mul_f32 v85, v85, v169
    v_mul_f32 v86, v86, v169
    v_mul_f32 v87, v87, v169
    v_mul_f32 v208, v208, v171
    v_mul_f32 v209, v209, v171
    v_mul_f32 v210, v210, v171
    v_mul_f32 v211, v211, v171
    v_mul_f32 v4, v4, v171
    v_mul_f32 v5, v5, v171
    v_mul_f32 v6, v6, v171
    v_mul_f32 v7, v7, v171
    v_mul_f32 v16, v16, v171
    v_mul_f32 v17, v17, v171
    v_mul_f32 v18, v18, v171
    v_mul_f32 v19, v19, v171
    v_mul_f32 v28, v28, v171
    v_mul_f32 v29, v29, v171
    v_mul_f32 v30, v30, v171
    v_mul_f32 v31, v31, v171
    v_mul_f32 v40, v40, v171
    v_mul_f32 v41, v41, v171
    v_mul_f32 v42, v42, v171
    v_mul_f32 v43, v43, v171
    v_mul_f32 v52, v52, v171
    v_mul_f32 v53, v53, v171
    v_mul_f32 v54, v54, v171
    v_mul_f32 v55, v55, v171
    v_mul_f32 v64, v64, v171
    v_mul_f32 v65, v65, v171
    v_mul_f32 v66, v66, v171
    v_mul_f32 v67, v67, v171
    v_mul_f32 v76, v76, v171
    v_mul_f32 v77, v77, v171
    v_mul_f32 v78, v78, v171
    v_mul_f32 v79, v79, v171
    v_mul_f32 v88, v88, v171
    v_mul_f32 v89, v89, v171
    v_mul_f32 v90, v90, v171
    v_mul_f32 v91, v91, v171
    v_mul_f32 v212, v212, v173
    v_mul_f32 v213, v213, v173
    v_mul_f32 v214, v214, v173
    v_mul_f32 v215, v215, v173
    v_mul_f32 v8, v8, v173
    v_mul_f32 v9, v9, v173
    v_mul_f32 v10, v10, v173
    v_mul_f32 v11, v11, v173
    v_mul_f32 v20, v20, v173
    v_mul_f32 v21, v21, v173
    v_mul_f32 v22, v22, v173
    v_mul_f32 v23, v23, v173
    v_mul_f32 v32, v32, v173
    v_mul_f32 v33, v33, v173
    v_mul_f32 v34, v34, v173
    v_mul_f32 v35, v35, v173
    v_mul_f32 v44, v44, v173
    v_mul_f32 v45, v45, v173
    v_mul_f32 v46, v46, v173
    v_mul_f32 v47, v47, v173
    v_mul_f32 v56, v56, v173
    v_mul_f32 v57, v57, v173
    v_mul_f32 v58, v58, v173
    v_mul_f32 v59, v59, v173
    v_mul_f32 v68, v68, v173
    v_mul_f32 v69, v69, v173
    v_mul_f32 v70, v70, v173
    v_mul_f32 v71, v71, v173
    v_mul_f32 v80, v80, v173
    v_mul_f32 v81, v81, v173
    v_mul_f32 v82, v82, v173
    v_mul_f32 v83, v83, v173
    v_mul_f32 v92, v92, v173
    v_mul_f32 v93, v93, v173
    v_mul_f32 v94, v94, v173
    v_mul_f32 v95, v95, v173
    s_branch A_backL
A_done:
    s_endpgm
.section .rodata,"a"
.p2align 6
.amdhsa_kernel standalone__gqa_block_cached__near_ridge_kernel
  .amdhsa_next_free_vgpr 256
  .amdhsa_next_free_sgpr 102
  .amdhsa_accum_offset 256
  .amdhsa_group_segment_fixed_size 0
  .amdhsa_kernarg_size 64
  .amdhsa_user_sgpr_count 2
  .amdhsa_user_sgpr_kernarg_segment_ptr 1
  .amdhsa_system_sgpr_workgroup_id_x 1
.end_amdhsa_kernel
```
